```python
import torch

def _softmax(x, axis=-1):
    return torch.softmax(x, dim=axis)
def _gelu(x):
    return torch.nn.functional.gelu(x, approximate="tanh")
def _silu(x):
    return torch.nn.functional.silu(x)
def _sigmoid(x):
    return torch.sigmoid(x)
def _layernorm(x, axis=-1, eps=1e-5):
    m = x.mean(dim=axis, keepdim=True)
    v = x.var(dim=axis, keepdim=True, unbiased=False)
    return (x - m) / torch.sqrt(v + eps)
def _scatter_add(tgt, idx, src, axis=0):
    return tgt.clone().index_add_(axis, idx, src)
def _segment_sum(src, seg, n):
    out = torch.zeros((n,) + src.shape[1:], dtype=src.dtype)
    return out.index_add_(0, seg, src)
def _pad(x, pw):
    flat = tuple(v for pair in reversed(pw) for v in pair)
    return torch.nn.functional.pad(x, flat)

kernel_name = 'sequential_preLN__sliding_local_dilated__geglu_ffn__prompt'

def setup_inputs():

    _w = (lambda a: (lambda t: t.to(torch.bfloat16) if t.is_floating_point() else t)(torch.as_tensor(a)))
    def _A_setup():
        B, S, D = 1, 2048, 1024
        return {
            "x": _w((lambda *s: torch.randn(*s, dtype=torch.bfloat16) * 0.05)(B, S, D)),
            "wqkv": _w((lambda *s: torch.randn(*s, dtype=torch.bfloat16) * 0.05)(D, 3 * D)),
            "wo": _w((lambda *s: torch.randn(*s, dtype=torch.bfloat16) * 0.05)(D, D)),
        }
    _A_in = _A_setup()

    def _B_setup():
        B, S, D, F = 1, 2048, 1024, 3584
        return {
            "x": _w((lambda *s: torch.randn(*s, dtype=torch.bfloat16) * 0.05)(B, S, D)),
            "w_gate": _w((lambda *s: torch.randn(*s, dtype=torch.bfloat16) * 0.05)(D, F)),
            "w_up": _w((lambda *s: torch.randn(*s, dtype=torch.bfloat16) * 0.05)(D, F)),
            "w_down": _w((lambda *s: torch.randn(*s, dtype=torch.bfloat16) * 0.05)(F, D)),
        }
    _B_in = _B_setup()

    return {
        "A_x": _A_in["x"],
        "A_wqkv": _A_in["wqkv"],
        "A_wo": _A_in["wo"],
        "B_x": _B_in["x"],
        "B_w_gate": _B_in["w_gate"],
        "B_w_up": _B_in["w_up"],
        "B_w_down": _B_in["w_down"],
    }

def reference(A_x, A_wqkv, A_wo, B_x, B_w_gate, B_w_up, B_w_down):
    def _A_ref(x, wqkv, wo):
        B, S, D = x.shape
        H = 32; Dh = D // H
        W, dil = 8, 2
        qkv = (lambda x, *d: x.permute(*d))((x @ wqkv).reshape(B, S, 3, H, Dh), 2, 0, 3, 1, 4)
        q, k, v = qkv[0], qkv[1], qkv[2]
        scale = Dh ** -0.5
        pos = torch.arange(S)
        off = torch.arange(W) * dil
        idx = pos[:, None] - off[None, :]
        mask = idx >= 0
        idx_c = torch.where(mask, idx, 0).reshape(-1)
        kg = k[:, :, idx_c, :].reshape(B, H, S, W, Dh)
        vg = v[:, :, idx_c, :].reshape(B, H, S, W, Dh)
        logits = torch.einsum("bhsd,bhswd->bhsw", q, kg) * scale
        logits = torch.where(mask[None, None, :, :], logits, -1e9)
        attn = _softmax(logits, axis=-1)
        o = torch.einsum("bhsw,bhswd->bhsd", attn, vg)
        return (lambda x, *d: x.permute(*d))(o, 0, 2, 1, 3).reshape(B, S, D) @ wo

    def _B_ref(x, w_gate, w_up, w_down):
        return (_gelu(x @ w_gate) * (x @ w_up)) @ w_down

    x = A_x
    h = x + _A_ref(_layernorm(x, axis=-1), A_wqkv, A_wo)
    h2 = h + _B_ref(_layernorm(h, axis=-1), B_w_gate, B_w_up, B_w_down)
    return h2
```

```asm
; @launch grid=(256,1,1) block=(512,1,1) lds=163840
.amdgcn_target "amdgcn-amd-amdhsa--gfx950"
.text
.globl sequential_preLN__sliding_local_dilated__geglu_ffn__prompt_kernel
.p2align 8
.type sequential_preLN__sliding_local_dilated__geglu_ffn__prompt_kernel,@function
sequential_preLN__sliding_local_dilated__geglu_ffn__prompt_kernel:
    s_cmp_ge_u32 s2, 256
    s_cbranch_scc1 Lend_sequential_preLN__sliding_local_dilated__geglu_ffn__prompt_kernel
    s_load_dwordx8 s[52:59], s[0:1], 0
    s_load_dwordx8 s[60:67], s[0:1], 32
    s_load_dwordx4 s[68:71], s[0:1], 64
    s_getpc_b64 s[50:51]
    s_and_b32 s50, s50, 0xffffff00
    s_and_b32 s51, s51, 0xffff
    s_mov_b32 s72, s50
    s_mov_b32 s73, s51
    s_mov_b32 s74, 0xe560
    s_mov_b32 s75, 0x20000
    s_bfe_u32 s79, s2, 0x30003
    s_lshl_b32 s79, s79, 13
    v_lshlrev_b32 v1, 4, v0
    buffer_load_dwordx4 a[88:91], v1, s[72:75], s79 offen
    v_lshrrev_b32 v1, 6, v0
    v_and_b32 v0, 63, v0
    v_readfirstlane_b32 s3, v1
    v_lshlrev_b32 v1, 4, v0
    s_and_b32 s28, s2, 7
    s_lshr_b32 s29, s2, 3
    s_and_b32 s33, s3, 3
    s_and_b32 s31, s28, 1
    s_lshl_b32 s31, s31, 2
    s_and_b32 s32, s29, 3
    s_add_u32 s31, s31, s32
    s_lshl_b32 s31, s31, 1
    s_bfe_u32 s32, s29, 0x10002
    s_add_u32 s31, s31, s32
    s_lshr_b32 s32, s28, 1
    s_lshl_b32 s32, s32, 2
    s_lshr_b32 s34, s29, 3
    s_add_u32 s32, s32, s34
    s_and_b32 s34, s33, 1
    s_lshr_b32 s35, s33, 1
    s_waitcnt lgkmcnt(0)
    s_add_u32 s20, s70, 50331648
    s_addc_u32 s21, s71, 0
    s_and_b32 s21, s21, 0xffff
    s_mov_b32 s22, 1572864
    s_mov_b32 s23, 0x20000
    s_cmp_ge_u32 s3, 4
    s_cbranch_scc1 LLpath_1
    s_mov_b32 s24, s54
    s_and_b32 s25, s55, 0xffff
    s_mov_b32 s26, 6291456
    s_mov_b32 s27, 0x20000
    v_mul_u32_u24 v10, 2731, v0
    v_lshrrev_b32 v10, 16, v10
    v_mul_u32_u24 v11, 24, v10
    v_sub_u32 v11, v0, v11
    v_mul_u32_u24 v12, 6144, v10
    v_lshrrev_b32 v13, 3, v11
    v_lshl_add_u32 v12, v13, 11, v12
    v_and_b32 v13, 7, v11
    v_lshl_add_u32 v12, v13, 4, v12
    v_cmp_gt_u32 vcc, 48, v0
    v_mov_b32 v13, 2147418112
    s_lshl_b32 s41, s32, 7
    v_cndmask_b32 v12, v13, v12, vcc
    s_lshl_b32 s42, s31, 6
    s_lshl_b32 s43, s33, 4
    s_add_u32 s42, s42, s43
    s_mul_i32 s42, s42, 6144
    s_add_u32 s41, s41, s42
    buffer_load_dwordx4 v[48:51], v12, s[24:27], s41 offen
    s_add_u32 s41, s41, 12288
    buffer_load_dwordx4 v[52:55], v12, s[24:27], s41 offen
    s_add_u32 s41, s41, 12288
    buffer_load_dwordx4 v[56:59], v12, s[24:27], s41 offen
    s_add_u32 s41, s41, 12288
    buffer_load_dwordx4 v[60:63], v12, s[24:27], s41 offen
    s_add_u32 s41, s41, 12288
    buffer_load_dwordx4 v[64:67], v12, s[24:27], s41 offen
    s_add_u32 s41, s41, 12288
    buffer_load_dwordx4 v[68:71], v12, s[24:27], s41 offen
    s_add_u32 s41, s41, 12288
    buffer_load_dwordx4 v[72:75], v12, s[24:27], s41 offen
    s_add_u32 s41, s41, 12288
    buffer_load_dwordx4 v[76:79], v12, s[24:27], s41 offen
    s_mov_b32 s24, s52
    s_and_b32 s25, s53, 0xffff
    s_mov_b32 s26, 4194304
    s_mov_b32 s27, 0x20000
    s_and_b32 s40, s28, 1
    s_lshl_b32 s40, s40, 7
    s_lshr_b32 s41, s28, 1
    s_lshl_b32 s41, s41, 5
    s_add_u32 s40, s40, s41
    s_add_u32 s40, s40, s29
    s_lshl_b32 s40, s40, 14
    s_lshl_b32 s41, s33, 12
    s_add_u32 s40, s40, s41
    buffer_load_dwordx4 v[32:35], v1, s[24:27], s40 offen offset:0
    buffer_load_dwordx4 v[36:39], v1, s[24:27], s40 offen offset:1024
    buffer_load_dwordx4 v[40:43], v1, s[24:27], s40 offen offset:2048
    buffer_load_dwordx4 v[44:47], v1, s[24:27], s40 offen offset:3072
    v_mov_b32 v124, v10
    v_mov_b32 v125, v11
    v_lshlrev_b32 v2, 2, v0
    v_add_u32 v2, 163776, v2
    v_mov_b32 v3, 0
    s_mov_b64 exec, 0xffff
    ds_write_b32 v2, v3
    s_mov_b64 exec, -1
    s_waitcnt lgkmcnt(0)
    v_mov_b32 v3, 1
    s_barrier
    v_and_b32 v14, 15, v0
    v_lshrrev_b32 v15, 4, v0
    v_lshrrev_b32 v16, 1, v14
    v_xor_b32 v16, v15, v16
    v_lshlrev_b32 v17, 7, v14
    s_lshl_b32 s40, s34, 11
    s_add_u32 s40, s40, 24576
    v_add_u32 v17, s40, v17
    v_lshl_add_u32 v6, v16, 4, v17
    v_xor_b32 v16, 4, v16
    v_lshl_add_u32 v7, v16, 4, v17
    v_mul_u32_u24 v17, 3072, v15
    v_bfe_u32 v16, v0, 2, 2
    v_lshl_add_u32 v17, v16, 7, v17
    v_and_b32 v16, 3, v0
    v_lshl_add_u32 v17, v16, 3, v17
    v_bfe_u32 v16, v0, 3, 2
    s_lshl_b32 s40, s35, 1
    v_xor_b32 v16, s40, v16
    v_lshl_add_u32 v8, v16, 5, v17
    v_xor_b32 v16, 1, v16
    v_lshl_add_u32 v9, v16, 5, v17
    s_lshl_b32 s40, s34, 2
    s_add_u32 s40, s40, 131136
    v_lshl_add_u32 v18, v14, 3, s40
    v_lshl_add_u32 v19, v15, 5, s40
    v_lshlrev_b32 v20, 2, v14
    v_add_u32 v20, 131072, v20
    v_lshlrev_b32 v21, 4, v15
    v_add_u32 v21, 131072, v21
    s_lshl_b32 s41, s35, 7
    v_add_u32 v22, s41, v21
    v_add_u32 v10, s41, v20
    v_lshlrev_b32 v11, 2, v15
    v_sub_u32 v12, v14, v11
    s_and_b32 s76, s28, 3
    s_lshl_b32 s76, s76, 2
    s_and_b32 s77, s29, 3
    s_add_u32 s76, s76, s77
    s_lshr_b32 s77, s28, 2
    s_lshl_b32 s77, s77, 3
    s_lshr_b32 s78, s29, 2
    s_add_u32 s77, s77, s78
    s_mov_b32 s17, 1
    s_lshl_b32 s16, s76, 13
    s_lshl_b32 s40, s33, 11
    s_add_u32 s16, s16, s40
    s_lshl_b32 s18, s76, 11
    s_lshl_b32 s40, s77, 7
    s_add_u32 s18, s18, s40
    s_add_u32 s18, s18, 1310720
    s_lshl_b32 s19, s76, 18
    s_lshl_b32 s40, s33, 16
    s_add_u32 s19, s19, s40
    s_lshl_b32 s40, s77, 7
    s_add_u32 s19, s19, s40
    s_add_u32 s19, s19, 2048
    v_subrev_u32 v13, 0, v12
    v_cmp_ge_i32 s[72:73], -9, v13
    v_cmp_gt_u32 s[80:81], 8, v13
    v_lshl_add_u32 v13, v15, 1, 0
    v_cmp_gt_u32 s[4:5], v13, v14
    v_subrev_u32 v13, 1, v12
    v_cmp_ge_i32 s[74:75], -9, v13
    v_cmp_gt_u32 s[82:83], 8, v13
    v_lshl_add_u32 v13, v15, 1, 0
    v_cmp_gt_u32 s[6:7], v13, v14
    v_subrev_u32 v13, 2, v12
    v_cmp_ge_i32 s[76:77], -9, v13
    v_cmp_gt_u32 s[84:85], 8, v13
    v_lshl_add_u32 v13, v15, 1, 1
    v_cmp_gt_u32 s[8:9], v13, v14
    v_subrev_u32 v13, 3, v12
    v_cmp_ge_i32 s[78:79], -9, v13
    v_cmp_gt_u32 s[86:87], 8, v13
    v_lshl_add_u32 v13, v15, 1, 1
    v_cmp_gt_u32 s[10:11], v13, v14
    s_cmp_eq_u32 s31, 0
    s_cselect_b32 s88, 0, -1
    s_cmp_eq_u32 s34, 0
    s_cselect_b32 s89, s88, 0
    s_cselect_b32 s90, 0, s88
    s_and_b32 s4, s4, s89
    s_and_b32 s5, s5, s89
    s_and_b32 s6, s6, s90
    s_and_b32 s7, s7, s90
    s_and_b32 s8, s8, s89
    s_and_b32 s9, s9, s89
    s_and_b32 s10, s10, s90
    s_and_b32 s11, s11, s90
    s_add_u32 s12, s70, 4194304
    s_addc_u32 s13, s71, 0
    s_and_b32 s13, s13, 0xffff
    s_mov_b32 s14, 4194304
    s_mov_b32 s15, 0x20000
    s_mov_b32 s91, 1048744942
    s_lshl_b32 s44, s32, 1
    s_add_u32 s44, s44, s35
    s_lshl_b32 s44, s44, 17
    s_lshl_b32 s45, s31, 13
    s_add_u32 s44, s44, s45
    s_lshl_b32 s45, s34, 10
    s_add_u32 s44, s44, s45
    s_add_u32 s45, s44, 4096
    s_waitcnt vmcnt(0)
    v_lshlrev_b32 v128, 16, v48
    v_and_b32 v129, 0xffff0000, v48
    v_lshlrev_b32 v130, 16, v49
    v_and_b32 v131, 0xffff0000, v49
    v_lshlrev_b32 v132, 16, v50
    v_and_b32 v133, 0xffff0000, v50
    v_lshlrev_b32 v134, 16, v51
    v_and_b32 v135, 0xffff0000, v51
    v_lshlrev_b32 v140, 16, v52
    v_and_b32 v141, 0xffff0000, v52
    v_lshlrev_b32 v142, 16, v53
    v_and_b32 v143, 0xffff0000, v53
    v_lshlrev_b32 v144, 16, v54
    v_and_b32 v145, 0xffff0000, v54
    v_lshlrev_b32 v146, 16, v55
    v_and_b32 v147, 0xffff0000, v55
    v_pk_add_f32 v[128:129], v[128:129], v[140:141]
    v_pk_add_f32 v[130:131], v[130:131], v[142:143]
    v_pk_add_f32 v[132:133], v[132:133], v[144:145]
    v_pk_add_f32 v[134:135], v[134:135], v[146:147]
    v_lshlrev_b32 v140, 16, v56
    v_and_b32 v141, 0xffff0000, v56
    v_lshlrev_b32 v142, 16, v57
    v_and_b32 v143, 0xffff0000, v57
    v_lshlrev_b32 v144, 16, v58
    v_and_b32 v145, 0xffff0000, v58
    v_lshlrev_b32 v146, 16, v59
    v_and_b32 v147, 0xffff0000, v59
    v_pk_add_f32 v[128:129], v[128:129], v[140:141]
    v_pk_add_f32 v[130:131], v[130:131], v[142:143]
    v_pk_add_f32 v[132:133], v[132:133], v[144:145]
    v_pk_add_f32 v[134:135], v[134:135], v[146:147]
    v_lshlrev_b32 v140, 16, v60
    v_and_b32 v141, 0xffff0000, v60
    v_lshlrev_b32 v142, 16, v61
    v_and_b32 v143, 0xffff0000, v61
    v_lshlrev_b32 v144, 16, v62
    v_and_b32 v145, 0xffff0000, v62
    v_lshlrev_b32 v146, 16, v63
    v_and_b32 v147, 0xffff0000, v63
    v_pk_add_f32 v[128:129], v[128:129], v[140:141]
    v_pk_add_f32 v[130:131], v[130:131], v[142:143]
    v_pk_add_f32 v[132:133], v[132:133], v[144:145]
    v_pk_add_f32 v[134:135], v[134:135], v[146:147]
    v_lshlrev_b32 v140, 16, v64
    v_and_b32 v141, 0xffff0000, v64
    v_lshlrev_b32 v142, 16, v65
    v_and_b32 v143, 0xffff0000, v65
    v_lshlrev_b32 v144, 16, v66
    v_and_b32 v145, 0xffff0000, v66
    v_lshlrev_b32 v146, 16, v67
    v_and_b32 v147, 0xffff0000, v67
    v_pk_add_f32 v[128:129], v[128:129], v[140:141]
    v_pk_add_f32 v[130:131], v[130:131], v[142:143]
    v_pk_add_f32 v[132:133], v[132:133], v[144:145]
    v_pk_add_f32 v[134:135], v[134:135], v[146:147]
    v_lshlrev_b32 v140, 16, v68
    v_and_b32 v141, 0xffff0000, v68
    v_lshlrev_b32 v142, 16, v69
    v_and_b32 v143, 0xffff0000, v69
    v_lshlrev_b32 v144, 16, v70
    v_and_b32 v145, 0xffff0000, v70
    v_lshlrev_b32 v146, 16, v71
    v_and_b32 v147, 0xffff0000, v71
    v_pk_add_f32 v[128:129], v[128:129], v[140:141]
    v_pk_add_f32 v[130:131], v[130:131], v[142:143]
    v_pk_add_f32 v[132:133], v[132:133], v[144:145]
    v_pk_add_f32 v[134:135], v[134:135], v[146:147]
    v_lshlrev_b32 v140, 16, v72
    v_and_b32 v141, 0xffff0000, v72
    v_lshlrev_b32 v142, 16, v73
    v_and_b32 v143, 0xffff0000, v73
    v_lshlrev_b32 v144, 16, v74
    v_and_b32 v145, 0xffff0000, v74
    v_lshlrev_b32 v146, 16, v75
    v_and_b32 v147, 0xffff0000, v75
    v_pk_add_f32 v[128:129], v[128:129], v[140:141]
    v_pk_add_f32 v[130:131], v[130:131], v[142:143]
    v_pk_add_f32 v[132:133], v[132:133], v[144:145]
    v_pk_add_f32 v[134:135], v[134:135], v[146:147]
    v_lshlrev_b32 v140, 16, v76
    v_and_b32 v141, 0xffff0000, v76
    v_lshlrev_b32 v142, 16, v77
    v_and_b32 v143, 0xffff0000, v77
    v_lshlrev_b32 v144, 16, v78
    v_and_b32 v145, 0xffff0000, v78
    v_lshlrev_b32 v146, 16, v79
    v_and_b32 v147, 0xffff0000, v79
    v_pk_add_f32 v[128:129], v[128:129], v[140:141]
    v_pk_add_f32 v[130:131], v[130:131], v[142:143]
    v_pk_add_f32 v[132:133], v[132:133], v[144:145]
    v_pk_add_f32 v[134:135], v[134:135], v[146:147]
    s_lshl_b32 s40, s33, 1
    v_add_u32 v126, s40, v124
    v_cmp_gt_u32 vcc, 48, v0
    v_mov_b32 v127, 9
    s_nop 0
    v_cndmask_b32 v126, v127, v126, vcc
    v_mul_u32_u24 v126, 768, v126
    v_lshl_add_u32 v126, v125, 5, v126
    v_add_u32 v126, 147456, v126
    ds_write_b128 v126, v[128:131]
    ds_write_b128 v126, v[132:135] offset:16
    v_lshlrev_b32 v80, 16, v32
    v_and_b32 v81, 0xffff0000, v32
    v_lshlrev_b32 v82, 16, v33
    v_and_b32 v83, 0xffff0000, v33
    v_lshlrev_b32 v84, 16, v34
    v_and_b32 v85, 0xffff0000, v34
    v_lshlrev_b32 v86, 16, v35
    v_and_b32 v87, 0xffff0000, v35
    v_lshlrev_b32 v88, 16, v36
    v_and_b32 v89, 0xffff0000, v36
    v_lshlrev_b32 v90, 16, v37
    v_and_b32 v91, 0xffff0000, v37
    v_lshlrev_b32 v92, 16, v38
    v_and_b32 v93, 0xffff0000, v38
    v_lshlrev_b32 v94, 16, v39
    v_and_b32 v95, 0xffff0000, v39
    v_lshlrev_b32 v96, 16, v40
    v_and_b32 v97, 0xffff0000, v40
    v_lshlrev_b32 v98, 16, v41
    v_and_b32 v99, 0xffff0000, v41
    v_lshlrev_b32 v100, 16, v42
    v_and_b32 v101, 0xffff0000, v42
    v_lshlrev_b32 v102, 16, v43
    v_and_b32 v103, 0xffff0000, v43
    v_lshlrev_b32 v104, 16, v44
    v_and_b32 v105, 0xffff0000, v44
    v_lshlrev_b32 v106, 16, v45
    v_and_b32 v107, 0xffff0000, v45
    v_lshlrev_b32 v108, 16, v46
    v_and_b32 v109, 0xffff0000, v46
    v_lshlrev_b32 v110, 16, v47
    v_and_b32 v111, 0xffff0000, v47
    v_add_f32 v112, v80, v81
    v_add_f32 v112, v112, v82
    v_add_f32 v112, v112, v83
    v_add_f32 v112, v112, v84
    v_add_f32 v112, v112, v85
    v_add_f32 v112, v112, v86
    v_add_f32 v112, v112, v87
    v_add_f32 v112, v112, v88
    v_add_f32 v112, v112, v89
    v_add_f32 v112, v112, v90
    v_add_f32 v112, v112, v91
    v_add_f32 v112, v112, v92
    v_add_f32 v112, v112, v93
    v_add_f32 v112, v112, v94
    v_add_f32 v112, v112, v95
    v_add_f32 v113, v96, v97
    v_add_f32 v113, v113, v98
    v_add_f32 v113, v113, v99
    v_add_f32 v113, v113, v100
    v_add_f32 v113, v113, v101
    v_add_f32 v113, v113, v102
    v_add_f32 v113, v113, v103
    v_add_f32 v113, v113, v104
    v_add_f32 v113, v113, v105
    v_add_f32 v113, v113, v106
    v_add_f32 v113, v113, v107
    v_add_f32 v113, v113, v108
    v_add_f32 v113, v113, v109
    v_add_f32 v113, v113, v110
    v_add_f32 v113, v113, v111
    s_nop 0
    s_nop 0
    v_add_f32_dpp v112, v112, v112 quad_perm:[1,0,3,2] row_mask:0xf bank_mask:0xf
    v_add_f32_dpp v113, v113, v113 quad_perm:[1,0,3,2] row_mask:0xf bank_mask:0xf
    s_nop 0
    v_add_f32_dpp v112, v112, v112 quad_perm:[2,3,0,1] row_mask:0xf bank_mask:0xf
    v_add_f32_dpp v113, v113, v113 quad_perm:[2,3,0,1] row_mask:0xf bank_mask:0xf
    s_nop 0
    v_add_f32_dpp v112, v112, v112 row_half_mirror row_mask:0xf bank_mask:0xf
    v_add_f32_dpp v113, v113, v113 row_half_mirror row_mask:0xf bank_mask:0xf
    s_nop 0
    v_add_f32_dpp v112, v112, v112 row_mirror row_mask:0xf bank_mask:0xf
    v_add_f32_dpp v113, v113, v113 row_mirror row_mask:0xf bank_mask:0xf
    v_mov_b32 v118, v112
    v_mov_b32 v119, v113
    s_nop 1
    v_permlane16_swap_b32 v112, v118
    v_permlane16_swap_b32 v113, v119
    s_nop 1
    v_add_f32 v112, v112, v118
    v_add_f32 v113, v113, v119
    v_mov_b32 v118, v112
    v_mov_b32 v119, v113
    s_nop 1
    v_permlane32_swap_b32 v112, v118
    v_permlane32_swap_b32 v113, v119
    s_nop 1
    v_add_f32 v112, v112, v118
    v_add_f32 v113, v113, v119
    v_mul_f32 v112, 981467136, v112
    v_sub_f32 v80, v80, v112
    v_sub_f32 v81, v81, v112
    v_sub_f32 v82, v82, v112
    v_sub_f32 v83, v83, v112
    v_sub_f32 v84, v84, v112
    v_sub_f32 v85, v85, v112
    v_sub_f32 v86, v86, v112
    v_sub_f32 v87, v87, v112
    v_sub_f32 v88, v88, v112
    v_sub_f32 v89, v89, v112
    v_sub_f32 v90, v90, v112
    v_sub_f32 v91, v91, v112
    v_sub_f32 v92, v92, v112
    v_sub_f32 v93, v93, v112
    v_sub_f32 v94, v94, v112
    v_sub_f32 v95, v95, v112
    v_mul_f32 v114, v80, v80
    v_fmac_f32 v114, v81, v81
    v_fmac_f32 v114, v82, v82
    v_fmac_f32 v114, v83, v83
    v_fmac_f32 v114, v84, v84
    v_fmac_f32 v114, v85, v85
    v_fmac_f32 v114, v86, v86
    v_fmac_f32 v114, v87, v87
    v_fmac_f32 v114, v88, v88
    v_fmac_f32 v114, v89, v89
    v_fmac_f32 v114, v90, v90
    v_fmac_f32 v114, v91, v91
    v_fmac_f32 v114, v92, v92
    v_fmac_f32 v114, v93, v93
    v_fmac_f32 v114, v94, v94
    v_fmac_f32 v114, v95, v95
    v_mul_f32 v113, 981467136, v113
    v_sub_f32 v96, v96, v113
    v_sub_f32 v97, v97, v113
    v_sub_f32 v98, v98, v113
    v_sub_f32 v99, v99, v113
    v_sub_f32 v100, v100, v113
    v_sub_f32 v101, v101, v113
    v_sub_f32 v102, v102, v113
    v_sub_f32 v103, v103, v113
    v_sub_f32 v104, v104, v113
    v_sub_f32 v105, v105, v113
    v_sub_f32 v106, v106, v113
    v_sub_f32 v107, v107, v113
    v_sub_f32 v108, v108, v113
    v_sub_f32 v109, v109, v113
    v_sub_f32 v110, v110, v113
    v_sub_f32 v111, v111, v113
    v_mul_f32 v115, v96, v96
    v_fmac_f32 v115, v97, v97
    v_fmac_f32 v115, v98, v98
    v_fmac_f32 v115, v99, v99
    v_fmac_f32 v115, v100, v100
    v_fmac_f32 v115, v101, v101
    v_fmac_f32 v115, v102, v102
    v_fmac_f32 v115, v103, v103
    v_fmac_f32 v115, v104, v104
    v_fmac_f32 v115, v105, v105
    v_fmac_f32 v115, v106, v106
    v_fmac_f32 v115, v107, v107
    v_fmac_f32 v115, v108, v108
    v_fmac_f32 v115, v109, v109
    v_fmac_f32 v115, v110, v110
    v_fmac_f32 v115, v111, v111
    s_nop 0
    s_nop 0
    v_add_f32_dpp v114, v114, v114 quad_perm:[1,0,3,2] row_mask:0xf bank_mask:0xf
    v_add_f32_dpp v115, v115, v115 quad_perm:[1,0,3,2] row_mask:0xf bank_mask:0xf
    s_nop 0
    v_add_f32_dpp v114, v114, v114 quad_perm:[2,3,0,1] row_mask:0xf bank_mask:0xf
    v_add_f32_dpp v115, v115, v115 quad_perm:[2,3,0,1] row_mask:0xf bank_mask:0xf
    s_nop 0
    v_add_f32_dpp v114, v114, v114 row_half_mirror row_mask:0xf bank_mask:0xf
    v_add_f32_dpp v115, v115, v115 row_half_mirror row_mask:0xf bank_mask:0xf
    s_nop 0
    v_add_f32_dpp v114, v114, v114 row_mirror row_mask:0xf bank_mask:0xf
    v_add_f32_dpp v115, v115, v115 row_mirror row_mask:0xf bank_mask:0xf
    v_mov_b32 v118, v114
    v_mov_b32 v119, v115
    s_nop 1
    v_permlane16_swap_b32 v114, v118
    v_permlane16_swap_b32 v115, v119
    s_nop 1
    v_add_f32 v114, v114, v118
    v_add_f32 v115, v115, v119
    v_mov_b32 v118, v114
    v_mov_b32 v119, v115
    s_nop 1
    v_permlane32_swap_b32 v114, v118
    v_permlane32_swap_b32 v115, v119
    s_nop 1
    v_add_f32 v114, v114, v118
    v_add_f32 v115, v115, v119
    v_mov_b32 v118, 925353388
    v_fmac_f32 v118, 981467136, v114
    v_rsq_f32 v136, v118
    v_sub_f32 v137, 0, v112
    v_mov_b32 v118, 925353388
    v_fmac_f32 v118, 981467136, v115
    v_rsq_f32 v138, v118
    v_sub_f32 v139, 0, v113
    s_lshl_b32 s40, s33, 4
    s_add_u32 s40, s40, 155648
    v_mov_b32 v126, s40
    ds_write_b128 v126, v[136:139]
    s_lshl_b32 s43, s31, 11
    s_add_u32 s43, s43, 1310720
    v_add_u32 v13, 1024, v19
    s_cmp_eq_u32 s34, 1
    s_cbranch_scc1 Lp1v_137
    s_mov_b32 s36, 0
    s_mov_b32 s46, 43008
    s_mov_b32 s47, 4294881280
    s_waitcnt lgkmcnt(0)
    s_barrier
    ds_read_b128 a[0:3], v6 offset:0
    ds_read_b128 a[44:47], v7 offset:0
    ds_read_b64_tr_b16 a[20:21], v8 offset:0
    ds_read_b64_tr_b16 a[22:23], v8 offset:512
    ds_read_b64_tr_b16 a[64:65], v8 offset:12288
    ds_read_b64_tr_b16 a[66:67], v8 offset:12800
    ds_read_b64_tr_b16 a[24:25], v9 offset:0
    ds_read_b64_tr_b16 a[26:27], v9 offset:512
    ds_read_b64_tr_b16 a[68:69], v9 offset:12288
    ds_read_b64_tr_b16 a[70:71], v9 offset:12800
    ds_read_b128 a[4:7], v6 offset:4096
    ds_read_b128 a[48:51], v7 offset:4096
    ds_read_b128 a[8:11], v6 offset:8192
    ds_read_b128 a[52:55], v7 offset:8192
    s_add_u32 s36, s36, 43008
    s_cmp_ge_u32 s36, 129024
    s_cselect_b32 s37, s47, s46
    s_cselect_b32 s36, 0, s36
    s_waitcnt lgkmcnt(10)
    v_mfma_f32_16x16x32_bf16 v[24:27], a[20:23], a[0:3], 0
    ds_read_b128 a[12:15], v6 offset:12288
    ds_read_b128 a[56:59], v7 offset:12288
    s_waitcnt lgkmcnt(10)
    v_mfma_f32_16x16x32_bf16 v[24:27], a[64:67], a[44:47], v[24:27]
    ds_read_b64_tr_b16 a[28:29], v8 offset:1024
    ds_read_b64_tr_b16 a[30:31], v8 offset:1536
    s_waitcnt lgkmcnt(10)
    v_mfma_f32_16x16x32_bf16 v[28:31], a[24:27], a[0:3], 0
    ds_read_b64_tr_b16 a[72:73], v8 offset:13312
    ds_read_b64_tr_b16 a[74:75], v8 offset:13824
    s_waitcnt lgkmcnt(10)
    v_mfma_f32_16x16x32_bf16 v[28:31], a[68:71], a[44:47], v[28:31]
    ds_read_b128 a[16:19], v6 offset:16384
    ds_read_b128 a[60:63], v7 offset:16384
    s_waitcnt lgkmcnt(11)
    v_mfma_f32_16x16x32_bf16 v[36:39], a[24:27], a[4:7], 0
    ds_read_b64_tr_b16 a[32:33], v9 offset:1024
    ds_read_b64_tr_b16 a[34:35], v9 offset:1536
    s_waitcnt lgkmcnt(12)
    v_mfma_f32_16x16x32_bf16 v[36:39], a[68:71], a[48:51], v[36:39]
    ds_read_b64_tr_b16 a[76:77], v9 offset:13312
    ds_read_b64_tr_b16 a[78:79], v9 offset:13824
    v_mfma_f32_16x16x32_bf16 v[32:35], a[20:23], a[4:7], 0
    ds_read_b64_tr_b16 a[36:37], v8 offset:2048
    ds_read_b64_tr_b16 a[38:39], v8 offset:2560
    v_mfma_f32_16x16x32_bf16 v[32:35], a[64:67], a[48:51], v[32:35]
    ds_read_b64_tr_b16 a[80:81], v8 offset:14336
    ds_read_b64_tr_b16 a[82:83], v8 offset:14848
    s_waitcnt lgkmcnt(14)
    v_mfma_f32_16x16x32_bf16 v[40:43], a[20:23], a[8:11], 0
    ds_read_b64_tr_b16 a[40:41], v9 offset:2048
    ds_read_b64_tr_b16 a[42:43], v9 offset:2560
    v_mfma_f32_16x16x32_bf16 v[40:43], a[64:67], a[52:55], v[40:43]
    ds_read_b64_tr_b16 a[84:85], v9 offset:14336
    ds_read_b64_tr_b16 a[86:87], v9 offset:14848
    v_mfma_f32_16x16x32_bf16 v[44:47], a[24:27], a[8:11], 0
    v_mfma_f32_16x16x32_bf16 v[44:47], a[68:71], a[52:55], v[44:47]
    v_add_u32 v6, s37, v6
    v_mfma_f32_16x16x32_bf16 v[52:55], a[24:27], a[12:15], 0
    v_add_u32 v7, s37, v7
    v_mfma_f32_16x16x32_bf16 v[52:55], a[68:71], a[56:59], v[52:55]
    v_add_u32 v8, s37, v8
    v_mfma_f32_16x16x32_bf16 v[48:51], a[20:23], a[12:15], 0
    v_add_u32 v9, s37, v9
    v_mfma_f32_16x16x32_bf16 v[48:51], a[64:67], a[56:59], v[48:51]
    s_waitcnt lgkmcnt(0)
    s_barrier
    v_mfma_f32_16x16x32_bf16 v[80:83], a[28:31], a[12:15], 0
    ds_read_b64_tr_b16 a[24:25], v9 offset:0
    v_mfma_f32_16x16x32_bf16 v[80:83], a[72:75], a[56:59], v[80:83]
    ds_read_b64_tr_b16 a[26:27], v9 offset:512
    v_mfma_f32_16x16x32_bf16 v[72:75], a[28:31], a[8:11], 0
    ds_read_b64_tr_b16 a[68:69], v9 offset:12288
    v_mfma_f32_16x16x32_bf16 v[72:75], a[72:75], a[52:55], v[72:75]
    ds_read_b64_tr_b16 a[70:71], v9 offset:12800
    v_mfma_f32_16x16x32_bf16 v[64:67], a[28:31], a[4:7], 0
    ds_read_b64_tr_b16 a[20:21], v8 offset:0
    v_mfma_f32_16x16x32_bf16 v[64:67], a[72:75], a[48:51], v[64:67]
    ds_read_b64_tr_b16 a[22:23], v8 offset:512
    v_mfma_f32_16x16x32_bf16 v[56:59], a[28:31], a[0:3], 0
    ds_read_b64_tr_b16 a[64:65], v8 offset:12288
    v_mfma_f32_16x16x32_bf16 v[56:59], a[72:75], a[44:47], v[56:59]
    ds_read_b64_tr_b16 a[66:67], v8 offset:12800
    v_mfma_f32_16x16x32_bf16 v[120:123], a[28:31], a[16:19], 0
    ds_read_b64_tr_b16 a[28:29], v8 offset:1024
    v_mfma_f32_16x16x32_bf16 v[120:123], a[72:75], a[60:63], v[120:123]
    ds_read_b64_tr_b16 a[30:31], v8 offset:1536
    v_mfma_f32_16x16x32_bf16 v[124:127], a[32:35], a[16:19], 0
    ds_read_b64_tr_b16 a[72:73], v8 offset:13312
    v_mfma_f32_16x16x32_bf16 v[124:127], a[76:79], a[60:63], v[124:127]
    ds_read_b64_tr_b16 a[74:75], v8 offset:13824
    v_mfma_f32_16x16x32_bf16 v[84:87], a[32:35], a[12:15], 0
    ds_read_b128 a[16:19], v6 offset:16384
    v_mfma_f32_16x16x32_bf16 v[84:87], a[76:79], a[56:59], v[84:87]
    ds_read_b128 a[60:63], v7 offset:16384
    v_mfma_f32_16x16x32_bf16 v[76:79], a[32:35], a[8:11], 0
    s_add_u32 s36, s36, 43008
    v_mfma_f32_16x16x32_bf16 v[76:79], a[76:79], a[52:55], v[76:79]
    s_cmp_ge_u32 s36, 129024
    v_mfma_f32_16x16x32_bf16 v[68:71], a[32:35], a[4:7], 0
    s_cselect_b32 s37, s47, s46
    v_mfma_f32_16x16x32_bf16 v[68:71], a[76:79], a[48:51], v[68:71]
    s_cselect_b32 s36, 0, s36
    v_mfma_f32_16x16x32_bf16 v[60:63], a[32:35], a[0:3], 0
    ds_read_b64_tr_b16 a[32:33], v9 offset:1024
    v_mfma_f32_16x16x32_bf16 v[60:63], a[76:79], a[44:47], v[60:63]
    ds_read_b64_tr_b16 a[34:35], v9 offset:1536
    v_mfma_f32_16x16x32_bf16 v[88:91], a[0:3], a[36:39], 0
    ds_read_b64_tr_b16 a[76:77], v9 offset:13312
    v_mfma_f32_16x16x32_bf16 v[88:91], a[44:47], a[80:83], v[88:91]
    ds_read_b64_tr_b16 a[78:79], v9 offset:13824
    v_mfma_f32_16x16x32_bf16 v[92:95], a[0:3], a[40:43], 0
    ds_read_b128 a[0:3], v6 offset:0
    v_mfma_f32_16x16x32_bf16 v[92:95], a[44:47], a[84:87], v[92:95]
    ds_read_b128 a[44:47], v7 offset:0
    v_mfma_f32_16x16x32_bf16 v[100:103], a[4:7], a[40:43], 0
    v_mfma_f32_16x16x32_bf16 v[100:103], a[48:51], a[84:87], v[100:103]
    v_mfma_f32_16x16x32_bf16 v[96:99], a[4:7], a[36:39], 0
    ds_read_b128 a[4:7], v6 offset:4096
    v_mfma_f32_16x16x32_bf16 v[96:99], a[48:51], a[80:83], v[96:99]
    ds_read_b128 a[48:51], v7 offset:4096
    v_mfma_f32_16x16x32_bf16 v[104:107], a[8:11], a[36:39], 0
    v_mfma_f32_16x16x32_bf16 v[104:107], a[52:55], a[80:83], v[104:107]
    v_mfma_f32_16x16x32_bf16 v[108:111], a[8:11], a[40:43], 0
    ds_read_b128 a[8:11], v6 offset:8192
    v_mfma_f32_16x16x32_bf16 v[108:111], a[52:55], a[84:87], v[108:111]
    ds_read_b128 a[52:55], v7 offset:8192
    v_mfma_f32_16x16x32_bf16 v[116:119], a[12:15], a[40:43], 0
    ds_read_b64_tr_b16 a[40:41], v9 offset:2048
    v_mfma_f32_16x16x32_bf16 v[116:119], a[56:59], a[84:87], v[116:119]
    ds_read_b64_tr_b16 a[42:43], v9 offset:2560
    v_mfma_f32_16x16x32_bf16 v[112:115], a[12:15], a[36:39], 0
    ds_read_b128 a[12:15], v6 offset:12288
    v_mfma_f32_16x16x32_bf16 v[112:115], a[56:59], a[80:83], v[112:115]
    ds_read_b128 a[56:59], v7 offset:12288
    s_waitcnt lgkmcnt(8)
    v_mfma_f32_16x16x32_bf16 v[24:27], a[20:23], a[0:3], v[24:27]
    ds_read_b64_tr_b16 a[84:85], v9 offset:14336
    v_mfma_f32_16x16x32_bf16 v[24:27], a[64:67], a[44:47], v[24:27]
    ds_read_b64_tr_b16 a[86:87], v9 offset:14848
    v_mfma_f32_16x16x32_bf16 v[28:31], a[24:27], a[0:3], v[28:31]
    ds_read_b64_tr_b16 a[36:37], v8 offset:2048
    v_mfma_f32_16x16x32_bf16 v[28:31], a[68:71], a[44:47], v[28:31]
    ds_read_b64_tr_b16 a[38:39], v8 offset:2560
    s_waitcnt lgkmcnt(10)
    v_mfma_f32_16x16x32_bf16 v[36:39], a[24:27], a[4:7], v[36:39]
    ds_read_b64_tr_b16 a[80:81], v8 offset:14336
    v_mfma_f32_16x16x32_bf16 v[36:39], a[68:71], a[48:51], v[36:39]
    ds_read_b64_tr_b16 a[82:83], v8 offset:14848
    v_mfma_f32_16x16x32_bf16 v[32:35], a[20:23], a[4:7], v[32:35]
    v_add_u32 v6, s37, v6
    v_mfma_f32_16x16x32_bf16 v[32:35], a[64:67], a[48:51], v[32:35]
    v_add_u32 v7, s37, v7
    s_waitcnt lgkmcnt(10)
    v_mfma_f32_16x16x32_bf16 v[40:43], a[20:23], a[8:11], v[40:43]
    v_mfma_f32_16x16x32_bf16 v[40:43], a[64:67], a[52:55], v[40:43]
    v_add_u32 v8, s37, v8
    v_mfma_f32_16x16x32_bf16 v[44:47], a[24:27], a[8:11], v[44:47]
    v_add_u32 v9, s37, v9
    v_mfma_f32_16x16x32_bf16 v[44:47], a[68:71], a[52:55], v[44:47]
    s_waitcnt lgkmcnt(6)
    v_mfma_f32_16x16x32_bf16 v[52:55], a[24:27], a[12:15], v[52:55]
    v_mfma_f32_16x16x32_bf16 v[52:55], a[68:71], a[56:59], v[52:55]
    v_mfma_f32_16x16x32_bf16 v[48:51], a[20:23], a[12:15], v[48:51]
    v_mfma_f32_16x16x32_bf16 v[48:51], a[64:67], a[56:59], v[48:51]
    s_mov_b32 s38, 13
Lcloop_139:
    s_waitcnt lgkmcnt(0)
    s_barrier
    v_mfma_f32_16x16x32_bf16 v[80:83], a[28:31], a[12:15], v[80:83]
    ds_read_b64_tr_b16 a[24:25], v9 offset:0
    v_mfma_f32_16x16x32_bf16 v[80:83], a[72:75], a[56:59], v[80:83]
    ds_read_b64_tr_b16 a[26:27], v9 offset:512
    v_mfma_f32_16x16x32_bf16 v[72:75], a[28:31], a[8:11], v[72:75]
    ds_read_b64_tr_b16 a[68:69], v9 offset:12288
    v_mfma_f32_16x16x32_bf16 v[72:75], a[72:75], a[52:55], v[72:75]
    ds_read_b64_tr_b16 a[70:71], v9 offset:12800
    v_mfma_f32_16x16x32_bf16 v[64:67], a[28:31], a[4:7], v[64:67]
    ds_read_b64_tr_b16 a[20:21], v8 offset:0
    v_mfma_f32_16x16x32_bf16 v[64:67], a[72:75], a[48:51], v[64:67]
    ds_read_b64_tr_b16 a[22:23], v8 offset:512
    v_mfma_f32_16x16x32_bf16 v[56:59], a[28:31], a[0:3], v[56:59]
    ds_read_b64_tr_b16 a[64:65], v8 offset:12288
    v_mfma_f32_16x16x32_bf16 v[56:59], a[72:75], a[44:47], v[56:59]
    ds_read_b64_tr_b16 a[66:67], v8 offset:12800
    v_mfma_f32_16x16x32_bf16 v[120:123], a[28:31], a[16:19], v[120:123]
    ds_read_b64_tr_b16 a[28:29], v8 offset:1024
    v_mfma_f32_16x16x32_bf16 v[120:123], a[72:75], a[60:63], v[120:123]
    ds_read_b64_tr_b16 a[30:31], v8 offset:1536
    v_mfma_f32_16x16x32_bf16 v[124:127], a[32:35], a[16:19], v[124:127]
    ds_read_b64_tr_b16 a[72:73], v8 offset:13312
    v_mfma_f32_16x16x32_bf16 v[124:127], a[76:79], a[60:63], v[124:127]
    ds_read_b64_tr_b16 a[74:75], v8 offset:13824
    v_mfma_f32_16x16x32_bf16 v[84:87], a[32:35], a[12:15], v[84:87]
    ds_read_b128 a[16:19], v6 offset:16384
    v_mfma_f32_16x16x32_bf16 v[84:87], a[76:79], a[56:59], v[84:87]
    ds_read_b128 a[60:63], v7 offset:16384
    v_mfma_f32_16x16x32_bf16 v[76:79], a[32:35], a[8:11], v[76:79]
    s_add_u32 s36, s36, 43008
    v_mfma_f32_16x16x32_bf16 v[76:79], a[76:79], a[52:55], v[76:79]
    s_cmp_ge_u32 s36, 129024
    v_mfma_f32_16x16x32_bf16 v[68:71], a[32:35], a[4:7], v[68:71]
    s_cselect_b32 s37, s47, s46
    v_mfma_f32_16x16x32_bf16 v[68:71], a[76:79], a[48:51], v[68:71]
    s_cselect_b32 s36, 0, s36
    v_mfma_f32_16x16x32_bf16 v[60:63], a[32:35], a[0:3], v[60:63]
    ds_read_b64_tr_b16 a[32:33], v9 offset:1024
    v_mfma_f32_16x16x32_bf16 v[60:63], a[76:79], a[44:47], v[60:63]
    ds_read_b64_tr_b16 a[34:35], v9 offset:1536
    v_mfma_f32_16x16x32_bf16 v[88:91], a[0:3], a[36:39], v[88:91]
    ds_read_b64_tr_b16 a[76:77], v9 offset:13312
    v_mfma_f32_16x16x32_bf16 v[88:91], a[44:47], a[80:83], v[88:91]
    ds_read_b64_tr_b16 a[78:79], v9 offset:13824
    v_mfma_f32_16x16x32_bf16 v[92:95], a[0:3], a[40:43], v[92:95]
    ds_read_b128 a[0:3], v6 offset:0
    v_mfma_f32_16x16x32_bf16 v[92:95], a[44:47], a[84:87], v[92:95]
    ds_read_b128 a[44:47], v7 offset:0
    v_mfma_f32_16x16x32_bf16 v[100:103], a[4:7], a[40:43], v[100:103]
    v_mfma_f32_16x16x32_bf16 v[100:103], a[48:51], a[84:87], v[100:103]
    v_mfma_f32_16x16x32_bf16 v[96:99], a[4:7], a[36:39], v[96:99]
    ds_read_b128 a[4:7], v6 offset:4096
    v_mfma_f32_16x16x32_bf16 v[96:99], a[48:51], a[80:83], v[96:99]
    ds_read_b128 a[48:51], v7 offset:4096
    v_mfma_f32_16x16x32_bf16 v[104:107], a[8:11], a[36:39], v[104:107]
    v_mfma_f32_16x16x32_bf16 v[104:107], a[52:55], a[80:83], v[104:107]
    v_mfma_f32_16x16x32_bf16 v[108:111], a[8:11], a[40:43], v[108:111]
    ds_read_b128 a[8:11], v6 offset:8192
    v_mfma_f32_16x16x32_bf16 v[108:111], a[52:55], a[84:87], v[108:111]
    ds_read_b128 a[52:55], v7 offset:8192
    v_mfma_f32_16x16x32_bf16 v[116:119], a[12:15], a[40:43], v[116:119]
    ds_read_b64_tr_b16 a[40:41], v9 offset:2048
    v_mfma_f32_16x16x32_bf16 v[116:119], a[56:59], a[84:87], v[116:119]
    ds_read_b64_tr_b16 a[42:43], v9 offset:2560
    v_mfma_f32_16x16x32_bf16 v[112:115], a[12:15], a[36:39], v[112:115]
    ds_read_b128 a[12:15], v6 offset:12288
    v_mfma_f32_16x16x32_bf16 v[112:115], a[56:59], a[80:83], v[112:115]
    ds_read_b128 a[56:59], v7 offset:12288
    s_waitcnt lgkmcnt(8)
    v_mfma_f32_16x16x32_bf16 v[24:27], a[20:23], a[0:3], v[24:27]
    ds_read_b64_tr_b16 a[84:85], v9 offset:14336
    v_mfma_f32_16x16x32_bf16 v[24:27], a[64:67], a[44:47], v[24:27]
    ds_read_b64_tr_b16 a[86:87], v9 offset:14848
    v_mfma_f32_16x16x32_bf16 v[28:31], a[24:27], a[0:3], v[28:31]
    ds_read_b64_tr_b16 a[36:37], v8 offset:2048
    v_mfma_f32_16x16x32_bf16 v[28:31], a[68:71], a[44:47], v[28:31]
    ds_read_b64_tr_b16 a[38:39], v8 offset:2560
    s_waitcnt lgkmcnt(10)
    v_mfma_f32_16x16x32_bf16 v[36:39], a[24:27], a[4:7], v[36:39]
    ds_read_b64_tr_b16 a[80:81], v8 offset:14336
    v_mfma_f32_16x16x32_bf16 v[36:39], a[68:71], a[48:51], v[36:39]
    ds_read_b64_tr_b16 a[82:83], v8 offset:14848
    v_mfma_f32_16x16x32_bf16 v[32:35], a[20:23], a[4:7], v[32:35]
    v_add_u32 v6, s37, v6
    v_mfma_f32_16x16x32_bf16 v[32:35], a[64:67], a[48:51], v[32:35]
    v_add_u32 v7, s37, v7
    s_waitcnt lgkmcnt(10)
    v_mfma_f32_16x16x32_bf16 v[40:43], a[20:23], a[8:11], v[40:43]
    v_add_u32 v8, s37, v8
    v_mfma_f32_16x16x32_bf16 v[40:43], a[64:67], a[52:55], v[40:43]
    v_add_u32 v9, s37, v9
    v_mfma_f32_16x16x32_bf16 v[44:47], a[24:27], a[8:11], v[44:47]
    s_sub_u32 s38, s38, 1
    v_mfma_f32_16x16x32_bf16 v[44:47], a[68:71], a[52:55], v[44:47]
    s_cmp_lg_u32 s38, 0
    s_waitcnt lgkmcnt(6)
    v_mfma_f32_16x16x32_bf16 v[52:55], a[24:27], a[12:15], v[52:55]
    v_mfma_f32_16x16x32_bf16 v[52:55], a[68:71], a[56:59], v[52:55]
    v_mfma_f32_16x16x32_bf16 v[48:51], a[20:23], a[12:15], v[48:51]
    v_mfma_f32_16x16x32_bf16 v[48:51], a[64:67], a[56:59], v[48:51]
    s_cbranch_scc1 Lcloop_139
    s_waitcnt lgkmcnt(0)
    s_barrier
    ds_read_b128 v[128:131], v22 offset:2048
    ds_read_b128 v[132:135], v22 offset:2112
    ds_read_b32 v156, v18 offset:1024
    ds_read_b32 v157, v18 offset:1152
    ds_read_b32 v158, v18 offset:1280
    ds_read_b32 v159, v18 offset:1408
    v_mfma_f32_16x16x32_bf16 v[80:83], a[28:31], a[12:15], v[80:83]
    ds_read_b64_tr_b16 a[24:25], v9 offset:0
    v_mfma_f32_16x16x32_bf16 v[80:83], a[72:75], a[56:59], v[80:83]
    ds_read_b64_tr_b16 a[26:27], v9 offset:512
    v_mfma_f32_16x16x32_bf16 v[72:75], a[28:31], a[8:11], v[72:75]
    ds_read_b64_tr_b16 a[68:69], v9 offset:12288
    v_mfma_f32_16x16x32_bf16 v[72:75], a[72:75], a[52:55], v[72:75]
    ds_read_b64_tr_b16 a[70:71], v9 offset:12800
    v_mfma_f32_16x16x32_bf16 v[64:67], a[28:31], a[4:7], v[64:67]
    ds_read_b64_tr_b16 a[20:21], v8 offset:0
    v_mfma_f32_16x16x32_bf16 v[64:67], a[72:75], a[48:51], v[64:67]
    ds_read_b64_tr_b16 a[22:23], v8 offset:512
    s_waitcnt lgkmcnt(9)
    v_fmac_f32 v24, v156, v128
    v_mfma_f32_16x16x32_bf16 v[56:59], a[28:31], a[0:3], v[56:59]
    ds_read_b64_tr_b16 a[64:65], v8 offset:12288
    v_fmac_f32 v25, v156, v129
    v_mfma_f32_16x16x32_bf16 v[56:59], a[72:75], a[44:47], v[56:59]
    ds_read_b64_tr_b16 a[66:67], v8 offset:12800
    v_fmac_f32 v26, v156, v130
    v_mfma_f32_16x16x32_bf16 v[120:123], a[28:31], a[16:19], v[120:123]
    ds_read_b64_tr_b16 a[28:29], v8 offset:1024
    ds_read_b128 v[136:139], v22 offset:2304
    v_mfma_f32_16x16x32_bf16 v[120:123], a[72:75], a[60:63], v[120:123]
    ds_read_b64_tr_b16 a[30:31], v8 offset:1536
    ds_read_b128 v[140:143], v22 offset:2368
    v_mfma_f32_16x16x32_bf16 v[124:127], a[32:35], a[16:19], v[124:127]
    ds_read_b64_tr_b16 a[72:73], v8 offset:13312
    ds_read_b32 v144, v10 offset:2560
    v_mfma_f32_16x16x32_bf16 v[124:127], a[76:79], a[60:63], v[124:127]
    ds_read_b64_tr_b16 a[74:75], v8 offset:13824
    ds_read_b32 v145, v10 offset:2624
    v_mfma_f32_16x16x32_bf16 v[84:87], a[32:35], a[12:15], v[84:87]
    ds_read_b128 a[16:19], v6 offset:16384
    ds_read2_b32 v[146:147], v13 offset0:0 offset1:2
    v_mfma_f32_16x16x32_bf16 v[84:87], a[76:79], a[56:59], v[84:87]
    ds_read_b128 a[60:63], v7 offset:16384
    ds_read2_b32 v[148:149], v13 offset0:4 offset1:6
    v_mfma_f32_16x16x32_bf16 v[76:79], a[32:35], a[8:11], v[76:79]
    v_fmac_f32 v27, v156, v131
    s_waitcnt lgkmcnt(14)
    v_fmac_f32 v32, v157, v128
    v_mfma_f32_16x16x32_bf16 v[76:79], a[76:79], a[52:55], v[76:79]
    ds_read2_b32 v[150:151], v13 offset0:32 offset1:34
    v_fmac_f32 v33, v157, v129
    v_mfma_f32_16x16x32_bf16 v[68:71], a[32:35], a[4:7], v[68:71]
    ds_read2_b32 v[152:153], v13 offset0:36 offset1:38
    v_fmac_f32 v34, v157, v130
    v_mfma_f32_16x16x32_bf16 v[68:71], a[76:79], a[48:51], v[68:71]
    ds_read2_b32 v[154:155], v13 offset0:64 offset1:66
    v_fmac_f32 v35, v157, v131
    v_mfma_f32_16x16x32_bf16 v[60:63], a[32:35], a[0:3], v[60:63]
    ds_read_b64_tr_b16 a[32:33], v9 offset:1024
    ds_read2_b32 v[4:5], v13 offset0:68 offset1:70
    v_mfma_f32_16x16x32_bf16 v[60:63], a[76:79], a[44:47], v[60:63]
    ds_read_b64_tr_b16 a[34:35], v9 offset:1536
    ds_read2_b32 v[14:15], v13 offset0:96 offset1:98
    v_mfma_f32_16x16x32_bf16 v[88:91], a[0:3], a[36:39], v[88:91]
    ds_read_b64_tr_b16 a[76:77], v9 offset:13312
    ds_read2_b32 v[16:17], v13 offset0:100 offset1:102
    v_mfma_f32_16x16x32_bf16 v[88:91], a[44:47], a[80:83], v[88:91]
    ds_read_b64_tr_b16 a[78:79], v9 offset:13824
    v_fmac_f32 v40, v158, v128
    v_mfma_f32_16x16x32_bf16 v[92:95], a[0:3], a[40:43], v[92:95]
    ds_read_b128 a[0:3], v6 offset:0
    v_fmac_f32 v41, v158, v129
    v_mfma_f32_16x16x32_bf16 v[92:95], a[44:47], a[84:87], v[92:95]
    ds_read_b128 a[44:47], v7 offset:0
    v_fmac_f32 v42, v158, v130
    v_mfma_f32_16x16x32_bf16 v[100:103], a[4:7], a[40:43], v[100:103]
    v_fmac_f32 v43, v158, v131
    v_fmac_f32 v48, v159, v128
    v_mfma_f32_16x16x32_bf16 v[100:103], a[48:51], a[84:87], v[100:103]
    v_fmac_f32 v49, v159, v129
    v_fmac_f32 v50, v159, v130
    v_mfma_f32_16x16x32_bf16 v[96:99], a[4:7], a[36:39], v[96:99]
    ds_read_b128 a[4:7], v6 offset:4096
    v_fmac_f32 v51, v159, v131
    v_mfma_f32_16x16x32_bf16 v[96:99], a[48:51], a[80:83], v[96:99]
    ds_read_b128 a[48:51], v7 offset:4096
    v_fmac_f32 v28, v156, v132
    v_mfma_f32_16x16x32_bf16 v[104:107], a[8:11], a[36:39], v[104:107]
    v_fmac_f32 v29, v156, v133
    v_fmac_f32 v30, v156, v134
    v_mfma_f32_16x16x32_bf16 v[104:107], a[52:55], a[80:83], v[104:107]
    v_fmac_f32 v31, v156, v135
    v_fmac_f32 v36, v157, v132
    v_mfma_f32_16x16x32_bf16 v[108:111], a[8:11], a[40:43], v[108:111]
    ds_read_b128 a[8:11], v6 offset:8192
    v_fmac_f32 v37, v157, v133
    v_mfma_f32_16x16x32_bf16 v[108:111], a[52:55], a[84:87], v[108:111]
    ds_read_b128 a[52:55], v7 offset:8192
    v_fmac_f32 v38, v157, v134
    v_mfma_f32_16x16x32_bf16 v[116:119], a[12:15], a[40:43], v[116:119]
    ds_read_b64_tr_b16 a[40:41], v9 offset:2048
    v_fmac_f32 v39, v157, v135
    v_mfma_f32_16x16x32_bf16 v[116:119], a[56:59], a[84:87], v[116:119]
    ds_read_b64_tr_b16 a[42:43], v9 offset:2560
    v_fmac_f32 v44, v158, v132
    v_mfma_f32_16x16x32_bf16 v[112:115], a[12:15], a[36:39], v[112:115]
    ds_read_b128 a[12:15], v6 offset:12288
    v_fmac_f32 v45, v158, v133
    v_mfma_f32_16x16x32_bf16 v[112:115], a[56:59], a[80:83], v[112:115]
    ds_read_b128 a[56:59], v7 offset:12288
    v_fmac_f32 v46, v158, v134
    s_waitcnt lgkmcnt(8)
    v_mfma_f32_16x16x32_bf16 v[24:27], a[20:23], a[0:3], v[24:27]
    ds_read_b64_tr_b16 a[84:85], v9 offset:14336
    v_fmac_f32 v47, v158, v135
    v_mfma_f32_16x16x32_bf16 v[24:27], a[64:67], a[44:47], v[24:27]
    ds_read_b64_tr_b16 a[86:87], v9 offset:14848
    v_fmac_f32 v52, v159, v132
    v_mfma_f32_16x16x32_bf16 v[28:31], a[24:27], a[0:3], v[28:31]
    ds_read_b64_tr_b16 a[36:37], v8 offset:2048
    v_fmac_f32 v53, v159, v133
    v_mfma_f32_16x16x32_bf16 v[28:31], a[68:71], a[44:47], v[28:31]
    ds_read_b64_tr_b16 a[38:39], v8 offset:2560
    v_fmac_f32 v54, v159, v134
    s_waitcnt lgkmcnt(10)
    v_mfma_f32_16x16x32_bf16 v[36:39], a[24:27], a[4:7], v[36:39]
    ds_read_b64_tr_b16 a[80:81], v8 offset:14336
    v_fmac_f32 v55, v159, v135
    v_mfma_f32_16x16x32_bf16 v[36:39], a[68:71], a[48:51], v[36:39]
    ds_read_b64_tr_b16 a[82:83], v8 offset:14848
    v_fmac_f32 v88, v146, v144
    v_mfma_f32_16x16x32_bf16 v[32:35], a[20:23], a[4:7], v[32:35]
    s_mov_b64 exec, 1
    ds_add_u32 v2, v3 offset:12
    s_mov_b64 exec, -1
    v_mfma_f32_16x16x32_bf16 v[32:35], a[64:67], a[48:51], v[32:35]
    v_fmac_f32 v89, v147, v144
    v_fmac_f32 v90, v148, v144
    ds_read_b32 v128, v18 offset:0
    s_waitcnt lgkmcnt(12)
    v_mfma_f32_16x16x32_bf16 v[40:43], a[20:23], a[8:11], v[40:43]
    v_fmac_f32 v91, v149, v144
    v_fmac_f32 v92, v146, v145
    ds_read_b32 v129, v18 offset:128
    v_mfma_f32_16x16x32_bf16 v[40:43], a[64:67], a[52:55], v[40:43]
    v_fmac_f32 v93, v147, v145
    v_fmac_f32 v94, v148, v145
    ds_read_b32 v130, v18 offset:256
    v_mfma_f32_16x16x32_bf16 v[44:47], a[24:27], a[8:11], v[44:47]
    v_fmac_f32 v95, v149, v145
    v_fmac_f32 v96, v150, v144
    ds_read_b32 v131, v18 offset:384
    v_mfma_f32_16x16x32_bf16 v[44:47], a[68:71], a[52:55], v[44:47]
    v_fmac_f32 v97, v151, v144
    v_fmac_f32 v98, v152, v144
    ds_read_b32 v132, v20
    s_waitcnt lgkmcnt(12)
    v_mfma_f32_16x16x32_bf16 v[52:55], a[24:27], a[12:15], v[52:55]
    v_fmac_f32 v99, v153, v144
    v_fmac_f32 v100, v150, v145
    ds_read_b32 v133, v20 offset:1024
    v_mfma_f32_16x16x32_bf16 v[52:55], a[68:71], a[56:59], v[52:55]
    v_fmac_f32 v101, v151, v145
    v_fmac_f32 v102, v152, v145
    v_mfma_f32_16x16x32_bf16 v[48:51], a[20:23], a[12:15], v[48:51]
    v_fmac_f32 v103, v153, v145
    v_fmac_f32 v104, v154, v144
    v_mfma_f32_16x16x32_bf16 v[48:51], a[64:67], a[56:59], v[48:51]
    v_fmac_f32 v105, v155, v144
    v_fmac_f32 v106, v4, v144
    v_mfma_f32_16x16x32_bf16 v[80:83], a[28:31], a[12:15], v[80:83]
    v_fmac_f32 v107, v5, v144
    v_fmac_f32 v108, v154, v145
    v_mfma_f32_16x16x32_bf16 v[80:83], a[72:75], a[56:59], v[80:83]
    v_fmac_f32 v109, v155, v145
    v_fmac_f32 v110, v4, v145
    v_mfma_f32_16x16x32_bf16 v[72:75], a[28:31], a[8:11], v[72:75]
    v_fmac_f32 v111, v5, v145
    v_fmac_f32 v112, v14, v144
    v_mfma_f32_16x16x32_bf16 v[72:75], a[72:75], a[52:55], v[72:75]
    v_fmac_f32 v113, v15, v144
    v_fmac_f32 v114, v16, v144
    v_mfma_f32_16x16x32_bf16 v[64:67], a[28:31], a[4:7], v[64:67]
    v_fmac_f32 v115, v17, v144
    v_fmac_f32 v116, v14, v145
    v_mfma_f32_16x16x32_bf16 v[64:67], a[72:75], a[48:51], v[64:67]
    v_fmac_f32 v117, v15, v145
    v_fmac_f32 v118, v16, v145
    v_mfma_f32_16x16x32_bf16 v[56:59], a[28:31], a[0:3], v[56:59]
    v_fmac_f32 v119, v17, v145
    v_fmac_f32 v80, v159, v136
    v_mfma_f32_16x16x32_bf16 v[56:59], a[72:75], a[44:47], v[56:59]
    v_fmac_f32 v81, v159, v137
    v_fmac_f32 v82, v159, v138
    ds_read2_b32 v[146:147], v19 offset0:0 offset1:2
    v_mfma_f32_16x16x32_bf16 v[120:123], a[28:31], a[16:19], v[120:123]
    v_fmac_f32 v72, v158, v136
    v_fmac_f32 v73, v158, v137
    ds_read2_b32 v[148:149], v19 offset0:4 offset1:6
    v_mfma_f32_16x16x32_bf16 v[120:123], a[72:75], a[60:63], v[120:123]
    v_fmac_f32 v74, v158, v138
    v_fmac_f32 v75, v158, v139
    ds_read2_b32 v[150:151], v19 offset0:32 offset1:34
    v_mfma_f32_16x16x32_bf16 v[124:127], a[32:35], a[16:19], v[124:127]
    v_fmac_f32 v64, v157, v136
    v_fmac_f32 v65, v157, v137
    ds_read2_b32 v[152:153], v19 offset0:36 offset1:38
    v_mfma_f32_16x16x32_bf16 v[124:127], a[76:79], a[60:63], v[124:127]
    v_fmac_f32 v66, v157, v138
    v_fmac_f32 v67, v157, v139
    ds_read2_b32 v[154:155], v19 offset0:64 offset1:66
    v_mfma_f32_16x16x32_bf16 v[84:87], a[32:35], a[12:15], v[84:87]
    v_fmac_f32 v56, v156, v136
    v_fmac_f32 v57, v156, v137
    ds_read2_b32 v[4:5], v19 offset0:68 offset1:70
    v_mfma_f32_16x16x32_bf16 v[84:87], a[76:79], a[56:59], v[84:87]
    v_fmac_f32 v58, v156, v138
    v_fmac_f32 v59, v156, v139
    ds_read2_b32 v[14:15], v19 offset0:96 offset1:98
    v_mfma_f32_16x16x32_bf16 v[76:79], a[32:35], a[8:11], v[76:79]
    v_fmac_f32 v83, v159, v139
    v_fmac_f32 v60, v156, v140
    ds_read2_b32 v[16:17], v19 offset0:100 offset1:102
    v_mfma_f32_16x16x32_bf16 v[76:79], a[76:79], a[52:55], v[76:79]
    v_fmac_f32 v61, v156, v141
    v_fmac_f32 v62, v156, v142
    v_mfma_f32_16x16x32_bf16 v[68:71], a[32:35], a[4:7], v[68:71]
    v_mfma_f32_16x16x32_bf16 v[68:71], a[76:79], a[48:51], v[68:71]
    v_mfma_f32_16x16x32_bf16 v[60:63], a[32:35], a[0:3], v[60:63]
    v_fmac_f32 v84, v159, v140
    v_fmac_f32 v85, v159, v141
    v_mfma_f32_16x16x32_bf16 v[60:63], a[76:79], a[44:47], v[60:63]
    v_fmac_f32 v86, v159, v142
    v_fmac_f32 v87, v159, v143
    s_waitcnt lgkmcnt(14)
    v_mfma_f32_16x16x32_bf16 v[88:91], a[0:3], a[36:39], v[88:91]
    v_fmac_f32 v76, v158, v140
    v_fmac_f32 v77, v158, v141
    v_mfma_f32_16x16x32_bf16 v[88:91], a[44:47], a[80:83], v[88:91]
    v_fmac_f32 v78, v158, v142
    v_fmac_f32 v79, v158, v143
    v_mfma_f32_16x16x32_bf16 v[92:95], a[0:3], a[40:43], v[92:95]
    v_fmac_f32 v68, v157, v140
    v_fmac_f32 v69, v157, v141
    v_mfma_f32_16x16x32_bf16 v[92:95], a[44:47], a[84:87], v[92:95]
    v_fmac_f32 v70, v157, v142
    v_fmac_f32 v71, v157, v143
    v_mfma_f32_16x16x32_bf16 v[100:103], a[4:7], a[40:43], v[100:103]
    v_fmac_f32 v63, v156, v143
    v_mfma_f32_16x16x32_bf16 v[100:103], a[48:51], a[84:87], v[100:103]
    v_mfma_f32_16x16x32_bf16 v[96:99], a[4:7], a[36:39], v[96:99]
    v_mfma_f32_16x16x32_bf16 v[96:99], a[48:51], a[80:83], v[96:99]
    v_mfma_f32_16x16x32_bf16 v[104:107], a[8:11], a[36:39], v[104:107]
    v_mfma_f32_16x16x32_bf16 v[104:107], a[52:55], a[80:83], v[104:107]
    v_mfma_f32_16x16x32_bf16 v[108:111], a[8:11], a[40:43], v[108:111]
    v_mfma_f32_16x16x32_bf16 v[108:111], a[52:55], a[84:87], v[108:111]
    v_mfma_f32_16x16x32_bf16 v[116:119], a[12:15], a[40:43], v[116:119]
    v_mfma_f32_16x16x32_bf16 v[116:119], a[56:59], a[84:87], v[116:119]
    v_mfma_f32_16x16x32_bf16 v[112:115], a[12:15], a[36:39], v[112:115]
    v_mfma_f32_16x16x32_bf16 v[112:115], a[56:59], a[80:83], v[112:115]
    v_cvt_pk_bf16_f32 v24, v24, v25
    v_cvt_pk_bf16_f32 v25, v26, v27
    v_cvt_pk_bf16_f32 v26, v28, v29
    v_cvt_pk_bf16_f32 v27, v30, v31
    v_cvt_pk_bf16_f32 v32, v32, v33
    v_cvt_pk_bf16_f32 v33, v34, v35
    v_cvt_pk_bf16_f32 v34, v36, v37
    v_cvt_pk_bf16_f32 v35, v38, v39
    v_cvt_pk_bf16_f32 v40, v40, v41
    v_cvt_pk_bf16_f32 v41, v42, v43
    v_cvt_pk_bf16_f32 v42, v44, v45
    v_cvt_pk_bf16_f32 v43, v46, v47
    v_cvt_pk_bf16_f32 v48, v48, v49
    v_cvt_pk_bf16_f32 v49, v50, v51
    v_cvt_pk_bf16_f32 v50, v52, v53
    v_cvt_pk_bf16_f32 v51, v54, v55
    s_waitcnt lgkmcnt(8)
    v_fmac_f32 v120, v133, v136
    v_fmac_f32 v121, v133, v137
    v_fmac_f32 v122, v133, v138
    v_fmac_f32 v123, v133, v139
    v_fmac_f32 v124, v133, v140
    v_fmac_f32 v125, v133, v141
    v_fmac_f32 v126, v133, v142
    v_fmac_f32 v127, v133, v143
    v_mul_f32 v120, v132, v120
    v_mul_f32 v121, v132, v121
    v_mul_f32 v122, v132, v122
    v_mul_f32 v123, v132, v123
    v_mul_f32 v124, v132, v124
    v_mul_f32 v125, v132, v125
    v_mul_f32 v126, v132, v126
    v_mul_f32 v127, v132, v127
    s_branch Lp1j_138
Lp1v_137:
    s_mov_b32 s36, 0
    s_mov_b32 s46, 43008
    s_mov_b32 s47, 4294881280
    s_waitcnt lgkmcnt(0)
    s_barrier
    ds_read_b128 a[0:3], v6 offset:0
    ds_read_b128 a[44:47], v7 offset:0
    ds_read_b64_tr_b16 a[20:21], v8 offset:0
    ds_read_b64_tr_b16 a[22:23], v8 offset:512
    ds_read_b64_tr_b16 a[64:65], v8 offset:12288
    ds_read_b64_tr_b16 a[66:67], v8 offset:12800
    ds_read_b64_tr_b16 a[24:25], v9 offset:0
    ds_read_b64_tr_b16 a[26:27], v9 offset:512
    ds_read_b64_tr_b16 a[68:69], v9 offset:12288
    ds_read_b64_tr_b16 a[70:71], v9 offset:12800
    ds_read_b128 a[4:7], v6 offset:4096
    ds_read_b128 a[48:51], v7 offset:4096
    ds_read_b128 a[8:11], v6 offset:8192
    ds_read_b128 a[52:55], v7 offset:8192
    s_add_u32 s36, s36, 43008
    s_cmp_ge_u32 s36, 129024
    s_cselect_b32 s37, s47, s46
    s_cselect_b32 s36, 0, s36
    s_waitcnt lgkmcnt(10)
    v_mfma_f32_16x16x32_bf16 v[24:27], a[20:23], a[0:3], 0
    ds_read_b128 a[12:15], v6 offset:12288
    ds_read_b128 a[56:59], v7 offset:12288
    s_waitcnt lgkmcnt(10)
    v_mfma_f32_16x16x32_bf16 v[24:27], a[64:67], a[44:47], v[24:27]
    ds_read_b64_tr_b16 a[36:37], v8 offset:2048
    ds_read_b64_tr_b16 a[38:39], v8 offset:2560
    s_waitcnt lgkmcnt(10)
    v_mfma_f32_16x16x32_bf16 v[28:31], a[24:27], a[0:3], 0
    ds_read_b64_tr_b16 a[80:81], v8 offset:14336
    ds_read_b64_tr_b16 a[82:83], v8 offset:14848
    s_waitcnt lgkmcnt(10)
    v_mfma_f32_16x16x32_bf16 v[28:31], a[68:71], a[44:47], v[28:31]
    ds_read_b128 a[16:19], v6 offset:14336
    ds_read_b128 a[60:63], v7 offset:14336
    s_waitcnt lgkmcnt(11)
    v_mfma_f32_16x16x32_bf16 v[36:39], a[24:27], a[4:7], 0
    ds_read_b64_tr_b16 a[40:41], v9 offset:2048
    ds_read_b64_tr_b16 a[42:43], v9 offset:2560
    s_waitcnt lgkmcnt(12)
    v_mfma_f32_16x16x32_bf16 v[36:39], a[68:71], a[48:51], v[36:39]
    ds_read_b64_tr_b16 a[84:85], v9 offset:14336
    ds_read_b64_tr_b16 a[86:87], v9 offset:14848
    v_mfma_f32_16x16x32_bf16 v[32:35], a[20:23], a[4:7], 0
    ds_read_b64_tr_b16 a[28:29], v8 offset:1024
    ds_read_b64_tr_b16 a[30:31], v8 offset:1536
    v_mfma_f32_16x16x32_bf16 v[32:35], a[64:67], a[48:51], v[32:35]
    ds_read_b64_tr_b16 a[72:73], v8 offset:13312
    ds_read_b64_tr_b16 a[74:75], v8 offset:13824
    s_waitcnt lgkmcnt(14)
    v_mfma_f32_16x16x32_bf16 v[40:43], a[20:23], a[8:11], 0
    ds_read_b64_tr_b16 a[32:33], v9 offset:1024
    ds_read_b64_tr_b16 a[34:35], v9 offset:1536
    v_mfma_f32_16x16x32_bf16 v[40:43], a[64:67], a[52:55], v[40:43]
    ds_read_b64_tr_b16 a[76:77], v9 offset:13312
    ds_read_b64_tr_b16 a[78:79], v9 offset:13824
    v_mfma_f32_16x16x32_bf16 v[44:47], a[24:27], a[8:11], 0
    v_mfma_f32_16x16x32_bf16 v[44:47], a[68:71], a[52:55], v[44:47]
    v_add_u32 v6, s37, v6
    v_mfma_f32_16x16x32_bf16 v[52:55], a[24:27], a[12:15], 0
    v_add_u32 v7, s37, v7
    v_mfma_f32_16x16x32_bf16 v[52:55], a[68:71], a[56:59], v[52:55]
    v_add_u32 v8, s37, v8
    v_mfma_f32_16x16x32_bf16 v[48:51], a[20:23], a[12:15], 0
    v_add_u32 v9, s37, v9
    v_mfma_f32_16x16x32_bf16 v[48:51], a[64:67], a[56:59], v[48:51]
    s_waitcnt lgkmcnt(0)
    s_barrier
    v_mfma_f32_16x16x32_bf16 v[112:115], a[12:15], a[36:39], 0
    ds_read_b64_tr_b16 a[24:25], v9 offset:0
    v_mfma_f32_16x16x32_bf16 v[112:115], a[56:59], a[80:83], v[112:115]
    ds_read_b64_tr_b16 a[26:27], v9 offset:512
    v_mfma_f32_16x16x32_bf16 v[104:107], a[8:11], a[36:39], 0
    ds_read_b64_tr_b16 a[68:69], v9 offset:12288
    v_mfma_f32_16x16x32_bf16 v[104:107], a[52:55], a[80:83], v[104:107]
    ds_read_b64_tr_b16 a[70:71], v9 offset:12800
    v_mfma_f32_16x16x32_bf16 v[96:99], a[4:7], a[36:39], 0
    ds_read_b64_tr_b16 a[20:21], v8 offset:0
    v_mfma_f32_16x16x32_bf16 v[96:99], a[48:51], a[80:83], v[96:99]
    ds_read_b64_tr_b16 a[22:23], v8 offset:512
    v_mfma_f32_16x16x32_bf16 v[88:91], a[0:3], a[36:39], 0
    ds_read_b64_tr_b16 a[64:65], v8 offset:12288
    v_mfma_f32_16x16x32_bf16 v[88:91], a[44:47], a[80:83], v[88:91]
    ds_read_b64_tr_b16 a[66:67], v8 offset:12800
    v_mfma_f32_16x16x32_bf16 v[120:123], a[16:19], a[36:39], 0
    ds_read_b64_tr_b16 a[36:37], v8 offset:2048
    v_mfma_f32_16x16x32_bf16 v[120:123], a[60:63], a[80:83], v[120:123]
    ds_read_b64_tr_b16 a[38:39], v8 offset:2560
    v_mfma_f32_16x16x32_bf16 v[124:127], a[16:19], a[40:43], 0
    ds_read_b64_tr_b16 a[80:81], v8 offset:14336
    v_mfma_f32_16x16x32_bf16 v[124:127], a[60:63], a[84:87], v[124:127]
    ds_read_b64_tr_b16 a[82:83], v8 offset:14848
    v_mfma_f32_16x16x32_bf16 v[116:119], a[12:15], a[40:43], 0
    ds_read_b128 a[16:19], v6 offset:14336
    v_mfma_f32_16x16x32_bf16 v[116:119], a[56:59], a[84:87], v[116:119]
    ds_read_b128 a[60:63], v7 offset:14336
    v_mfma_f32_16x16x32_bf16 v[108:111], a[8:11], a[40:43], 0
    s_add_u32 s36, s36, 43008
    v_mfma_f32_16x16x32_bf16 v[108:111], a[52:55], a[84:87], v[108:111]
    s_cmp_ge_u32 s36, 129024
    v_mfma_f32_16x16x32_bf16 v[100:103], a[4:7], a[40:43], 0
    s_cselect_b32 s37, s47, s46
    v_mfma_f32_16x16x32_bf16 v[100:103], a[48:51], a[84:87], v[100:103]
    s_cselect_b32 s36, 0, s36
    v_mfma_f32_16x16x32_bf16 v[92:95], a[0:3], a[40:43], 0
    ds_read_b64_tr_b16 a[40:41], v9 offset:2048
    v_mfma_f32_16x16x32_bf16 v[92:95], a[44:47], a[84:87], v[92:95]
    ds_read_b64_tr_b16 a[42:43], v9 offset:2560
    v_mfma_f32_16x16x32_bf16 v[56:59], a[28:31], a[0:3], 0
    ds_read_b64_tr_b16 a[84:85], v9 offset:14336
    v_mfma_f32_16x16x32_bf16 v[56:59], a[72:75], a[44:47], v[56:59]
    ds_read_b64_tr_b16 a[86:87], v9 offset:14848
    v_mfma_f32_16x16x32_bf16 v[60:63], a[32:35], a[0:3], 0
    ds_read_b128 a[0:3], v6 offset:0
    v_mfma_f32_16x16x32_bf16 v[60:63], a[76:79], a[44:47], v[60:63]
    ds_read_b128 a[44:47], v7 offset:0
    v_mfma_f32_16x16x32_bf16 v[68:71], a[32:35], a[4:7], 0
    v_mfma_f32_16x16x32_bf16 v[68:71], a[76:79], a[48:51], v[68:71]
    v_mfma_f32_16x16x32_bf16 v[64:67], a[28:31], a[4:7], 0
    ds_read_b128 a[4:7], v6 offset:4096
    v_mfma_f32_16x16x32_bf16 v[64:67], a[72:75], a[48:51], v[64:67]
    ds_read_b128 a[48:51], v7 offset:4096
    v_mfma_f32_16x16x32_bf16 v[72:75], a[28:31], a[8:11], 0
    v_mfma_f32_16x16x32_bf16 v[72:75], a[72:75], a[52:55], v[72:75]
    v_mfma_f32_16x16x32_bf16 v[76:79], a[32:35], a[8:11], 0
    ds_read_b128 a[8:11], v6 offset:8192
    v_mfma_f32_16x16x32_bf16 v[76:79], a[76:79], a[52:55], v[76:79]
    ds_read_b128 a[52:55], v7 offset:8192
    v_mfma_f32_16x16x32_bf16 v[84:87], a[32:35], a[12:15], 0
    ds_read_b64_tr_b16 a[32:33], v9 offset:1024
    v_mfma_f32_16x16x32_bf16 v[84:87], a[76:79], a[56:59], v[84:87]
    ds_read_b64_tr_b16 a[34:35], v9 offset:1536
    v_mfma_f32_16x16x32_bf16 v[80:83], a[28:31], a[12:15], 0
    ds_read_b128 a[12:15], v6 offset:12288
    v_mfma_f32_16x16x32_bf16 v[80:83], a[72:75], a[56:59], v[80:83]
    ds_read_b128 a[56:59], v7 offset:12288
    s_waitcnt lgkmcnt(8)
    v_mfma_f32_16x16x32_bf16 v[24:27], a[20:23], a[0:3], v[24:27]
    ds_read_b64_tr_b16 a[76:77], v9 offset:13312
    v_mfma_f32_16x16x32_bf16 v[24:27], a[64:67], a[44:47], v[24:27]
    ds_read_b64_tr_b16 a[78:79], v9 offset:13824
    v_mfma_f32_16x16x32_bf16 v[28:31], a[24:27], a[0:3], v[28:31]
    ds_read_b64_tr_b16 a[28:29], v8 offset:1024
    v_mfma_f32_16x16x32_bf16 v[28:31], a[68:71], a[44:47], v[28:31]
    ds_read_b64_tr_b16 a[30:31], v8 offset:1536
    s_waitcnt lgkmcnt(10)
    v_mfma_f32_16x16x32_bf16 v[36:39], a[24:27], a[4:7], v[36:39]
    ds_read_b64_tr_b16 a[72:73], v8 offset:13312
    v_mfma_f32_16x16x32_bf16 v[36:39], a[68:71], a[48:51], v[36:39]
    ds_read_b64_tr_b16 a[74:75], v8 offset:13824
    v_mfma_f32_16x16x32_bf16 v[32:35], a[20:23], a[4:7], v[32:35]
    v_add_u32 v6, s37, v6
    v_mfma_f32_16x16x32_bf16 v[32:35], a[64:67], a[48:51], v[32:35]
    v_add_u32 v7, s37, v7
    s_waitcnt lgkmcnt(10)
    v_mfma_f32_16x16x32_bf16 v[40:43], a[20:23], a[8:11], v[40:43]
    v_mfma_f32_16x16x32_bf16 v[40:43], a[64:67], a[52:55], v[40:43]
    v_add_u32 v8, s37, v8
    v_mfma_f32_16x16x32_bf16 v[44:47], a[24:27], a[8:11], v[44:47]
    v_add_u32 v9, s37, v9
    v_mfma_f32_16x16x32_bf16 v[44:47], a[68:71], a[52:55], v[44:47]
    s_waitcnt lgkmcnt(6)
    v_mfma_f32_16x16x32_bf16 v[52:55], a[24:27], a[12:15], v[52:55]
    v_mfma_f32_16x16x32_bf16 v[52:55], a[68:71], a[56:59], v[52:55]
    v_mfma_f32_16x16x32_bf16 v[48:51], a[20:23], a[12:15], v[48:51]
    v_mfma_f32_16x16x32_bf16 v[48:51], a[64:67], a[56:59], v[48:51]
    s_mov_b32 s38, 13
Lcloop_140:
    s_waitcnt lgkmcnt(0)
    s_barrier
    v_mfma_f32_16x16x32_bf16 v[112:115], a[12:15], a[36:39], v[112:115]
    ds_read_b64_tr_b16 a[24:25], v9 offset:0
    v_mfma_f32_16x16x32_bf16 v[112:115], a[56:59], a[80:83], v[112:115]
    ds_read_b64_tr_b16 a[26:27], v9 offset:512
    v_mfma_f32_16x16x32_bf16 v[104:107], a[8:11], a[36:39], v[104:107]
    ds_read_b64_tr_b16 a[68:69], v9 offset:12288
    v_mfma_f32_16x16x32_bf16 v[104:107], a[52:55], a[80:83], v[104:107]
    ds_read_b64_tr_b16 a[70:71], v9 offset:12800
    v_mfma_f32_16x16x32_bf16 v[96:99], a[4:7], a[36:39], v[96:99]
    ds_read_b64_tr_b16 a[20:21], v8 offset:0
    v_mfma_f32_16x16x32_bf16 v[96:99], a[48:51], a[80:83], v[96:99]
    ds_read_b64_tr_b16 a[22:23], v8 offset:512
    v_mfma_f32_16x16x32_bf16 v[88:91], a[0:3], a[36:39], v[88:91]
    ds_read_b64_tr_b16 a[64:65], v8 offset:12288
    v_mfma_f32_16x16x32_bf16 v[88:91], a[44:47], a[80:83], v[88:91]
    ds_read_b64_tr_b16 a[66:67], v8 offset:12800
    v_mfma_f32_16x16x32_bf16 v[120:123], a[16:19], a[36:39], v[120:123]
    ds_read_b64_tr_b16 a[36:37], v8 offset:2048
    v_mfma_f32_16x16x32_bf16 v[120:123], a[60:63], a[80:83], v[120:123]
    ds_read_b64_tr_b16 a[38:39], v8 offset:2560
    v_mfma_f32_16x16x32_bf16 v[124:127], a[16:19], a[40:43], v[124:127]
    ds_read_b64_tr_b16 a[80:81], v8 offset:14336
    v_mfma_f32_16x16x32_bf16 v[124:127], a[60:63], a[84:87], v[124:127]
    ds_read_b64_tr_b16 a[82:83], v8 offset:14848
    v_mfma_f32_16x16x32_bf16 v[116:119], a[12:15], a[40:43], v[116:119]
    ds_read_b128 a[16:19], v6 offset:14336
    v_mfma_f32_16x16x32_bf16 v[116:119], a[56:59], a[84:87], v[116:119]
    ds_read_b128 a[60:63], v7 offset:14336
    v_mfma_f32_16x16x32_bf16 v[108:111], a[8:11], a[40:43], v[108:111]
    s_add_u32 s36, s36, 43008
    v_mfma_f32_16x16x32_bf16 v[108:111], a[52:55], a[84:87], v[108:111]
    s_cmp_ge_u32 s36, 129024
    v_mfma_f32_16x16x32_bf16 v[100:103], a[4:7], a[40:43], v[100:103]
    s_cselect_b32 s37, s47, s46
    v_mfma_f32_16x16x32_bf16 v[100:103], a[48:51], a[84:87], v[100:103]
    s_cselect_b32 s36, 0, s36
    v_mfma_f32_16x16x32_bf16 v[92:95], a[0:3], a[40:43], v[92:95]
    ds_read_b64_tr_b16 a[40:41], v9 offset:2048
    v_mfma_f32_16x16x32_bf16 v[92:95], a[44:47], a[84:87], v[92:95]
    ds_read_b64_tr_b16 a[42:43], v9 offset:2560
    v_mfma_f32_16x16x32_bf16 v[56:59], a[28:31], a[0:3], v[56:59]
    ds_read_b64_tr_b16 a[84:85], v9 offset:14336
    v_mfma_f32_16x16x32_bf16 v[56:59], a[72:75], a[44:47], v[56:59]
    ds_read_b64_tr_b16 a[86:87], v9 offset:14848
    v_mfma_f32_16x16x32_bf16 v[60:63], a[32:35], a[0:3], v[60:63]
    ds_read_b128 a[0:3], v6 offset:0
    v_mfma_f32_16x16x32_bf16 v[60:63], a[76:79], a[44:47], v[60:63]
    ds_read_b128 a[44:47], v7 offset:0
    v_mfma_f32_16x16x32_bf16 v[68:71], a[32:35], a[4:7], v[68:71]
    v_mfma_f32_16x16x32_bf16 v[68:71], a[76:79], a[48:51], v[68:71]
    v_mfma_f32_16x16x32_bf16 v[64:67], a[28:31], a[4:7], v[64:67]
    ds_read_b128 a[4:7], v6 offset:4096
    v_mfma_f32_16x16x32_bf16 v[64:67], a[72:75], a[48:51], v[64:67]
    ds_read_b128 a[48:51], v7 offset:4096
    v_mfma_f32_16x16x32_bf16 v[72:75], a[28:31], a[8:11], v[72:75]
    v_mfma_f32_16x16x32_bf16 v[72:75], a[72:75], a[52:55], v[72:75]
    v_mfma_f32_16x16x32_bf16 v[76:79], a[32:35], a[8:11], v[76:79]
    ds_read_b128 a[8:11], v6 offset:8192
    v_mfma_f32_16x16x32_bf16 v[76:79], a[76:79], a[52:55], v[76:79]
    ds_read_b128 a[52:55], v7 offset:8192
    v_mfma_f32_16x16x32_bf16 v[84:87], a[32:35], a[12:15], v[84:87]
    ds_read_b64_tr_b16 a[32:33], v9 offset:1024
    v_mfma_f32_16x16x32_bf16 v[84:87], a[76:79], a[56:59], v[84:87]
    ds_read_b64_tr_b16 a[34:35], v9 offset:1536
    v_mfma_f32_16x16x32_bf16 v[80:83], a[28:31], a[12:15], v[80:83]
    ds_read_b128 a[12:15], v6 offset:12288
    v_mfma_f32_16x16x32_bf16 v[80:83], a[72:75], a[56:59], v[80:83]
    ds_read_b128 a[56:59], v7 offset:12288
    s_waitcnt lgkmcnt(8)
    v_mfma_f32_16x16x32_bf16 v[24:27], a[20:23], a[0:3], v[24:27]
    ds_read_b64_tr_b16 a[76:77], v9 offset:13312
    v_mfma_f32_16x16x32_bf16 v[24:27], a[64:67], a[44:47], v[24:27]
    ds_read_b64_tr_b16 a[78:79], v9 offset:13824
    v_mfma_f32_16x16x32_bf16 v[28:31], a[24:27], a[0:3], v[28:31]
    ds_read_b64_tr_b16 a[28:29], v8 offset:1024
    v_mfma_f32_16x16x32_bf16 v[28:31], a[68:71], a[44:47], v[28:31]
    ds_read_b64_tr_b16 a[30:31], v8 offset:1536
    s_waitcnt lgkmcnt(10)
    v_mfma_f32_16x16x32_bf16 v[36:39], a[24:27], a[4:7], v[36:39]
    ds_read_b64_tr_b16 a[72:73], v8 offset:13312
    v_mfma_f32_16x16x32_bf16 v[36:39], a[68:71], a[48:51], v[36:39]
    ds_read_b64_tr_b16 a[74:75], v8 offset:13824
    v_mfma_f32_16x16x32_bf16 v[32:35], a[20:23], a[4:7], v[32:35]
    v_add_u32 v6, s37, v6
    v_mfma_f32_16x16x32_bf16 v[32:35], a[64:67], a[48:51], v[32:35]
    v_add_u32 v7, s37, v7
    s_waitcnt lgkmcnt(10)
    v_mfma_f32_16x16x32_bf16 v[40:43], a[20:23], a[8:11], v[40:43]
    v_add_u32 v8, s37, v8
    v_mfma_f32_16x16x32_bf16 v[40:43], a[64:67], a[52:55], v[40:43]
    v_add_u32 v9, s37, v9
    v_mfma_f32_16x16x32_bf16 v[44:47], a[24:27], a[8:11], v[44:47]
    s_sub_u32 s38, s38, 1
    v_mfma_f32_16x16x32_bf16 v[44:47], a[68:71], a[52:55], v[44:47]
    s_cmp_lg_u32 s38, 0
    s_waitcnt lgkmcnt(6)
    v_mfma_f32_16x16x32_bf16 v[52:55], a[24:27], a[12:15], v[52:55]
    v_mfma_f32_16x16x32_bf16 v[52:55], a[68:71], a[56:59], v[52:55]
    v_mfma_f32_16x16x32_bf16 v[48:51], a[20:23], a[12:15], v[48:51]
    v_mfma_f32_16x16x32_bf16 v[48:51], a[64:67], a[56:59], v[48:51]
    s_cbranch_scc1 Lcloop_140
    s_waitcnt lgkmcnt(0)
    s_barrier
    ds_read_b128 v[128:131], v22 offset:2048
    ds_read_b128 v[132:135], v22 offset:2112
    ds_read_b32 v156, v18 offset:1024
    ds_read_b32 v157, v18 offset:1152
    ds_read_b32 v158, v18 offset:1280
    ds_read_b32 v159, v18 offset:1408
    v_mfma_f32_16x16x32_bf16 v[112:115], a[12:15], a[36:39], v[112:115]
    ds_read_b64_tr_b16 a[24:25], v9 offset:0
    v_mfma_f32_16x16x32_bf16 v[112:115], a[56:59], a[80:83], v[112:115]
    ds_read_b64_tr_b16 a[26:27], v9 offset:512
    v_mfma_f32_16x16x32_bf16 v[104:107], a[8:11], a[36:39], v[104:107]
    ds_read_b64_tr_b16 a[68:69], v9 offset:12288
    v_mfma_f32_16x16x32_bf16 v[104:107], a[52:55], a[80:83], v[104:107]
    ds_read_b64_tr_b16 a[70:71], v9 offset:12800
    v_mfma_f32_16x16x32_bf16 v[96:99], a[4:7], a[36:39], v[96:99]
    ds_read_b64_tr_b16 a[20:21], v8 offset:0
    v_mfma_f32_16x16x32_bf16 v[96:99], a[48:51], a[80:83], v[96:99]
    ds_read_b64_tr_b16 a[22:23], v8 offset:512
    s_waitcnt lgkmcnt(9)
    v_fmac_f32 v24, v156, v128
    v_mfma_f32_16x16x32_bf16 v[88:91], a[0:3], a[36:39], v[88:91]
    ds_read_b64_tr_b16 a[64:65], v8 offset:12288
    v_fmac_f32 v25, v156, v129
    v_mfma_f32_16x16x32_bf16 v[88:91], a[44:47], a[80:83], v[88:91]
    ds_read_b64_tr_b16 a[66:67], v8 offset:12800
    v_fmac_f32 v26, v156, v130
    v_mfma_f32_16x16x32_bf16 v[120:123], a[16:19], a[36:39], v[120:123]
    ds_read_b64_tr_b16 a[36:37], v8 offset:2048
    ds_read_b128 v[136:139], v22 offset:2304
    v_mfma_f32_16x16x32_bf16 v[120:123], a[60:63], a[80:83], v[120:123]
    ds_read_b64_tr_b16 a[38:39], v8 offset:2560
    ds_read_b128 v[140:143], v22 offset:2368
    v_mfma_f32_16x16x32_bf16 v[124:127], a[16:19], a[40:43], v[124:127]
    ds_read_b64_tr_b16 a[80:81], v8 offset:14336
    ds_read_b32 v144, v10 offset:2560
    v_mfma_f32_16x16x32_bf16 v[124:127], a[60:63], a[84:87], v[124:127]
    ds_read_b64_tr_b16 a[82:83], v8 offset:14848
    ds_read_b32 v145, v10 offset:2624
    v_mfma_f32_16x16x32_bf16 v[116:119], a[12:15], a[40:43], v[116:119]
    ds_read_b128 a[16:19], v6 offset:14336
    ds_read2_b32 v[146:147], v13 offset0:0 offset1:2
    v_mfma_f32_16x16x32_bf16 v[116:119], a[56:59], a[84:87], v[116:119]
    ds_read_b128 a[60:63], v7 offset:14336
    ds_read2_b32 v[148:149], v13 offset0:4 offset1:6
    v_mfma_f32_16x16x32_bf16 v[108:111], a[8:11], a[40:43], v[108:111]
    v_fmac_f32 v27, v156, v131
    s_waitcnt lgkmcnt(14)
    v_fmac_f32 v32, v157, v128
    v_mfma_f32_16x16x32_bf16 v[108:111], a[52:55], a[84:87], v[108:111]
    ds_read2_b32 v[150:151], v13 offset0:32 offset1:34
    v_fmac_f32 v33, v157, v129
    v_mfma_f32_16x16x32_bf16 v[100:103], a[4:7], a[40:43], v[100:103]
    ds_read2_b32 v[152:153], v13 offset0:36 offset1:38
    v_fmac_f32 v34, v157, v130
    v_mfma_f32_16x16x32_bf16 v[100:103], a[48:51], a[84:87], v[100:103]
    ds_read2_b32 v[154:155], v13 offset0:64 offset1:66
    v_fmac_f32 v35, v157, v131
    v_mfma_f32_16x16x32_bf16 v[92:95], a[0:3], a[40:43], v[92:95]
    ds_read_b64_tr_b16 a[40:41], v9 offset:2048
    ds_read2_b32 v[4:5], v13 offset0:68 offset1:70
    v_mfma_f32_16x16x32_bf16 v[92:95], a[44:47], a[84:87], v[92:95]
    ds_read_b64_tr_b16 a[42:43], v9 offset:2560
    ds_read2_b32 v[14:15], v13 offset0:96 offset1:98
    v_mfma_f32_16x16x32_bf16 v[56:59], a[28:31], a[0:3], v[56:59]
    ds_read_b64_tr_b16 a[84:85], v9 offset:14336
    ds_read2_b32 v[16:17], v13 offset0:100 offset1:102
    v_mfma_f32_16x16x32_bf16 v[56:59], a[72:75], a[44:47], v[56:59]
    ds_read_b64_tr_b16 a[86:87], v9 offset:14848
    v_fmac_f32 v40, v158, v128
    v_mfma_f32_16x16x32_bf16 v[60:63], a[32:35], a[0:3], v[60:63]
    ds_read_b128 a[0:3], v6 offset:0
    v_fmac_f32 v41, v158, v129
    v_mfma_f32_16x16x32_bf16 v[60:63], a[76:79], a[44:47], v[60:63]
    ds_read_b128 a[44:47], v7 offset:0
    v_fmac_f32 v42, v158, v130
    v_mfma_f32_16x16x32_bf16 v[68:71], a[32:35], a[4:7], v[68:71]
    v_fmac_f32 v43, v158, v131
    v_fmac_f32 v48, v159, v128
    v_mfma_f32_16x16x32_bf16 v[68:71], a[76:79], a[48:51], v[68:71]
    v_fmac_f32 v49, v159, v129
    v_fmac_f32 v50, v159, v130
    v_mfma_f32_16x16x32_bf16 v[64:67], a[28:31], a[4:7], v[64:67]
    ds_read_b128 a[4:7], v6 offset:4096
    v_fmac_f32 v51, v159, v131
    v_mfma_f32_16x16x32_bf16 v[64:67], a[72:75], a[48:51], v[64:67]
    ds_read_b128 a[48:51], v7 offset:4096
    v_fmac_f32 v28, v156, v132
    v_mfma_f32_16x16x32_bf16 v[72:75], a[28:31], a[8:11], v[72:75]
    v_fmac_f32 v29, v156, v133
    v_fmac_f32 v30, v156, v134
    v_mfma_f32_16x16x32_bf16 v[72:75], a[72:75], a[52:55], v[72:75]
    v_fmac_f32 v31, v156, v135
    v_fmac_f32 v36, v157, v132
    v_mfma_f32_16x16x32_bf16 v[76:79], a[32:35], a[8:11], v[76:79]
    ds_read_b128 a[8:11], v6 offset:8192
    v_fmac_f32 v37, v157, v133
    v_mfma_f32_16x16x32_bf16 v[76:79], a[76:79], a[52:55], v[76:79]
    ds_read_b128 a[52:55], v7 offset:8192
    v_fmac_f32 v38, v157, v134
    v_mfma_f32_16x16x32_bf16 v[84:87], a[32:35], a[12:15], v[84:87]
    ds_read_b64_tr_b16 a[32:33], v9 offset:1024
    v_fmac_f32 v39, v157, v135
    v_mfma_f32_16x16x32_bf16 v[84:87], a[76:79], a[56:59], v[84:87]
    ds_read_b64_tr_b16 a[34:35], v9 offset:1536
    v_fmac_f32 v44, v158, v132
    v_mfma_f32_16x16x32_bf16 v[80:83], a[28:31], a[12:15], v[80:83]
    ds_read_b128 a[12:15], v6 offset:12288
    v_fmac_f32 v45, v158, v133
    v_mfma_f32_16x16x32_bf16 v[80:83], a[72:75], a[56:59], v[80:83]
    ds_read_b128 a[56:59], v7 offset:12288
    v_fmac_f32 v46, v158, v134
    s_waitcnt lgkmcnt(8)
    v_mfma_f32_16x16x32_bf16 v[24:27], a[20:23], a[0:3], v[24:27]
    ds_read_b64_tr_b16 a[76:77], v9 offset:13312
    v_fmac_f32 v47, v158, v135
    v_mfma_f32_16x16x32_bf16 v[24:27], a[64:67], a[44:47], v[24:27]
    ds_read_b64_tr_b16 a[78:79], v9 offset:13824
    v_fmac_f32 v52, v159, v132
    v_mfma_f32_16x16x32_bf16 v[28:31], a[24:27], a[0:3], v[28:31]
    ds_read_b64_tr_b16 a[28:29], v8 offset:1024
    v_fmac_f32 v53, v159, v133
    v_mfma_f32_16x16x32_bf16 v[28:31], a[68:71], a[44:47], v[28:31]
    ds_read_b64_tr_b16 a[30:31], v8 offset:1536
    v_fmac_f32 v54, v159, v134
    s_waitcnt lgkmcnt(10)
    v_mfma_f32_16x16x32_bf16 v[36:39], a[24:27], a[4:7], v[36:39]
    ds_read_b64_tr_b16 a[72:73], v8 offset:13312
    v_fmac_f32 v55, v159, v135
    v_mfma_f32_16x16x32_bf16 v[36:39], a[68:71], a[48:51], v[36:39]
    ds_read_b64_tr_b16 a[74:75], v8 offset:13824
    v_fmac_f32 v88, v146, v144
    v_mfma_f32_16x16x32_bf16 v[32:35], a[20:23], a[4:7], v[32:35]
    s_mov_b64 exec, 1
    ds_add_u32 v2, v3 offset:12
    s_mov_b64 exec, -1
    v_mfma_f32_16x16x32_bf16 v[32:35], a[64:67], a[48:51], v[32:35]
    v_fmac_f32 v89, v147, v144
    v_fmac_f32 v90, v148, v144
    ds_read_b32 v128, v18 offset:0
    s_waitcnt lgkmcnt(12)
    v_mfma_f32_16x16x32_bf16 v[40:43], a[20:23], a[8:11], v[40:43]
    v_fmac_f32 v91, v149, v144
    v_fmac_f32 v92, v146, v145
    ds_read_b32 v129, v18 offset:128
    v_mfma_f32_16x16x32_bf16 v[40:43], a[64:67], a[52:55], v[40:43]
    v_fmac_f32 v93, v147, v145
    v_fmac_f32 v94, v148, v145
    ds_read_b32 v130, v18 offset:256
    v_mfma_f32_16x16x32_bf16 v[44:47], a[24:27], a[8:11], v[44:47]
    v_fmac_f32 v95, v149, v145
    v_fmac_f32 v96, v150, v144
    ds_read_b32 v131, v18 offset:384
    v_mfma_f32_16x16x32_bf16 v[44:47], a[68:71], a[52:55], v[44:47]
    v_fmac_f32 v97, v151, v144
    v_fmac_f32 v98, v152, v144
    ds_read_b128 v[132:135], v21
    s_waitcnt lgkmcnt(12)
    v_mfma_f32_16x16x32_bf16 v[52:55], a[24:27], a[12:15], v[52:55]
    v_fmac_f32 v99, v153, v144
    v_fmac_f32 v100, v150, v145
    ds_read_b128 v[6:9], v21 offset:1024
    v_mfma_f32_16x16x32_bf16 v[52:55], a[68:71], a[56:59], v[52:55]
    v_fmac_f32 v101, v151, v145
    v_fmac_f32 v102, v152, v145
    v_mfma_f32_16x16x32_bf16 v[48:51], a[20:23], a[12:15], v[48:51]
    v_fmac_f32 v103, v153, v145
    v_fmac_f32 v104, v154, v144
    v_mfma_f32_16x16x32_bf16 v[48:51], a[64:67], a[56:59], v[48:51]
    v_fmac_f32 v105, v155, v144
    v_fmac_f32 v106, v4, v144
    v_mfma_f32_16x16x32_bf16 v[112:115], a[12:15], a[36:39], v[112:115]
    v_fmac_f32 v108, v154, v145
    v_fmac_f32 v109, v155, v145
    v_mfma_f32_16x16x32_bf16 v[112:115], a[56:59], a[80:83], v[112:115]
    v_fmac_f32 v110, v4, v145
    v_fmac_f32 v111, v5, v145
    v_mfma_f32_16x16x32_bf16 v[104:107], a[8:11], a[36:39], v[104:107]
    v_fmac_f32 v116, v14, v145
    v_fmac_f32 v117, v15, v145
    v_mfma_f32_16x16x32_bf16 v[104:107], a[52:55], a[80:83], v[104:107]
    v_fmac_f32 v118, v16, v145
    v_fmac_f32 v119, v17, v145
    v_mfma_f32_16x16x32_bf16 v[96:99], a[4:7], a[36:39], v[96:99]
    v_fmac_f32 v56, v156, v136
    v_fmac_f32 v57, v156, v137
    v_mfma_f32_16x16x32_bf16 v[96:99], a[48:51], a[80:83], v[96:99]
    v_fmac_f32 v58, v156, v138
    v_fmac_f32 v59, v156, v139
    v_mfma_f32_16x16x32_bf16 v[88:91], a[0:3], a[36:39], v[88:91]
    v_fmac_f32 v112, v14, v144
    v_fmac_f32 v113, v15, v144
    v_mfma_f32_16x16x32_bf16 v[88:91], a[44:47], a[80:83], v[88:91]
    v_fmac_f32 v114, v16, v144
    v_fmac_f32 v115, v17, v144
    v_mfma_f32_16x16x32_bf16 v[120:123], a[16:19], a[36:39], v[120:123]
    v_fmac_f32 v107, v5, v144
    v_fmac_f32 v64, v157, v136
    v_mfma_f32_16x16x32_bf16 v[120:123], a[60:63], a[80:83], v[120:123]
    v_fmac_f32 v65, v157, v137
    v_fmac_f32 v66, v157, v138
    ds_read2_b32 v[146:147], v19 offset0:0 offset1:2
    v_mfma_f32_16x16x32_bf16 v[124:127], a[16:19], a[40:43], v[124:127]
    v_fmac_f32 v67, v157, v139
    v_fmac_f32 v72, v158, v136
    ds_read2_b32 v[148:149], v19 offset0:4 offset1:6
    v_mfma_f32_16x16x32_bf16 v[124:127], a[60:63], a[84:87], v[124:127]
    v_fmac_f32 v73, v158, v137
    v_fmac_f32 v74, v158, v138
    ds_read2_b32 v[150:151], v19 offset0:32 offset1:34
    v_mfma_f32_16x16x32_bf16 v[116:119], a[12:15], a[40:43], v[116:119]
    v_fmac_f32 v75, v158, v139
    v_fmac_f32 v80, v159, v136
    ds_read2_b32 v[152:153], v19 offset0:36 offset1:38
    v_mfma_f32_16x16x32_bf16 v[116:119], a[56:59], a[84:87], v[116:119]
    v_fmac_f32 v81, v159, v137
    v_fmac_f32 v82, v159, v138
    ds_read2_b32 v[154:155], v19 offset0:64 offset1:66
    v_mfma_f32_16x16x32_bf16 v[108:111], a[8:11], a[40:43], v[108:111]
    v_fmac_f32 v83, v159, v139
    v_fmac_f32 v60, v156, v140
    ds_read2_b32 v[4:5], v19 offset0:68 offset1:70
    v_mfma_f32_16x16x32_bf16 v[108:111], a[52:55], a[84:87], v[108:111]
    v_fmac_f32 v61, v156, v141
    v_fmac_f32 v62, v156, v142
    ds_read2_b32 v[14:15], v19 offset0:96 offset1:98
    v_mfma_f32_16x16x32_bf16 v[100:103], a[4:7], a[40:43], v[100:103]
    v_fmac_f32 v63, v156, v143
    v_fmac_f32 v68, v157, v140
    ds_read2_b32 v[16:17], v19 offset0:100 offset1:102
    v_mfma_f32_16x16x32_bf16 v[100:103], a[48:51], a[84:87], v[100:103]
    v_fmac_f32 v69, v157, v141
    v_fmac_f32 v70, v157, v142
    v_mfma_f32_16x16x32_bf16 v[92:95], a[0:3], a[40:43], v[92:95]
    v_fmac_f32 v71, v157, v143
    v_fmac_f32 v76, v158, v140
    v_mfma_f32_16x16x32_bf16 v[92:95], a[44:47], a[84:87], v[92:95]
    v_fmac_f32 v77, v158, v141
    v_fmac_f32 v78, v158, v142
    s_waitcnt lgkmcnt(14)
    v_mfma_f32_16x16x32_bf16 v[56:59], a[28:31], a[0:3], v[56:59]
    v_fmac_f32 v79, v158, v143
    v_fmac_f32 v84, v159, v140
    v_mfma_f32_16x16x32_bf16 v[56:59], a[72:75], a[44:47], v[56:59]
    v_fmac_f32 v85, v159, v141
    v_fmac_f32 v86, v159, v142
    v_mfma_f32_16x16x32_bf16 v[60:63], a[32:35], a[0:3], v[60:63]
    v_fmac_f32 v87, v159, v143
    v_mfma_f32_16x16x32_bf16 v[60:63], a[76:79], a[44:47], v[60:63]
    v_mfma_f32_16x16x32_bf16 v[68:71], a[32:35], a[4:7], v[68:71]
    v_mfma_f32_16x16x32_bf16 v[68:71], a[76:79], a[48:51], v[68:71]
    v_mfma_f32_16x16x32_bf16 v[64:67], a[28:31], a[4:7], v[64:67]
    v_mfma_f32_16x16x32_bf16 v[64:67], a[72:75], a[48:51], v[64:67]
    v_mfma_f32_16x16x32_bf16 v[72:75], a[28:31], a[8:11], v[72:75]
    v_mfma_f32_16x16x32_bf16 v[72:75], a[72:75], a[52:55], v[72:75]
    v_mfma_f32_16x16x32_bf16 v[76:79], a[32:35], a[8:11], v[76:79]
    v_mfma_f32_16x16x32_bf16 v[76:79], a[76:79], a[52:55], v[76:79]
    v_mfma_f32_16x16x32_bf16 v[84:87], a[32:35], a[12:15], v[84:87]
    v_mfma_f32_16x16x32_bf16 v[84:87], a[76:79], a[56:59], v[84:87]
    v_mfma_f32_16x16x32_bf16 v[80:83], a[28:31], a[12:15], v[80:83]
    v_mfma_f32_16x16x32_bf16 v[80:83], a[72:75], a[56:59], v[80:83]
    v_cvt_pk_bf16_f32 v24, v24, v25
    v_cvt_pk_bf16_f32 v25, v26, v27
    v_cvt_pk_bf16_f32 v26, v28, v29
    v_cvt_pk_bf16_f32 v27, v30, v31
    v_cvt_pk_bf16_f32 v32, v32, v33
    v_cvt_pk_bf16_f32 v33, v34, v35
    v_cvt_pk_bf16_f32 v34, v36, v37
    v_cvt_pk_bf16_f32 v35, v38, v39
    v_cvt_pk_bf16_f32 v40, v40, v41
    v_cvt_pk_bf16_f32 v41, v42, v43
    v_cvt_pk_bf16_f32 v42, v44, v45
    v_cvt_pk_bf16_f32 v43, v46, v47
    v_cvt_pk_bf16_f32 v48, v48, v49
    v_cvt_pk_bf16_f32 v49, v50, v51
    v_cvt_pk_bf16_f32 v50, v52, v53
    v_cvt_pk_bf16_f32 v51, v54, v55
    s_waitcnt lgkmcnt(8)
    v_fmac_f32 v120, v6, v144
    v_fmac_f32 v121, v7, v144
    v_fmac_f32 v122, v8, v144
    v_fmac_f32 v123, v9, v144
    v_fmac_f32 v124, v6, v145
    v_fmac_f32 v125, v7, v145
    v_fmac_f32 v126, v8, v145
    v_fmac_f32 v127, v9, v145
    v_mul_f32 v120, v132, v120
    v_mul_f32 v121, v133, v121
    v_mul_f32 v122, v134, v122
    v_mul_f32 v123, v135, v123
    v_mul_f32 v124, v132, v124
    v_mul_f32 v125, v133, v125
    v_mul_f32 v126, v134, v126
    v_mul_f32 v127, v135, v127
Lp1j_138:
    v_cvt_pk_bf16_f32 v120, v120, v121
    v_cvt_pk_bf16_f32 v121, v122, v123
    v_cvt_pk_bf16_f32 v122, v124, v125
    v_cvt_pk_bf16_f32 v123, v126, v127
    s_lshl_b32 s40, s33, 10
    s_add_u32 s40, s40, 135168
    v_add_u32 v11, s40, v1
    v_mov_b32 v9, 4048155338
    ds_write_b128 v11, v[120:123]
    s_mov_b64 exec, 1
    ds_add_u32 v2, v3
    s_mov_b64 exec, -1
    v_mul_f32 v56, v128, v56
    v_mul_f32 v57, v128, v57
    v_mul_f32 v58, v128, v58
    v_mul_f32 v59, v128, v59
    v_mul_f32 v60, v128, v60
    v_mul_f32 v61, v128, v61
    v_mul_f32 v62, v128, v62
    v_mul_f32 v63, v128, v63
    v_mul_f32 v124, s91, v128
    v_cvt_pk_bf16_f32 v56, v56, v57
    v_cvt_pk_bf16_f32 v57, v58, v59
    v_cvt_pk_bf16_f32 v58, v60, v61
    v_cvt_pk_bf16_f32 v59, v62, v63
    v_mul_f32 v64, v129, v64
    v_mul_f32 v65, v129, v65
    v_mul_f32 v66, v129, v66
    v_mul_f32 v67, v129, v67
    v_mul_f32 v68, v129, v68
    v_mul_f32 v69, v129, v69
    v_mul_f32 v70, v129, v70
    v_mul_f32 v71, v129, v71
    v_mul_f32 v125, s91, v129
    v_cvt_pk_bf16_f32 v64, v64, v65
    v_cvt_pk_bf16_f32 v65, v66, v67
    v_cvt_pk_bf16_f32 v66, v68, v69
    v_cvt_pk_bf16_f32 v67, v70, v71
    v_mul_f32 v72, v130, v72
    v_mul_f32 v73, v130, v73
    v_mul_f32 v74, v130, v74
    v_mul_f32 v75, v130, v75
    v_mul_f32 v76, v130, v76
    v_mul_f32 v77, v130, v77
    v_mul_f32 v78, v130, v78
    v_mul_f32 v79, v130, v79
    v_mul_f32 v126, s91, v130
    v_cvt_pk_bf16_f32 v72, v72, v73
    v_cvt_pk_bf16_f32 v73, v74, v75
    v_cvt_pk_bf16_f32 v74, v76, v77
    v_cvt_pk_bf16_f32 v75, v78, v79
    v_mul_f32 v80, v131, v80
    v_mul_f32 v81, v131, v81
    v_mul_f32 v82, v131, v82
    v_mul_f32 v83, v131, v83
    v_mul_f32 v84, v131, v84
    v_mul_f32 v85, v131, v85
    v_mul_f32 v86, v131, v86
    v_mul_f32 v87, v131, v87
    v_mul_f32 v127, s91, v131
    v_cvt_pk_bf16_f32 v80, v80, v81
    v_cvt_pk_bf16_f32 v81, v82, v83
    v_cvt_pk_bf16_f32 v82, v84, v85
    v_cvt_pk_bf16_f32 v83, v86, v87
    v_cndmask_b32 v36, v9, 0, s[72:73]
    v_cndmask_b32 v37, v9, 0, s[74:75]
    v_cndmask_b32 v38, v9, 0, s[76:77]
    v_cndmask_b32 v39, v9, 0, s[78:79]
    v_cndmask_b32 v44, v9, 0, s[80:81]
    v_cndmask_b32 v45, v9, 0, s[82:83]
    v_cndmask_b32 v46, v9, 0, s[84:85]
    v_cndmask_b32 v47, v9, 0, s[86:87]
    v_cndmask_b32 v28, v9, 0, s[4:5]
    v_cndmask_b32 v29, v9, 0, s[6:7]
    v_cndmask_b32 v30, v9, 0, s[8:9]
    v_cndmask_b32 v31, v9, 0, s[10:11]
    s_waitcnt lgkmcnt(2)
    v_mul_f32 v88, v146, v88
    v_mul_f32 v89, v147, v89
    v_mul_f32 v90, v148, v90
    v_mul_f32 v91, v149, v91
    v_mul_f32 v92, v146, v92
    v_mul_f32 v93, v147, v93
    v_mul_f32 v94, v148, v94
    v_mul_f32 v95, v149, v95
    v_mul_f32 v96, v150, v96
    v_mul_f32 v97, v151, v97
    v_mul_f32 v98, v152, v98
    v_mul_f32 v99, v153, v99
    v_mul_f32 v100, v150, v100
    v_mul_f32 v101, v151, v101
    v_mul_f32 v102, v152, v102
    v_mul_f32 v103, v153, v103
    v_mul_f32 v104, v154, v104
    v_mul_f32 v105, v155, v105
    v_mul_f32 v106, v4, v106
    v_mul_f32 v107, v5, v107
    v_mul_f32 v108, v154, v108
    v_mul_f32 v109, v155, v109
    v_mul_f32 v110, v4, v110
    v_mul_f32 v111, v5, v111
    v_mul_f32 v112, v14, v112
    v_mul_f32 v113, v15, v113
    v_mul_f32 v114, v16, v114
    v_mul_f32 v115, v17, v115
    v_mul_f32 v116, v14, v116
    v_mul_f32 v117, v15, v117
    v_mul_f32 v118, v16, v118
    v_mul_f32 v119, v17, v119
    s_lshl_b32 s40, s35, 11
    s_add_u32 s40, s40, 135168
    v_mov_b32 v10, 163776
    v_add_u32 v14, s40, v1
    ds_read_b32 v3, v10
    ds_read_b128 v[148:151], v14
    ds_read_b128 v[152:155], v14 offset:1024
    v_cvt_pk_bf16_f32 v132, v96, v97
    v_cvt_pk_bf16_f32 v133, v98, v99
    v_cvt_pk_bf16_f32 v142, v100, v101
    v_cvt_pk_bf16_f32 v143, v102, v103
    v_mfma_f32_16x16x32_bf16 v[96:99], v[56:59], v[32:35], v[36:39]
    v_mfma_f32_16x16x32_bf16 v[100:103], v[64:67], v[32:35], v[44:47]
    v_cvt_pk_bf16_f32 v134, v104, v105
    v_cvt_pk_bf16_f32 v135, v106, v107
    v_cvt_pk_bf16_f32 v144, v108, v109
    v_cvt_pk_bf16_f32 v145, v110, v111
    v_mfma_f32_16x16x32_bf16 v[104:107], v[64:67], v[40:43], v[36:39]
    v_mfma_f32_16x16x32_bf16 v[108:111], v[72:75], v[40:43], v[44:47]
    v_cvt_pk_bf16_f32 v136, v112, v113
    v_cvt_pk_bf16_f32 v137, v114, v115
    v_cvt_pk_bf16_f32 v146, v116, v117
    v_cvt_pk_bf16_f32 v147, v118, v119
    v_mfma_f32_16x16x32_bf16 v[112:115], v[72:75], v[48:51], v[36:39]
    v_mfma_f32_16x16x32_bf16 v[116:119], v[80:83], v[48:51], v[44:47]
    v_cvt_pk_bf16_f32 v130, v88, v89
    v_cvt_pk_bf16_f32 v131, v90, v91
    v_cvt_pk_bf16_f32 v140, v92, v93
    v_cvt_pk_bf16_f32 v141, v94, v95
    v_mfma_f32_16x16x32_bf16 v[92:95], v[56:59], v[24:27], v[44:47]
    s_add_u32 s4, s70, 4194304
    s_addc_u32 s5, s71, 0
    s_and_b32 s5, s5, 0xffff
    s_mov_b32 s6, 4194304
    s_mov_b32 s7, 0x20000
    s_mov_b64 s[46:47], 0
    s_mov_b32 s49, -2
    s_mov_b32 s37, 0
    s_mov_b32 s101, 0
    s_mov_b32 s39, 0
    s_mov_b64 s[80:81], 0
    s_mov_b64 s[82:83], 0
    v_mov_b32 v8, 163808
    v_mov_b32 v4, 0
    v_mov_b32 v5, 0
Lhw_141:
    s_waitcnt lgkmcnt(0)
    v_cmp_gt_u32 vcc, 4, v3
    s_cbranch_vccnz Lhok_142
    v_mfma_f32_16x16x32_bf16 v[88:91], v[148:151], v[24:27], v[28:31]
    v_and_b32 v128, s88, v152
    v_and_b32 v129, s88, v153
    v_and_b32 v138, s88, v154
    v_and_b32 v139, s88, v155
    v_mov_b32 v52, 0x3f803f80
    v_mov_b32 v53, 0x3f803f80
    v_mov_b32 v54, 0x3f803f80
    v_mov_b32 v55, 0x3f803f80
    v_max3_f32 v11, v96, v97, v98
    v_max3_f32 v15, v99, v100, v101
    v_max3_f32 v11, v11, v102, v103
    v_max_f32 v11, v11, v15
    v_max_f32 v15, v11, v15
    v_max3_f32 v12, v104, v105, v106
    v_max3_f32 v16, v107, v108, v109
    v_max3_f32 v12, v12, v110, v111
    v_max_f32 v12, v12, v16
    v_max_f32 v16, v12, v16
    v_max3_f32 v13, v112, v113, v114
    v_max3_f32 v17, v115, v116, v117
    v_max3_f32 v13, v13, v118, v119
    v_max_f32 v13, v13, v17
    v_max_f32 v17, v13, v17
    v_max3_f32 v10, v88, v89, v90
    v_max3_f32 v14, v91, v92, v93
    v_max3_f32 v10, v10, v94, v95
    v_max_f32 v10, v10, v14
    v_max_f32 v14, v10, v14
    v_permlane16_swap_b32 v11, v15
    v_permlane16_swap_b32 v12, v16
    v_permlane16_swap_b32 v13, v17
    v_permlane16_swap_b32 v10, v14
    v_max_f32 v11, v11, v15
    v_max_f32 v15, v11, v15
    v_max_f32 v12, v12, v16
    v_max_f32 v16, v12, v16
    v_max_f32 v13, v13, v17
    v_max_f32 v17, v13, v17
    v_max_f32 v10, v10, v14
    v_max_f32 v14, v10, v14
    v_permlane32_swap_b32 v11, v15
    v_permlane32_swap_b32 v12, v16
    v_permlane32_swap_b32 v13, v17
    v_permlane32_swap_b32 v10, v14
    v_max_f32 v11, v11, v15
    v_max_f32 v12, v12, v16
    v_max_f32 v13, v13, v17
    v_max_f32 v10, v10, v14
    v_mul_f32 v11, v125, v11
    v_mul_f32 v12, v126, v12
    v_mul_f32 v13, v127, v13
    v_mul_f32 v10, v124, v10
    v_fma_f32 v96, v96, v125, -v11
    v_fma_f32 v97, v97, v125, -v11
    v_fma_f32 v98, v98, v125, -v11
    v_fma_f32 v99, v99, v125, -v11
    v_fma_f32 v100, v100, v125, -v11
    v_fma_f32 v101, v101, v125, -v11
    v_fma_f32 v102, v102, v125, -v11
    v_fma_f32 v103, v103, v125, -v11
    v_exp_f32 v96, v96
    v_exp_f32 v97, v97
    v_exp_f32 v98, v98
    v_exp_f32 v99, v99
    v_exp_f32 v100, v100
    v_exp_f32 v101, v101
    v_exp_f32 v102, v102
    v_exp_f32 v103, v103
    v_cvt_pk_bf16_f32 v96, v96, v97
    v_cvt_pk_bf16_f32 v97, v98, v99
    v_cvt_pk_bf16_f32 v98, v100, v101
    v_cvt_pk_bf16_f32 v99, v102, v103
    s_nop 1
    v_mfma_f32_16x16x32_bf16 v[68:71], v[52:55], v[96:99], 0
    v_mfma_f32_16x16x32_bf16 v[32:35], v[130:133], v[96:99], 0
    v_mfma_f32_16x16x32_bf16 v[100:103], v[140:143], v[96:99], 0
    v_fma_f32 v104, v104, v126, -v12
    v_fma_f32 v105, v105, v126, -v12
    v_fma_f32 v106, v106, v126, -v12
    v_fma_f32 v107, v107, v126, -v12
    v_fma_f32 v108, v108, v126, -v12
    v_fma_f32 v109, v109, v126, -v12
    v_fma_f32 v110, v110, v126, -v12
    v_fma_f32 v111, v111, v126, -v12
    v_exp_f32 v104, v104
    v_exp_f32 v105, v105
    v_exp_f32 v106, v106
    v_exp_f32 v107, v107
    v_exp_f32 v108, v108
    v_exp_f32 v109, v109
    v_exp_f32 v110, v110
    v_exp_f32 v111, v111
    v_rcp_f32 v68, v68
    v_cvt_pk_bf16_f32 v104, v104, v105
    v_cvt_pk_bf16_f32 v105, v106, v107
    v_cvt_pk_bf16_f32 v106, v108, v109
    v_cvt_pk_bf16_f32 v107, v110, v111
    s_lshl_b32 s40, s32, 2
    s_lshl_b64 s[40:41], 4, s40
    v_mov_b32 v2, s40
    v_mov_b32 v3, s41
    v_mul_u32_u24 v9, 128, v0
    s_cmp_lt_u32 s33, 1
    s_cselect_b64 exec, 0xffff, 0
    buffer_atomic_add_x2 v[2:3], v9, s[20:23], s43 offen sc1
    s_mov_b64 exec, -1
    v_mfma_f32_16x16x32_bf16 v[76:79], v[52:55], v[104:107], 0
    v_mfma_f32_16x16x32_bf16 v[40:43], v[132:135], v[104:107], 0
    v_mfma_f32_16x16x32_bf16 v[108:111], v[142:145], v[104:107], 0
    v_mul_f32 v32, v68, v32
    v_mul_f32 v33, v68, v33
    v_mul_f32 v34, v68, v34
    v_mul_f32 v35, v68, v35
    v_mul_f32 v100, v68, v100
    v_mul_f32 v101, v68, v101
    v_mul_f32 v102, v68, v102
    v_mul_f32 v103, v68, v103
    v_cvt_pk_bf16_f32 v32, v32, v33
    v_cvt_pk_bf16_f32 v33, v34, v35
    v_cvt_pk_bf16_f32 v34, v100, v101
    v_cvt_pk_bf16_f32 v35, v102, v103
    v_min_u32 v32, -2, v32
    v_min_u32 v33, -2, v33
    v_min_u32 v34, -2, v34
    v_min_u32 v35, -2, v35
    buffer_store_dwordx4 v[32:35], v1, s[12:15], s44 offen offset:2048 sc1
    v_fma_f32 v112, v112, v127, -v13
    v_fma_f32 v113, v113, v127, -v13
    v_fma_f32 v114, v114, v127, -v13
    v_fma_f32 v115, v115, v127, -v13
    v_fma_f32 v116, v116, v127, -v13
    v_fma_f32 v117, v117, v127, -v13
    v_fma_f32 v118, v118, v127, -v13
    v_fma_f32 v119, v119, v127, -v13
    v_exp_f32 v112, v112
    v_exp_f32 v113, v113
    v_exp_f32 v114, v114
    v_exp_f32 v115, v115
    v_exp_f32 v116, v116
    v_exp_f32 v117, v117
    v_exp_f32 v118, v118
    v_exp_f32 v119, v119
    v_rcp_f32 v76, v76
    v_cvt_pk_bf16_f32 v112, v112, v113
    v_cvt_pk_bf16_f32 v113, v114, v115
    v_cvt_pk_bf16_f32 v114, v116, v117
    v_cvt_pk_bf16_f32 v115, v118, v119
    s_mov_b64 exec, 1
    buffer_atomic_umax_x2 v[4:5], off, s[20:23], s18 sc0 sc1
    s_mov_b64 exec, -1
    v_mfma_f32_16x16x32_bf16 v[84:87], v[52:55], v[112:115], 0
    v_mfma_f32_16x16x32_bf16 v[48:51], v[134:137], v[112:115], 0
    v_mfma_f32_16x16x32_bf16 v[116:119], v[144:147], v[112:115], 0
    v_mul_f32 v40, v76, v40
    v_mul_f32 v41, v76, v41
    v_mul_f32 v42, v76, v42
    v_mul_f32 v43, v76, v43
    v_mul_f32 v108, v76, v108
    v_mul_f32 v109, v76, v109
    v_mul_f32 v110, v76, v110
    v_mul_f32 v111, v76, v111
    v_cvt_pk_bf16_f32 v40, v40, v41
    v_cvt_pk_bf16_f32 v41, v42, v43
    v_cvt_pk_bf16_f32 v42, v108, v109
    v_cvt_pk_bf16_f32 v43, v110, v111
    v_min_u32 v40, -2, v40
    v_min_u32 v41, -2, v41
    v_min_u32 v42, -2, v42
    v_min_u32 v43, -2, v43
    buffer_store_dwordx4 v[40:43], v1, s[12:15], s45 offen offset:0 sc1
    v_fma_f32 v88, v88, v124, -v10
    v_fma_f32 v89, v89, v124, -v10
    v_fma_f32 v90, v90, v124, -v10
    v_fma_f32 v91, v91, v124, -v10
    v_fma_f32 v92, v92, v124, -v10
    v_fma_f32 v93, v93, v124, -v10
    v_fma_f32 v94, v94, v124, -v10
    v_fma_f32 v95, v95, v124, -v10
    v_exp_f32 v88, v88
    v_exp_f32 v89, v89
    v_exp_f32 v90, v90
    v_exp_f32 v91, v91
    v_exp_f32 v92, v92
    v_exp_f32 v93, v93
    v_exp_f32 v94, v94
    v_exp_f32 v95, v95
    v_rcp_f32 v84, v84
    v_cvt_pk_bf16_f32 v88, v88, v89
    v_cvt_pk_bf16_f32 v89, v90, v91
    v_cvt_pk_bf16_f32 v90, v92, v93
    v_cvt_pk_bf16_f32 v91, v94, v95
    s_nop 1
    v_mfma_f32_16x16x32_bf16 v[60:63], v[52:55], v[88:91], 0
    v_mfma_f32_16x16x32_bf16 v[24:27], v[128:131], v[88:91], 0
    v_mfma_f32_16x16x32_bf16 v[92:95], v[138:141], v[88:91], 0
    v_mul_f32 v48, v84, v48
    v_mul_f32 v49, v84, v49
    v_mul_f32 v50, v84, v50
    v_mul_f32 v51, v84, v51
    v_mul_f32 v116, v84, v116
    v_mul_f32 v117, v84, v117
    v_mul_f32 v118, v84, v118
    v_mul_f32 v119, v84, v119
    v_cvt_pk_bf16_f32 v48, v48, v49
    v_cvt_pk_bf16_f32 v49, v50, v51
    v_cvt_pk_bf16_f32 v50, v116, v117
    v_cvt_pk_bf16_f32 v51, v118, v119
    v_min_u32 v48, -2, v48
    v_min_u32 v49, -2, v49
    v_min_u32 v50, -2, v50
    v_min_u32 v51, -2, v51
    buffer_store_dwordx4 v[48:51], v1, s[12:15], s45 offen offset:2048 sc1
    v_rcp_f32 v60, v60
    s_nop 0
    v_mul_f32 v24, v60, v24
    v_mul_f32 v25, v60, v25
    v_mul_f32 v26, v60, v26
    v_mul_f32 v27, v60, v27
    v_mul_f32 v92, v60, v92
    v_mul_f32 v93, v60, v93
    v_mul_f32 v94, v60, v94
    v_mul_f32 v95, v60, v95
    v_cvt_pk_bf16_f32 v24, v24, v25
    v_cvt_pk_bf16_f32 v25, v26, v27
    v_cvt_pk_bf16_f32 v26, v92, v93
    v_cvt_pk_bf16_f32 v27, v94, v95
    v_min_u32 v24, -2, v24
    v_min_u32 v25, -2, v25
    v_min_u32 v26, -2, v26
    v_min_u32 v27, -2, v27
    buffer_store_dwordx4 v[24:27], v1, s[12:15], s44 offen offset:0 sc1
    ds_read_b64 v[6:7], v8
    s_mov_b32 s43, s18
    s_mov_b32 s44, 1077952576
    s_mov_b32 s45, 1077952576
    s_nop 0
    v_add_u32 v24, 1024, v1
    v_xor_b32 v25, 1024, v24
    s_waitcnt lgkmcnt(0)
    v_readfirstlane_b32 s46, v6
    v_readfirstlane_b32 s47, v7
    s_and_b64 s[40:41], s[44:45], s[46:47]
    s_cbranch_scc1 Lxs_143
    s_waitcnt vmcnt(3)
Lxs_143:
    s_branch LP2_23
LXB_24:
    s_and_b32 s80, s28, 1
    s_lshl_b32 s80, s80, 2
    s_and_b32 s81, s29, 3
    s_add_u32 s80, s80, s81
    s_lshr_b32 s81, s28, 1
    s_lshl_b32 s81, s81, 3
    s_lshr_b32 s40, s29, 2
    s_add_u32 s81, s81, s40
    s_and_b32 s83, s81, 1
    s_lshl_b32 s82, s80, 14
    s_lshl_b32 s30, s33, 12
    s_add_u32 s82, s82, s30
    v_add_u32 v6, s30, v1
    v_lshrrev_b32 v7, 2, v0
    v_mul_u32_u24 v7, 224, v7
    v_and_b32 v10, 3, v0
    v_lshl_add_u32 v7, v10, 3, v7
    s_cmp_ge_u32 s33, 2
    s_cselect_b32 s40, s62, s60
    s_cselect_b32 s41, s63, s61
    s_mov_b32 s8, s40
    s_and_b32 s9, s41, 0xffff
    s_mov_b32 s10, 7340032
    s_mov_b32 s11, 0x20000
    s_add_u32 s4, s70, 8388608
    s_addc_u32 s5, s71, 0
    s_and_b32 s5, s5, 0xffff
    s_mov_b32 s6, 4194304
    s_mov_b32 s7, 0x20000
    s_mov_b32 s16, s82
    s_mov_b32 s17, 0
    s_lshl_b32 s40, s34, 4
    s_mul_i32 s41, s81, 7
    v_add_u32 v10, 0, v0
    v_mul_u32_u24 v11, 4682, v10
    v_lshrrev_b32 v11, 16, v11
    v_mul_u32_u24 v12, 14, v11
    v_sub_u32 v12, v10, v12
    v_lshrrev_b32 v13, 1, v12
    v_add_u32 v13, s83, v13
    v_cmp_eq_u32 vcc, 7, v13
    v_add_u32 v11, s40, v11
    v_and_b32 v12, 1, v12
    v_cndmask_b32 v13, v13, 0, vcc
    v_add_u32 v13, s41, v13
    v_mul_u32_u24 v11, 7168, v11
    v_lshlrev_b32 v13, 5, v13
    v_lshlrev_b32 v12, 4, v12
    v_add3_u32 v16, v11, v13, v12
    v_subrev_u32 v16, 0, v16
    v_add_u32 v10, 64, v0
    v_mul_u32_u24 v11, 4682, v10
    v_lshrrev_b32 v11, 16, v11
    v_mul_u32_u24 v12, 14, v11
    v_sub_u32 v12, v10, v12
    v_lshrrev_b32 v13, 1, v12
    v_add_u32 v13, s83, v13
    v_cmp_eq_u32 vcc, 7, v13
    v_add_u32 v11, s40, v11
    v_and_b32 v12, 1, v12
    v_cndmask_b32 v13, v13, 0, vcc
    v_add_u32 v13, s41, v13
    v_mul_u32_u24 v11, 7168, v11
    v_lshlrev_b32 v13, 5, v13
    v_lshlrev_b32 v12, 4, v12
    v_add3_u32 v17, v11, v13, v12
    v_subrev_u32 v17, 1024, v17
    v_add_u32 v10, 128, v0
    v_mul_u32_u24 v11, 4682, v10
    v_lshrrev_b32 v11, 16, v11
    v_mul_u32_u24 v12, 14, v11
    v_sub_u32 v12, v10, v12
    v_lshrrev_b32 v13, 1, v12
    v_add_u32 v13, s83, v13
    v_cmp_eq_u32 vcc, 7, v13
    v_add_u32 v11, s40, v11
    v_and_b32 v12, 1, v12
    v_cndmask_b32 v13, v13, 0, vcc
    v_add_u32 v13, s41, v13
    v_mul_u32_u24 v11, 7168, v11
    v_lshlrev_b32 v13, 5, v13
    v_lshlrev_b32 v12, 4, v12
    v_add3_u32 v18, v11, v13, v12
    v_subrev_u32 v18, 2048, v18
    v_add_u32 v10, 192, v0
    v_mul_u32_u24 v11, 4682, v10
    v_lshrrev_b32 v11, 16, v11
    v_mul_u32_u24 v12, 14, v11
    v_sub_u32 v12, v10, v12
    v_lshrrev_b32 v13, 1, v12
    v_add_u32 v13, s83, v13
    v_cmp_eq_u32 vcc, 7, v13
    v_add_u32 v11, s40, v11
    v_and_b32 v12, 1, v12
    v_cndmask_b32 v13, v13, 0, vcc
    v_add_u32 v13, s41, v13
    v_mul_u32_u24 v11, 7168, v11
    v_lshlrev_b32 v13, 5, v13
    v_lshlrev_b32 v12, 4, v12
    v_add3_u32 v19, v11, v13, v12
    v_subrev_u32 v19, 3072, v19
    s_lshl_b32 s48, s33, 9
    s_sub_u32 s48, 16384, s48
    s_mul_i32 s30, s33, 3584
    s_add_u32 s18, s30, 57344
    s_mov_b32 m0, s18
    s_nop 0
    buffer_load_dwordx4 v16, s[8:11], s17 offen offset:0 lds
    buffer_load_dwordx4 v17, s[8:11], s17 offen offset:1024 lds
    buffer_load_dwordx4 v18, s[8:11], s17 offen offset:2048 lds
    s_mov_b32 exec_hi, 0
    buffer_load_dwordx4 v19, s[8:11], s17 offen offset:3072 lds
    s_mov_b32 exec_hi, -1
    s_add_u32 s17, s17, 229376
    s_add_u32 s18, s18, 14336
    s_cmp_ge_u32 s18, 86016
    s_cselect_b32 s18, s30, s18
    s_mov_b32 m0, s18
    s_nop 0
    buffer_load_dwordx4 v16, s[8:11], s17 offen offset:0 lds
    buffer_load_dwordx4 v17, s[8:11], s17 offen offset:1024 lds
    buffer_load_dwordx4 v18, s[8:11], s17 offen offset:2048 lds
    s_mov_b32 exec_hi, 0
    buffer_load_dwordx4 v19, s[8:11], s17 offen offset:3072 lds
    s_mov_b32 exec_hi, -1
    s_add_u32 s17, s17, 229376
    s_add_u32 s18, s18, 14336
    s_cmp_ge_u32 s18, 86016
    s_cselect_b32 s18, s30, s18
    s_mov_b32 m0, s18
    s_nop 0
    buffer_load_dwordx4 v16, s[8:11], s17 offen offset:0 lds
    buffer_load_dwordx4 v17, s[8:11], s17 offen offset:1024 lds
    buffer_load_dwordx4 v18, s[8:11], s17 offen offset:2048 lds
    s_mov_b32 exec_hi, 0
    buffer_load_dwordx4 v19, s[8:11], s17 offen offset:3072 lds
    s_mov_b32 exec_hi, -1
    s_add_u32 s17, s17, 229376
    s_add_u32 s18, s18, 14336
    s_cmp_ge_u32 s18, 86016
    s_cselect_b32 s18, s30, s18
    s_mov_b32 m0, s18
    s_nop 0
    buffer_load_dwordx4 v16, s[8:11], s17 offen offset:0 lds
    buffer_load_dwordx4 v17, s[8:11], s17 offen offset:1024 lds
    buffer_load_dwordx4 v18, s[8:11], s17 offen offset:2048 lds
    s_mov_b32 exec_hi, 0
    buffer_load_dwordx4 v19, s[8:11], s17 offen offset:3072 lds
    s_mov_b32 exec_hi, -1
    s_add_u32 s17, s17, 229376
    s_add_u32 s18, s18, 14336
    s_cmp_ge_u32 s18, 86016
    s_cselect_b32 s18, s30, s18
    s_mov_b32 s72, s50
    s_mov_b32 s73, s51
    s_mov_b32 s74, 0xe560
    s_mov_b32 s75, 0x20000
    s_lshl_b32 s79, s29, 12
    s_lshl_b32 s41, s33, 10
    s_add_u32 s79, s79, s41
    v_mov_b32 v144, 0
    v_mov_b32 v145, 0
    v_mov_b32 v146, 0
    v_mov_b32 v147, 0
    v_mov_b32 v148, 0
    v_mov_b32 v149, 0
    v_mov_b32 v150, 0
    v_mov_b32 v151, 0
    v_mov_b32 v152, 0x3f803f80
    v_mov_b32 v153, 0x3f803f80
    v_mov_b32 v154, 0x3f803f80
    v_mov_b32 v155, 0x3f803f80
    v_mov_b32 v28, 0
    v_mov_b32 v30, 163792
    ds_read_b32 v30, v30
    s_waitcnt lgkmcnt(0)
    v_readfirstlane_b32 s41, v30
    s_and_b32 s40, s80, 3
    s_lshl_b32 s89, 8736, s40
    s_lshl_b32 s44, s81, 2
    s_add_u32 s44, s44, s40
    s_lshl_b32 s44, s44, 11
    s_add_u32 s44, s44, 106496
    s_cmp_lg_u32 s41, 0
    s_cselect_b32 s89, 0, s89
    s_cselect_b32 s45, 2574, -1
    s_or_b32 s89, s89, 24
    s_and_b32 s45, s45, 2590
    s_mov_b32 s40, 155904
    s_cmp_eq_u32 s33, 1
    s_cselect_b32 s40, 155968, s40
    s_cmp_eq_u32 s33, 2
    s_cselect_b32 s40, 156032, s40
    s_cmp_eq_u32 s33, 3
    s_cselect_b32 s40, 156416, s40
    v_and_b32 v30, 48, v0
    v_add_u32 v30, s40, v30
    s_mov_b32 s40, 156672
    s_cmp_eq_u32 s33, 1
    s_cselect_b32 s40, 156672, s40
    s_cmp_eq_u32 s33, 2
    s_cselect_b32 s40, 156352, s40
    s_cmp_eq_u32 s33, 3
    s_cselect_b32 s40, 156480, s40
    v_and_b32 v31, 48, v0
    v_add_u32 v31, s40, v31
    s_bitcmp1_b32 s3, 0
    s_cselect_b32 s41, 3670016, 0
    s_lshl_b32 s40, s2, 9
    s_lshr_b32 s88, s3, 1
    s_lshl_b32 s88, s88, 7
    s_add_u32 s40, s40, s88
    s_add_u32 s40, s40, 60
    s_add_u32 s41, s41, s40
    s_add_u32 s86, s64, s41
    s_addc_u32 s87, s65, 0
    s_mov_b32 s88, 0
    s_lshl_b32 s40, s33, 6
    v_add_u32 v20, s40, v0
    v_lshlrev_b32 v21, 2, v20
    v_add_u32 v21, 153600, v21
    v_lshlrev_b32 v20, 3, v20
    s_lshl_b32 s84, s80, 11
    s_add_u32 s84, s84, 786432
    s_lshl_b32 s85, s80, 12
    s_and_b32 s41, s81, 31
    s_lshl_b32 s41, s41, 7
    s_add_u32 s85, s85, s41
    s_add_u32 s85, s85, 1310728
    s_add_u32 s43, s43, 4294934536
    s_cmp_lg_u32 s33, 0
    s_cselect_b32 s43, 2147418112, s43
    s_barrier
    s_setprio 1
    v_add_u32 v6, 86016, v6
    v_add_u32 v7, 57344, v7
    s_mov_b32 s36, 2
    s_mov_b32 s37, 4294934528
    s_mov_b32 s46, 28672
    s_mov_b32 s47, 4294909952
    s_mov_b32 s38, 16
    s_waitcnt vmcnt(8) lgkmcnt(0)
    s_barrier
    ds_read_b128 a[0:3], v6 offset:0
    ds_read_b128 a[48:51], v6 offset:16384
    ds_read_b64_tr_b16 a[16:17], v7 offset:128
    ds_read_b64_tr_b16 a[18:19], v7 offset:3712
    ds_read_b64_tr_b16 a[64:65], v7 offset:14464
    ds_read_b64_tr_b16 a[66:67], v7 offset:18048
    ds_read_b64_tr_b16 a[28:29], v7 offset:7296
    ds_read_b64_tr_b16 a[30:31], v7 offset:10880
    ds_read_b64_tr_b16 a[76:77], v7 offset:21632
    ds_read_b64_tr_b16 a[78:79], v7 offset:25216
    ds_read_b128 a[4:7], v6 offset:1024
    ds_read_b128 a[52:55], v6 offset:17408
    ds_read_b128 a[8:11], v6 offset:2048
    ds_read_b128 a[56:59], v6 offset:18432
    s_waitcnt lgkmcnt(10)
    v_mfma_f32_16x16x32_bf16 v[32:35], a[16:19], a[0:3], 0
    ds_read_b128 a[12:15], v6 offset:3072
    ds_read_b128 a[60:63], v6 offset:19456
    s_waitcnt lgkmcnt(10)
    v_mfma_f32_16x16x32_bf16 v[32:35], a[64:67], a[48:51], v[32:35]
    ds_read_b64_tr_b16 a[20:21], v7 offset:160
    s_waitcnt lgkmcnt(9)
    v_mfma_f32_16x16x32_bf16 v[80:83], a[28:31], a[0:3], 0
    ds_read_b64_tr_b16 a[22:23], v7 offset:3744
    ds_read_b64_tr_b16 a[68:69], v7 offset:14496
    s_waitcnt lgkmcnt(9)
    v_mfma_f32_16x16x32_bf16 v[80:83], a[76:79], a[48:51], v[80:83]
    ds_read_b64_tr_b16 a[70:71], v7 offset:18080
    s_waitcnt lgkmcnt(9)
    v_mfma_f32_16x16x32_bf16 v[84:87], a[28:31], a[4:7], 0
    ds_read_b64_tr_b16 a[32:33], v7 offset:7328
    ds_read_b64_tr_b16 a[34:35], v7 offset:10912
    s_waitcnt lgkmcnt(10)
    v_mfma_f32_16x16x32_bf16 v[84:87], a[76:79], a[52:55], v[84:87]
    ds_read_b64_tr_b16 a[80:81], v7 offset:21664
    v_mfma_f32_16x16x32_bf16 v[36:39], a[16:19], a[4:7], 0
    ds_read_b64_tr_b16 a[82:83], v7 offset:25248
    ds_read_b64_tr_b16 a[24:25], v7 offset:192
    v_mfma_f32_16x16x32_bf16 v[36:39], a[64:67], a[52:55], v[36:39]
    ds_read_b64_tr_b16 a[26:27], v7 offset:3776
    s_waitcnt lgkmcnt(13)
    v_mfma_f32_16x16x32_bf16 v[40:43], a[16:19], a[8:11], 0
    ds_read_b64_tr_b16 a[72:73], v7 offset:14528
    ds_read_b64_tr_b16 a[74:75], v7 offset:18112
    s_waitcnt lgkmcnt(14)
    v_mfma_f32_16x16x32_bf16 v[40:43], a[64:67], a[56:59], v[40:43]
    ds_read_b64_tr_b16 a[36:37], v7 offset:7360
    v_mfma_f32_16x16x32_bf16 v[88:91], a[28:31], a[8:11], 0
    ds_read_b64_tr_b16 a[38:39], v7 offset:10944
    ds_read_b64_tr_b16 a[84:85], v7 offset:21696
    v_mfma_f32_16x16x32_bf16 v[88:91], a[76:79], a[56:59], v[88:91]
    ds_read_b64_tr_b16 a[86:87], v7 offset:25280
    s_waitcnt lgkmcnt(14)
    v_mfma_f32_16x16x32_bf16 v[92:95], a[28:31], a[12:15], 0
    v_mfma_f32_16x16x32_bf16 v[92:95], a[76:79], a[60:63], v[92:95]
    v_mfma_f32_16x16x32_bf16 v[44:47], a[16:19], a[12:15], 0
    v_mfma_f32_16x16x32_bf16 v[44:47], a[64:67], a[60:63], v[44:47]
    s_mov_b32 m0, s18
    s_nop 0
    buffer_load_dwordx4 v16, s[8:11], s17 offen offset:0 lds
    buffer_load_dwordx4 v17, s[8:11], s17 offen offset:1024 lds
    buffer_load_dwordx4 v18, s[8:11], s17 offen offset:2048 lds
    s_mov_b32 exec_hi, 0
    buffer_load_dwordx4 v19, s[8:11], s17 offen offset:3072 lds
    s_mov_b32 exec_hi, -1
    s_add_u32 s17, s17, 229376
    s_add_u32 s18, s18, 14336
    s_cmp_ge_u32 s18, 86016
    s_cselect_b32 s18, s30, s18
    s_mov_b32 m0, s18
    s_nop 0
    buffer_load_dwordx4 v16, s[8:11], s17 offen offset:0 lds
    buffer_load_dwordx4 v17, s[8:11], s17 offen offset:1024 lds
    buffer_load_dwordx4 v18, s[8:11], s17 offen offset:2048 lds
    s_mov_b32 exec_hi, 0
    buffer_load_dwordx4 v19, s[8:11], s17 offen offset:3072 lds
    s_mov_b32 exec_hi, -1
    s_add_u32 s17, s17, 229376
    s_add_u32 s18, s18, 14336
    s_cmp_ge_u32 s18, 86016
    s_cselect_b32 s18, s30, s18
    s_bitcmp1_b32 s89, s38
    s_cbranch_scc0 Lxe_148
    s_waitcnt lgkmcnt(0)
    s_bitcmp1_b32 s33, 1
    s_cbranch_scc1 Lxh_146
    s_bitcmp1_b32 s33, 0
    s_cbranch_scc1 Lx1_145
    v_mfma_f32_16x16x32_bf16 v[144:147], a[16:19], v[152:155], v[144:147]
    v_mfma_f32_16x16x32_bf16 v[144:147], a[64:67], v[152:155], v[144:147]
    s_branch Lxe_148
Lx1_145:
    v_mfma_f32_16x16x32_bf16 v[144:147], a[20:23], v[152:155], v[144:147]
    v_mfma_f32_16x16x32_bf16 v[144:147], a[68:71], v[152:155], v[144:147]
    s_branch Lxe_148
Lxh_146:
    s_bitcmp1_b32 s33, 0
    s_cbranch_scc1 Lx3_147
    v_mfma_f32_16x16x32_bf16 v[144:147], a[24:27], v[152:155], v[144:147]
    v_mfma_f32_16x16x32_bf16 v[144:147], a[72:75], v[152:155], v[144:147]
    v_mfma_f32_16x16x32_bf16 v[148:151], a[28:31], v[152:155], v[148:151]
    v_mfma_f32_16x16x32_bf16 v[148:151], a[76:79], v[152:155], v[148:151]
    s_branch Lxe_148
Lx3_147:
    v_mfma_f32_16x16x32_bf16 v[144:147], a[32:35], v[152:155], v[144:147]
    v_mfma_f32_16x16x32_bf16 v[144:147], a[80:83], v[152:155], v[144:147]
    v_mfma_f32_16x16x32_bf16 v[148:151], a[36:39], v[152:155], v[148:151]
    v_mfma_f32_16x16x32_bf16 v[148:151], a[84:87], v[152:155], v[148:151]
Lxe_148:
    s_add_u32 s36, s36, 1
    s_cmp_ge_u32 s36, 3
    s_cselect_b32 s19, s47, s46
    s_cselect_b32 s36, 0, s36
    s_sub_u32 s37, 0, s37
    v_add_u32 v6, s37, v6
    v_add_u32 v7, s19, v7
    s_sub_u32 s38, s38, 1
    s_waitcnt vmcnt(8) lgkmcnt(0)
    s_barrier
    v_mfma_f32_16x16x32_bf16 v[60:63], a[20:23], a[12:15], 0
    ds_read_b64_tr_b16 a[16:17], v7 offset:128
    s_load_dwordx2 s[90:91], s[86:87], s88
    s_add_u32 s88, s88, 131072
    s_min_u32 s88, s88, 3538944
    v_mfma_f32_16x16x32_bf16 v[60:63], a[68:71], a[60:63], v[60:63]
    ds_read_b64_tr_b16 a[18:19], v7 offset:3712
    s_load_dwordx2 s[90:91], s[86:87], s88
    s_add_u32 s88, s88, 131072
    s_min_u32 s88, s88, 3538944
    v_mfma_f32_16x16x32_bf16 v[56:59], a[20:23], a[8:11], 0
    ds_read_b64_tr_b16 a[64:65], v7 offset:14464
    v_mfma_f32_16x16x32_bf16 v[56:59], a[68:71], a[56:59], v[56:59]
    ds_read_b64_tr_b16 a[66:67], v7 offset:18048
    v_mfma_f32_16x16x32_bf16 v[52:55], a[20:23], a[4:7], 0
    ds_read_b64_tr_b16 a[28:29], v7 offset:7296
    v_mfma_f32_16x16x32_bf16 v[52:55], a[68:71], a[52:55], v[52:55]
    ds_read_b64_tr_b16 a[30:31], v7 offset:10880
    v_mfma_f32_16x16x32_bf16 v[48:51], a[20:23], a[0:3], 0
    ds_read_b64_tr_b16 a[76:77], v7 offset:21632
    v_mfma_f32_16x16x32_bf16 v[48:51], a[68:71], a[48:51], v[48:51]
    ds_read_b64_tr_b16 a[78:79], v7 offset:25216
    v_mfma_f32_16x16x32_bf16 v[96:99], a[32:35], a[0:3], 0
    ds_read_b64_tr_b16 a[20:21], v7 offset:160
    v_mfma_f32_16x16x32_bf16 v[96:99], a[80:83], a[48:51], v[96:99]
    ds_read_b64_tr_b16 a[22:23], v7 offset:3744
    v_mfma_f32_16x16x32_bf16 v[100:103], a[32:35], a[4:7], 0
    ds_read_b64_tr_b16 a[68:69], v7 offset:14496
    v_mfma_f32_16x16x32_bf16 v[100:103], a[80:83], a[52:55], v[100:103]
    ds_read_b64_tr_b16 a[70:71], v7 offset:18080
    v_mfma_f32_16x16x32_bf16 v[104:107], a[32:35], a[8:11], 0
    v_mfma_f32_16x16x32_bf16 v[104:107], a[80:83], a[56:59], v[104:107]
    v_mfma_f32_16x16x32_bf16 v[108:111], a[32:35], a[12:15], 0
    v_mfma_f32_16x16x32_bf16 v[108:111], a[80:83], a[60:63], v[108:111]
    ds_read_b64_tr_b16 a[32:33], v7 offset:7328
    v_mfma_f32_16x16x32_bf16 v[64:67], a[24:27], a[0:3], 0
    ds_read_b64_tr_b16 a[34:35], v7 offset:10912
    v_mfma_f32_16x16x32_bf16 v[64:67], a[72:75], a[48:51], v[64:67]
    ds_read_b64_tr_b16 a[80:81], v7 offset:21664
    v_mfma_f32_16x16x32_bf16 v[112:115], a[36:39], a[0:3], 0
    ds_read_b64_tr_b16 a[82:83], v7 offset:25248
    v_mfma_f32_16x16x32_bf16 v[112:115], a[84:87], a[48:51], v[112:115]
    ds_read_b128 a[0:3], v6 offset:0
    ds_read_b128 a[48:51], v6 offset:16384
    v_mfma_f32_16x16x32_bf16 v[116:119], a[36:39], a[4:7], 0
    v_mfma_f32_16x16x32_bf16 v[116:119], a[84:87], a[52:55], v[116:119]
    v_mfma_f32_16x16x32_bf16 v[68:71], a[24:27], a[4:7], 0
    v_mfma_f32_16x16x32_bf16 v[68:71], a[72:75], a[52:55], v[68:71]
    ds_read_b128 a[4:7], v6 offset:1024
    ds_read_b128 a[52:55], v6 offset:17408
    v_mfma_f32_16x16x32_bf16 v[72:75], a[24:27], a[8:11], 0
    v_mfma_f32_16x16x32_bf16 v[72:75], a[72:75], a[56:59], v[72:75]
    v_mfma_f32_16x16x32_bf16 v[120:123], a[36:39], a[8:11], 0
    v_mfma_f32_16x16x32_bf16 v[120:123], a[84:87], a[56:59], v[120:123]
    ds_read_b128 a[8:11], v6 offset:2048
    ds_read_b128 a[56:59], v6 offset:18432
    v_mfma_f32_16x16x32_bf16 v[124:127], a[36:39], a[12:15], 0
    v_mfma_f32_16x16x32_bf16 v[124:127], a[84:87], a[60:63], v[124:127]
    v_mfma_f32_16x16x32_bf16 v[76:79], a[24:27], a[12:15], 0
    v_mfma_f32_16x16x32_bf16 v[76:79], a[72:75], a[60:63], v[76:79]
    ds_read_b128 a[12:15], v6 offset:3072
    ds_read_b128 a[60:63], v6 offset:19456
    s_waitcnt lgkmcnt(7)
    v_mfma_f32_16x16x32_bf16 v[32:35], a[16:19], a[0:3], v[32:35]
    ds_read_b64_tr_b16 a[24:25], v7 offset:192
    s_waitcnt lgkmcnt(7)
    v_mfma_f32_16x16x32_bf16 v[32:35], a[64:67], a[48:51], v[32:35]
    ds_read_b64_tr_b16 a[26:27], v7 offset:3776
    v_mfma_f32_16x16x32_bf16 v[80:83], a[28:31], a[0:3], v[80:83]
    ds_read_b64_tr_b16 a[72:73], v7 offset:14528
    v_mfma_f32_16x16x32_bf16 v[80:83], a[76:79], a[48:51], v[80:83]
    ds_read_b64_tr_b16 a[74:75], v7 offset:18112
    s_waitcnt lgkmcnt(9)
    v_mfma_f32_16x16x32_bf16 v[84:87], a[28:31], a[4:7], v[84:87]
    ds_read_b64_tr_b16 a[36:37], v7 offset:7360
    s_waitcnt lgkmcnt(9)
    v_mfma_f32_16x16x32_bf16 v[84:87], a[76:79], a[52:55], v[84:87]
    ds_read_b64_tr_b16 a[38:39], v7 offset:10944
    v_mfma_f32_16x16x32_bf16 v[36:39], a[16:19], a[4:7], v[36:39]
    ds_read_b64_tr_b16 a[84:85], v7 offset:21696
    v_mfma_f32_16x16x32_bf16 v[36:39], a[64:67], a[52:55], v[36:39]
    ds_read_b64_tr_b16 a[86:87], v7 offset:25280
    s_waitcnt lgkmcnt(11)
    v_mfma_f32_16x16x32_bf16 v[40:43], a[16:19], a[8:11], v[40:43]
    s_waitcnt lgkmcnt(10)
    v_mfma_f32_16x16x32_bf16 v[40:43], a[64:67], a[56:59], v[40:43]
    v_mfma_f32_16x16x32_bf16 v[88:91], a[28:31], a[8:11], v[88:91]
    v_mfma_f32_16x16x32_bf16 v[88:91], a[76:79], a[56:59], v[88:91]
    s_waitcnt lgkmcnt(9)
    v_mfma_f32_16x16x32_bf16 v[92:95], a[28:31], a[12:15], v[92:95]
    s_waitcnt lgkmcnt(8)
    v_mfma_f32_16x16x32_bf16 v[92:95], a[76:79], a[60:63], v[92:95]
    v_mfma_f32_16x16x32_bf16 v[44:47], a[16:19], a[12:15], v[44:47]
    v_mfma_f32_16x16x32_bf16 v[44:47], a[64:67], a[60:63], v[44:47]
    s_mov_b32 m0, s18
    s_nop 0
    buffer_load_dwordx4 v16, s[8:11], s17 offen offset:0 lds
    buffer_load_dwordx4 v17, s[8:11], s17 offen offset:1024 lds
    buffer_load_dwordx4 v18, s[8:11], s17 offen offset:2048 lds
    s_mov_b32 exec_hi, 0
    buffer_load_dwordx4 v19, s[8:11], s17 offen offset:3072 lds
    s_mov_b32 exec_hi, -1
    s_add_u32 s17, s17, 229376
    s_add_u32 s18, s18, 14336
    s_cmp_ge_u32 s18, 86016
    s_cselect_b32 s18, s30, s18
    s_mov_b32 m0, s18
    s_nop 0
    buffer_load_dwordx4 v16, s[8:11], s17 offen offset:0 lds
    buffer_load_dwordx4 v17, s[8:11], s17 offen offset:1024 lds
    buffer_load_dwordx4 v18, s[8:11], s17 offen offset:2048 lds
    s_mov_b32 exec_hi, 0
    buffer_load_dwordx4 v19, s[8:11], s17 offen offset:3072 lds
    s_mov_b32 exec_hi, -1
    s_add_u32 s17, s17, 229376
    s_add_u32 s18, s18, 14336
    s_cmp_ge_u32 s18, 86016
    s_cselect_b32 s18, s30, s18
    s_bitcmp1_b32 s89, s38
    s_cbranch_scc0 Lxe_152
    s_waitcnt lgkmcnt(0)
    s_bitcmp1_b32 s33, 1
    s_cbranch_scc1 Lxh_150
    s_bitcmp1_b32 s33, 0
    s_cbranch_scc1 Lx1_149
    v_mfma_f32_16x16x32_bf16 v[144:147], a[16:19], v[152:155], v[144:147]
    v_mfma_f32_16x16x32_bf16 v[144:147], a[64:67], v[152:155], v[144:147]
    s_branch Lxe_152
Lx1_149:
    v_mfma_f32_16x16x32_bf16 v[144:147], a[20:23], v[152:155], v[144:147]
    v_mfma_f32_16x16x32_bf16 v[144:147], a[68:71], v[152:155], v[144:147]
    s_branch Lxe_152
Lxh_150:
    s_bitcmp1_b32 s33, 0
    s_cbranch_scc1 Lx3_151
    v_mfma_f32_16x16x32_bf16 v[144:147], a[24:27], v[152:155], v[144:147]
    v_mfma_f32_16x16x32_bf16 v[144:147], a[72:75], v[152:155], v[144:147]
    v_mfma_f32_16x16x32_bf16 v[148:151], a[28:31], v[152:155], v[148:151]
    v_mfma_f32_16x16x32_bf16 v[148:151], a[76:79], v[152:155], v[148:151]
    s_branch Lxe_152
Lx3_151:
    v_mfma_f32_16x16x32_bf16 v[144:147], a[32:35], v[152:155], v[144:147]
    v_mfma_f32_16x16x32_bf16 v[144:147], a[80:83], v[152:155], v[144:147]
    v_mfma_f32_16x16x32_bf16 v[148:151], a[36:39], v[152:155], v[148:151]
    v_mfma_f32_16x16x32_bf16 v[148:151], a[84:87], v[152:155], v[148:151]
Lxe_152:
    s_add_u32 s36, s36, 1
    s_cmp_ge_u32 s36, 3
    s_cselect_b32 s19, s47, s46
    s_cselect_b32 s36, 0, s36
    s_sub_u32 s37, 0, s37
    v_add_u32 v6, s37, v6
    v_add_u32 v7, s19, v7
    s_sub_u32 s38, s38, 1
Lp3loop_144:
    s_bitcmp1_b32 s45, s38
    s_cbranch_scc1 Lhk_155
    s_waitcnt vmcnt(8) lgkmcnt(0)
Lhkb_156:
    s_barrier
    v_mfma_f32_16x16x32_bf16 v[60:63], a[20:23], a[12:15], v[60:63]
    ds_read_b64_tr_b16 a[16:17], v7 offset:128
    s_load_dwordx2 s[90:91], s[86:87], s88
    s_add_u32 s88, s88, 131072
    s_min_u32 s88, s88, 3538944
    v_mfma_f32_16x16x32_bf16 v[60:63], a[68:71], a[60:63], v[60:63]
    ds_read_b64_tr_b16 a[18:19], v7 offset:3712
    s_load_dwordx2 s[90:91], s[86:87], s88
    s_add_u32 s88, s88, 131072
    s_min_u32 s88, s88, 3538944
    v_mfma_f32_16x16x32_bf16 v[56:59], a[20:23], a[8:11], v[56:59]
    ds_read_b64_tr_b16 a[64:65], v7 offset:14464
    v_mfma_f32_16x16x32_bf16 v[56:59], a[68:71], a[56:59], v[56:59]
    ds_read_b64_tr_b16 a[66:67], v7 offset:18048
    v_mfma_f32_16x16x32_bf16 v[52:55], a[20:23], a[4:7], v[52:55]
    ds_read_b64_tr_b16 a[28:29], v7 offset:7296
    v_mfma_f32_16x16x32_bf16 v[52:55], a[68:71], a[52:55], v[52:55]
    ds_read_b64_tr_b16 a[30:31], v7 offset:10880
    v_mfma_f32_16x16x32_bf16 v[48:51], a[20:23], a[0:3], v[48:51]
    ds_read_b64_tr_b16 a[76:77], v7 offset:21632
    v_mfma_f32_16x16x32_bf16 v[48:51], a[68:71], a[48:51], v[48:51]
    ds_read_b64_tr_b16 a[78:79], v7 offset:25216
    v_mfma_f32_16x16x32_bf16 v[96:99], a[32:35], a[0:3], v[96:99]
    ds_read_b64_tr_b16 a[20:21], v7 offset:160
    v_mfma_f32_16x16x32_bf16 v[96:99], a[80:83], a[48:51], v[96:99]
    ds_read_b64_tr_b16 a[22:23], v7 offset:3744
    v_mfma_f32_16x16x32_bf16 v[100:103], a[32:35], a[4:7], v[100:103]
    ds_read_b64_tr_b16 a[68:69], v7 offset:14496
    v_mfma_f32_16x16x32_bf16 v[100:103], a[80:83], a[52:55], v[100:103]
    ds_read_b64_tr_b16 a[70:71], v7 offset:18080
    v_mfma_f32_16x16x32_bf16 v[104:107], a[32:35], a[8:11], v[104:107]
    v_mfma_f32_16x16x32_bf16 v[104:107], a[80:83], a[56:59], v[104:107]
    v_mfma_f32_16x16x32_bf16 v[108:111], a[32:35], a[12:15], v[108:111]
    v_mfma_f32_16x16x32_bf16 v[108:111], a[80:83], a[60:63], v[108:111]
    ds_read_b64_tr_b16 a[32:33], v7 offset:7328
    v_mfma_f32_16x16x32_bf16 v[64:67], a[24:27], a[0:3], v[64:67]
    ds_read_b64_tr_b16 a[34:35], v7 offset:10912
    v_mfma_f32_16x16x32_bf16 v[64:67], a[72:75], a[48:51], v[64:67]
    ds_read_b64_tr_b16 a[80:81], v7 offset:21664
    v_mfma_f32_16x16x32_bf16 v[112:115], a[36:39], a[0:3], v[112:115]
    ds_read_b64_tr_b16 a[82:83], v7 offset:25248
    v_mfma_f32_16x16x32_bf16 v[112:115], a[84:87], a[48:51], v[112:115]
    ds_read_b128 a[0:3], v6 offset:0
    ds_read_b128 a[48:51], v6 offset:16384
    v_mfma_f32_16x16x32_bf16 v[116:119], a[36:39], a[4:7], v[116:119]
    v_mfma_f32_16x16x32_bf16 v[116:119], a[84:87], a[52:55], v[116:119]
    v_mfma_f32_16x16x32_bf16 v[68:71], a[24:27], a[4:7], v[68:71]
    v_mfma_f32_16x16x32_bf16 v[68:71], a[72:75], a[52:55], v[68:71]
    ds_read_b128 a[4:7], v6 offset:1024
    ds_read_b128 a[52:55], v6 offset:17408
    v_mfma_f32_16x16x32_bf16 v[72:75], a[24:27], a[8:11], v[72:75]
    v_mfma_f32_16x16x32_bf16 v[72:75], a[72:75], a[56:59], v[72:75]
    v_mfma_f32_16x16x32_bf16 v[120:123], a[36:39], a[8:11], v[120:123]
    v_mfma_f32_16x16x32_bf16 v[120:123], a[84:87], a[56:59], v[120:123]
    ds_read_b128 a[8:11], v6 offset:2048
    ds_read_b128 a[56:59], v6 offset:18432
    v_mfma_f32_16x16x32_bf16 v[124:127], a[36:39], a[12:15], v[124:127]
    v_mfma_f32_16x16x32_bf16 v[124:127], a[84:87], a[60:63], v[124:127]
    v_mfma_f32_16x16x32_bf16 v[76:79], a[24:27], a[12:15], v[76:79]
    v_mfma_f32_16x16x32_bf16 v[76:79], a[72:75], a[60:63], v[76:79]
    ds_read_b128 a[12:15], v6 offset:3072
    ds_read_b128 a[60:63], v6 offset:19456
    s_waitcnt lgkmcnt(7)
    v_mfma_f32_16x16x32_bf16 v[32:35], a[16:19], a[0:3], v[32:35]
    ds_read_b64_tr_b16 a[24:25], v7 offset:192
    s_waitcnt lgkmcnt(7)
    v_mfma_f32_16x16x32_bf16 v[32:35], a[64:67], a[48:51], v[32:35]
    ds_read_b64_tr_b16 a[26:27], v7 offset:3776
    v_mfma_f32_16x16x32_bf16 v[80:83], a[28:31], a[0:3], v[80:83]
    ds_read_b64_tr_b16 a[72:73], v7 offset:14528
    v_mfma_f32_16x16x32_bf16 v[80:83], a[76:79], a[48:51], v[80:83]
    ds_read_b64_tr_b16 a[74:75], v7 offset:18112
    s_waitcnt lgkmcnt(9)
    v_mfma_f32_16x16x32_bf16 v[84:87], a[28:31], a[4:7], v[84:87]
    ds_read_b64_tr_b16 a[36:37], v7 offset:7360
    s_waitcnt lgkmcnt(9)
    v_mfma_f32_16x16x32_bf16 v[84:87], a[76:79], a[52:55], v[84:87]
    ds_read_b64_tr_b16 a[38:39], v7 offset:10944
    v_mfma_f32_16x16x32_bf16 v[36:39], a[16:19], a[4:7], v[36:39]
    ds_read_b64_tr_b16 a[84:85], v7 offset:21696
    v_mfma_f32_16x16x32_bf16 v[36:39], a[64:67], a[52:55], v[36:39]
    ds_read_b64_tr_b16 a[86:87], v7 offset:25280
    s_waitcnt lgkmcnt(11)
    v_mfma_f32_16x16x32_bf16 v[40:43], a[16:19], a[8:11], v[40:43]
    s_waitcnt lgkmcnt(10)
    v_mfma_f32_16x16x32_bf16 v[40:43], a[64:67], a[56:59], v[40:43]
    v_mfma_f32_16x16x32_bf16 v[88:91], a[28:31], a[8:11], v[88:91]
    v_mfma_f32_16x16x32_bf16 v[88:91], a[76:79], a[56:59], v[88:91]
    s_waitcnt lgkmcnt(9)
    v_mfma_f32_16x16x32_bf16 v[92:95], a[28:31], a[12:15], v[92:95]
    s_waitcnt lgkmcnt(8)
    v_mfma_f32_16x16x32_bf16 v[92:95], a[76:79], a[60:63], v[92:95]
    v_mfma_f32_16x16x32_bf16 v[44:47], a[16:19], a[12:15], v[44:47]
    v_mfma_f32_16x16x32_bf16 v[44:47], a[64:67], a[60:63], v[44:47]
    s_mov_b32 m0, s18
    s_nop 0
    buffer_load_dwordx4 v16, s[8:11], s17 offen offset:0 lds
    buffer_load_dwordx4 v17, s[8:11], s17 offen offset:1024 lds
    buffer_load_dwordx4 v18, s[8:11], s17 offen offset:2048 lds
    s_mov_b32 exec_hi, 0
    buffer_load_dwordx4 v19, s[8:11], s17 offen offset:3072 lds
    s_mov_b32 exec_hi, -1
    s_add_u32 s17, s17, 229376
    s_add_u32 s18, s18, 14336
    s_cmp_ge_u32 s18, 86016
    s_cselect_b32 s18, s30, s18
    s_mov_b32 m0, s18
    s_nop 0
    buffer_load_dwordx4 v16, s[8:11], s17 offen offset:0 lds
    buffer_load_dwordx4 v17, s[8:11], s17 offen offset:1024 lds
    buffer_load_dwordx4 v18, s[8:11], s17 offen offset:2048 lds
    s_mov_b32 exec_hi, 0
    buffer_load_dwordx4 v19, s[8:11], s17 offen offset:3072 lds
    s_mov_b32 exec_hi, -1
    s_add_u32 s17, s17, 229376
    s_add_u32 s18, s18, 14336
    s_cmp_ge_u32 s18, 86016
    s_cselect_b32 s18, s30, s18
    s_bitcmp1_b32 s89, s38
    s_cbranch_scc0 Lxe_164
    s_waitcnt lgkmcnt(0)
    s_bitcmp1_b32 s33, 1
    s_cbranch_scc1 Lxh_162
    s_bitcmp1_b32 s33, 0
    s_cbranch_scc1 Lx1_161
    v_mfma_f32_16x16x32_bf16 v[144:147], a[16:19], v[152:155], v[144:147]
    v_mfma_f32_16x16x32_bf16 v[144:147], a[64:67], v[152:155], v[144:147]
    s_branch Lxe_164
Lx1_161:
    v_mfma_f32_16x16x32_bf16 v[144:147], a[20:23], v[152:155], v[144:147]
    v_mfma_f32_16x16x32_bf16 v[144:147], a[68:71], v[152:155], v[144:147]
    s_branch Lxe_164
Lxh_162:
    s_bitcmp1_b32 s33, 0
    s_cbranch_scc1 Lx3_163
    v_mfma_f32_16x16x32_bf16 v[144:147], a[24:27], v[152:155], v[144:147]
    v_mfma_f32_16x16x32_bf16 v[144:147], a[72:75], v[152:155], v[144:147]
    v_mfma_f32_16x16x32_bf16 v[148:151], a[28:31], v[152:155], v[148:151]
    v_mfma_f32_16x16x32_bf16 v[148:151], a[76:79], v[152:155], v[148:151]
    s_branch Lxe_164
Lx3_163:
    v_mfma_f32_16x16x32_bf16 v[144:147], a[32:35], v[152:155], v[144:147]
    v_mfma_f32_16x16x32_bf16 v[144:147], a[80:83], v[152:155], v[144:147]
    v_mfma_f32_16x16x32_bf16 v[148:151], a[36:39], v[152:155], v[148:151]
    v_mfma_f32_16x16x32_bf16 v[148:151], a[84:87], v[152:155], v[148:151]
Lxe_164:
    s_add_u32 s36, s36, 1
    s_cmp_ge_u32 s36, 3
    s_cselect_b32 s19, s47, s46
    s_cselect_b32 s36, 0, s36
    s_sub_u32 s37, 0, s37
    v_add_u32 v6, s37, v6
    v_add_u32 v7, s19, v7
    s_sub_u32 s38, s38, 1
    s_cmp_lg_u32 s38, 2
    s_cbranch_scc1 Lp3loop_144
    s_waitcnt vmcnt(8) lgkmcnt(0)
    s_barrier
    v_mfma_f32_16x16x32_bf16 v[60:63], a[20:23], a[12:15], v[60:63]
    ds_read_b64_tr_b16 a[16:17], v7 offset:128
    s_load_dwordx2 s[90:91], s[86:87], s88
    s_add_u32 s88, s88, 131072
    s_min_u32 s88, s88, 3538944
    v_mfma_f32_16x16x32_bf16 v[60:63], a[68:71], a[60:63], v[60:63]
    ds_read_b64_tr_b16 a[18:19], v7 offset:3712
    s_load_dwordx2 s[90:91], s[86:87], s88
    s_add_u32 s88, s88, 131072
    s_min_u32 s88, s88, 3538944
    v_mfma_f32_16x16x32_bf16 v[56:59], a[20:23], a[8:11], v[56:59]
    ds_read_b64_tr_b16 a[64:65], v7 offset:14464
    v_mfma_f32_16x16x32_bf16 v[56:59], a[68:71], a[56:59], v[56:59]
    ds_read_b64_tr_b16 a[66:67], v7 offset:18048
    v_mfma_f32_16x16x32_bf16 v[52:55], a[20:23], a[4:7], v[52:55]
    ds_read_b64_tr_b16 a[28:29], v7 offset:7296
    v_mfma_f32_16x16x32_bf16 v[52:55], a[68:71], a[52:55], v[52:55]
    ds_read_b64_tr_b16 a[30:31], v7 offset:10880
    v_mfma_f32_16x16x32_bf16 v[48:51], a[20:23], a[0:3], v[48:51]
    ds_read_b64_tr_b16 a[76:77], v7 offset:21632
    v_mfma_f32_16x16x32_bf16 v[48:51], a[68:71], a[48:51], v[48:51]
    ds_read_b64_tr_b16 a[78:79], v7 offset:25216
    v_mfma_f32_16x16x32_bf16 v[96:99], a[32:35], a[0:3], v[96:99]
    ds_read_b64_tr_b16 a[20:21], v7 offset:160
    v_mfma_f32_16x16x32_bf16 v[96:99], a[80:83], a[48:51], v[96:99]
    ds_read_b64_tr_b16 a[22:23], v7 offset:3744
    v_mfma_f32_16x16x32_bf16 v[100:103], a[32:35], a[4:7], v[100:103]
    ds_read_b64_tr_b16 a[68:69], v7 offset:14496
    v_mfma_f32_16x16x32_bf16 v[100:103], a[80:83], a[52:55], v[100:103]
    ds_read_b64_tr_b16 a[70:71], v7 offset:18080
    v_mfma_f32_16x16x32_bf16 v[104:107], a[32:35], a[8:11], v[104:107]
    v_mfma_f32_16x16x32_bf16 v[104:107], a[80:83], a[56:59], v[104:107]
    v_mfma_f32_16x16x32_bf16 v[108:111], a[32:35], a[12:15], v[108:111]
    v_mfma_f32_16x16x32_bf16 v[108:111], a[80:83], a[60:63], v[108:111]
    ds_read_b64_tr_b16 a[32:33], v7 offset:7328
    v_mfma_f32_16x16x32_bf16 v[64:67], a[24:27], a[0:3], v[64:67]
    ds_read_b64_tr_b16 a[34:35], v7 offset:10912
    v_mfma_f32_16x16x32_bf16 v[64:67], a[72:75], a[48:51], v[64:67]
    ds_read_b64_tr_b16 a[80:81], v7 offset:21664
    v_mfma_f32_16x16x32_bf16 v[112:115], a[36:39], a[0:3], v[112:115]
    ds_read_b64_tr_b16 a[82:83], v7 offset:25248
    v_mfma_f32_16x16x32_bf16 v[112:115], a[84:87], a[48:51], v[112:115]
    ds_read_b128 a[0:3], v6 offset:0
    ds_read_b128 a[48:51], v6 offset:16384
    v_mfma_f32_16x16x32_bf16 v[116:119], a[36:39], a[4:7], v[116:119]
    v_mfma_f32_16x16x32_bf16 v[116:119], a[84:87], a[52:55], v[116:119]
    v_mfma_f32_16x16x32_bf16 v[68:71], a[24:27], a[4:7], v[68:71]
    v_mfma_f32_16x16x32_bf16 v[68:71], a[72:75], a[52:55], v[68:71]
    ds_read_b128 a[4:7], v6 offset:1024
    ds_read_b128 a[52:55], v6 offset:17408
    v_mfma_f32_16x16x32_bf16 v[72:75], a[24:27], a[8:11], v[72:75]
    v_mfma_f32_16x16x32_bf16 v[72:75], a[72:75], a[56:59], v[72:75]
    v_mfma_f32_16x16x32_bf16 v[120:123], a[36:39], a[8:11], v[120:123]
    v_mfma_f32_16x16x32_bf16 v[120:123], a[84:87], a[56:59], v[120:123]
    ds_read_b128 a[8:11], v6 offset:2048
    ds_read_b128 a[56:59], v6 offset:18432
    v_mfma_f32_16x16x32_bf16 v[124:127], a[36:39], a[12:15], v[124:127]
    v_mfma_f32_16x16x32_bf16 v[124:127], a[84:87], a[60:63], v[124:127]
    v_mfma_f32_16x16x32_bf16 v[76:79], a[24:27], a[12:15], v[76:79]
    v_mfma_f32_16x16x32_bf16 v[76:79], a[72:75], a[60:63], v[76:79]
    ds_read_b128 a[12:15], v6 offset:3072
    ds_read_b128 a[60:63], v6 offset:19456
    s_waitcnt lgkmcnt(7)
    v_mfma_f32_16x16x32_bf16 v[32:35], a[16:19], a[0:3], v[32:35]
    ds_read_b64_tr_b16 a[24:25], v7 offset:192
    s_waitcnt lgkmcnt(7)
    v_mfma_f32_16x16x32_bf16 v[32:35], a[64:67], a[48:51], v[32:35]
    ds_read_b64_tr_b16 a[26:27], v7 offset:3776
    v_mfma_f32_16x16x32_bf16 v[80:83], a[28:31], a[0:3], v[80:83]
    ds_read_b64_tr_b16 a[72:73], v7 offset:14528
    v_mfma_f32_16x16x32_bf16 v[80:83], a[76:79], a[48:51], v[80:83]
    ds_read_b64_tr_b16 a[74:75], v7 offset:18112
    s_waitcnt lgkmcnt(9)
    v_mfma_f32_16x16x32_bf16 v[84:87], a[28:31], a[4:7], v[84:87]
    ds_read_b64_tr_b16 a[36:37], v7 offset:7360
    s_waitcnt lgkmcnt(9)
    v_mfma_f32_16x16x32_bf16 v[84:87], a[76:79], a[52:55], v[84:87]
    ds_read_b64_tr_b16 a[38:39], v7 offset:10944
    v_mfma_f32_16x16x32_bf16 v[36:39], a[16:19], a[4:7], v[36:39]
    ds_read_b64_tr_b16 a[84:85], v7 offset:21696
    v_mfma_f32_16x16x32_bf16 v[36:39], a[64:67], a[52:55], v[36:39]
    ds_read_b64_tr_b16 a[86:87], v7 offset:25280
    s_waitcnt lgkmcnt(11)
    v_mfma_f32_16x16x32_bf16 v[40:43], a[16:19], a[8:11], v[40:43]
    s_waitcnt lgkmcnt(10)
    v_mfma_f32_16x16x32_bf16 v[40:43], a[64:67], a[56:59], v[40:43]
    v_mfma_f32_16x16x32_bf16 v[88:91], a[28:31], a[8:11], v[88:91]
    v_mfma_f32_16x16x32_bf16 v[88:91], a[76:79], a[56:59], v[88:91]
    s_waitcnt lgkmcnt(9)
    v_mfma_f32_16x16x32_bf16 v[92:95], a[28:31], a[12:15], v[92:95]
    s_waitcnt lgkmcnt(8)
    v_mfma_f32_16x16x32_bf16 v[92:95], a[76:79], a[60:63], v[92:95]
    v_mfma_f32_16x16x32_bf16 v[44:47], a[16:19], a[12:15], v[44:47]
    v_mfma_f32_16x16x32_bf16 v[44:47], a[64:67], a[60:63], v[44:47]
    s_and_b32 s72, s28, 1
    s_lshl_b32 s72, s72, 2
    s_and_b32 s73, s29, 3
    s_add_u32 s72, s72, s73
    s_lshl_b32 s72, s72, 1
    s_bfe_u32 s73, s29, 0x10002
    s_add_u32 s72, s72, s73
    s_bfe_u32 s73, s28, 0x10001
    s_lshl_b32 s73, s73, 2
    s_lshr_b32 s74, s29, 3
    s_add_u32 s73, s73, s74
    s_bfe_u32 s74, s28, 0x10002
    s_lshl_b32 s75, s72, 3
    s_add_u32 s75, s75, s73
    s_lshl_b32 s75, s75, 1
    s_add_u32 s75, s75, s74
    s_add_u32 s4, s70, 16777216
    s_addc_u32 s5, s71, 0
    s_and_b32 s5, s5, 0xffff
    s_mov_b32 s6, 14680064
    s_mov_b32 s7, 0x20000
    s_mov_b32 s8, s64
    s_and_b32 s9, s65, 0xffff
    s_mov_b32 s10, 7340032
    s_mov_b32 s11, 0x20000
    s_mul_i32 s16, s74, 7340032
    s_lshl_b32 s40, s72, 13
    s_add_u32 s16, s16, s40
    s_lshl_b32 s30, s33, 11
    s_xor_b32 s40, s33, s74
    s_lshl_b32 s40, s40, 11
    s_add_u32 s16, s16, s40
    s_mul_i32 s17, s74, 3670016
    v_lshrrev_b32 v22, 3, v0
    v_bfe_u32 v23, v0, 4, 2
    v_lshlrev_b32 v23, 1, v23
    v_and_b32 v11, 7, v0
    v_xor_b32 v11, v11, v23
    s_lshl_b32 s40, s33, 3
    v_add_u32 v22, s40, v22
    v_lshlrev_b32 v22, 11, v22
    v_lshl_add_u32 v22, v11, 4, v22
    s_lshl_b32 s40, s73, 8
    v_add_u32 v22, s40, v22
    buffer_load_dword v128, v20, s[20:23], s84 offen offset:0 sc1
    buffer_load_dword v129, v20, s[20:23], s84 offen offset:2048 sc1
    buffer_load_dword v130, v20, s[20:23], s85 offen offset:0 sc1
    buffer_load_dword v131, v20, s[20:23], s85 offen offset:2048 sc1
    buffer_load_dwordx2 v[132:133], v140, s[20:23], s49 offen offset:1536 sc1
    s_add_u32 m0, s30, 0
    s_add_u32 s41, s17, 262144
    buffer_load_dwordx4 v22, s[8:11], s41 offen lds
    s_add_u32 m0, s30, 896
    s_nop 0
    buffer_load_dwordx4 v22, s[8:11], s41 offen offset:128 lds
    s_add_u32 m0, s30, 8192
    s_add_u32 s41, s17, 458752
    buffer_load_dwordx4 v22, s[8:11], s41 offen lds
    s_add_u32 m0, s30, 9088
    s_nop 0
    buffer_load_dwordx4 v22, s[8:11], s41 offen offset:128 lds
    s_add_u32 m0, s30, 16384
    s_add_u32 s41, s17, 1179648
    buffer_load_dwordx4 v22, s[8:11], s41 offen lds
    s_add_u32 m0, s30, 17280
    s_nop 0
    buffer_load_dwordx4 v22, s[8:11], s41 offen offset:128 lds
    s_waitcnt lgkmcnt(0)
    s_bitcmp1_b32 s33, 1
    s_cbranch_scc1 Lxh_166
    s_bitcmp1_b32 s33, 0
    s_cbranch_scc1 Lx1_165
    v_mfma_f32_16x16x32_bf16 v[144:147], a[16:19], v[152:155], v[144:147]
    v_mfma_f32_16x16x32_bf16 v[144:147], a[64:67], v[152:155], v[144:147]
    s_branch Lxe_168
Lx1_165:
    v_mfma_f32_16x16x32_bf16 v[144:147], a[20:23], v[152:155], v[144:147]
    v_mfma_f32_16x16x32_bf16 v[144:147], a[68:71], v[152:155], v[144:147]
    s_branch Lxe_168
Lxh_166:
    s_bitcmp1_b32 s33, 0
    s_cbranch_scc1 Lx3_167
    v_mfma_f32_16x16x32_bf16 v[144:147], a[24:27], v[152:155], v[144:147]
    v_mfma_f32_16x16x32_bf16 v[144:147], a[72:75], v[152:155], v[144:147]
    v_mfma_f32_16x16x32_bf16 v[148:151], a[28:31], v[152:155], v[148:151]
    v_mfma_f32_16x16x32_bf16 v[148:151], a[76:79], v[152:155], v[148:151]
    s_branch Lxe_168
Lx3_167:
    v_mfma_f32_16x16x32_bf16 v[144:147], a[32:35], v[152:155], v[144:147]
    v_mfma_f32_16x16x32_bf16 v[144:147], a[80:83], v[152:155], v[144:147]
    v_mfma_f32_16x16x32_bf16 v[148:151], a[36:39], v[152:155], v[148:151]
    v_mfma_f32_16x16x32_bf16 v[148:151], a[84:87], v[152:155], v[148:151]
Lxe_168:
    s_add_u32 s36, s36, 1
    s_cmp_ge_u32 s36, 3
    s_cselect_b32 s19, s47, s46
    s_cselect_b32 s36, 0, s36
    s_sub_u32 s37, 0, s37
    v_add_u32 v6, s37, v6
    v_add_u32 v7, s19, v7
    s_waitcnt vmcnt(11) lgkmcnt(0)
    s_barrier
    v_mfma_f32_16x16x32_bf16 v[60:63], a[20:23], a[12:15], v[60:63]
    ds_read_b64_tr_b16 a[16:17], v7 offset:128
    v_mfma_f32_16x16x32_bf16 v[60:63], a[68:71], a[60:63], v[60:63]
    ds_read_b64_tr_b16 a[18:19], v7 offset:3712
    v_mfma_f32_16x16x32_bf16 v[56:59], a[20:23], a[8:11], v[56:59]
    ds_read_b64_tr_b16 a[64:65], v7 offset:14464
    v_mfma_f32_16x16x32_bf16 v[56:59], a[68:71], a[56:59], v[56:59]
    ds_read_b64_tr_b16 a[66:67], v7 offset:18048
    v_mfma_f32_16x16x32_bf16 v[52:55], a[20:23], a[4:7], v[52:55]
    ds_read_b64_tr_b16 a[28:29], v7 offset:7296
    v_mfma_f32_16x16x32_bf16 v[52:55], a[68:71], a[52:55], v[52:55]
    ds_read_b64_tr_b16 a[30:31], v7 offset:10880
    v_mfma_f32_16x16x32_bf16 v[48:51], a[20:23], a[0:3], v[48:51]
    ds_read_b64_tr_b16 a[76:77], v7 offset:21632
    v_mfma_f32_16x16x32_bf16 v[48:51], a[68:71], a[48:51], v[48:51]
    ds_read_b64_tr_b16 a[78:79], v7 offset:25216
    v_mfma_f32_16x16x32_bf16 v[96:99], a[32:35], a[0:3], v[96:99]
    ds_read_b64_tr_b16 a[20:21], v7 offset:160
    v_mfma_f32_16x16x32_bf16 v[96:99], a[80:83], a[48:51], v[96:99]
    ds_read_b64_tr_b16 a[22:23], v7 offset:3744
    v_mfma_f32_16x16x32_bf16 v[100:103], a[32:35], a[4:7], v[100:103]
    ds_read_b64_tr_b16 a[68:69], v7 offset:14496
    v_mfma_f32_16x16x32_bf16 v[100:103], a[80:83], a[52:55], v[100:103]
    ds_read_b64_tr_b16 a[70:71], v7 offset:18080
    v_mfma_f32_16x16x32_bf16 v[104:107], a[32:35], a[8:11], v[104:107]
    v_mfma_f32_16x16x32_bf16 v[104:107], a[80:83], a[56:59], v[104:107]
    v_mfma_f32_16x16x32_bf16 v[108:111], a[32:35], a[12:15], v[108:111]
    v_mfma_f32_16x16x32_bf16 v[108:111], a[80:83], a[60:63], v[108:111]
    ds_read_b64_tr_b16 a[32:33], v7 offset:7328
    v_mfma_f32_16x16x32_bf16 v[64:67], a[24:27], a[0:3], v[64:67]
    ds_read_b64_tr_b16 a[34:35], v7 offset:10912
    v_mfma_f32_16x16x32_bf16 v[64:67], a[72:75], a[48:51], v[64:67]
    ds_read_b64_tr_b16 a[80:81], v7 offset:21664
    v_mfma_f32_16x16x32_bf16 v[112:115], a[36:39], a[0:3], v[112:115]
    ds_read_b64_tr_b16 a[82:83], v7 offset:25248
    v_mfma_f32_16x16x32_bf16 v[112:115], a[84:87], a[48:51], v[112:115]
    ds_read_b128 a[0:3], v6 offset:0
    ds_read_b128 a[48:51], v6 offset:16384
    v_mfma_f32_16x16x32_bf16 v[116:119], a[36:39], a[4:7], v[116:119]
    v_mfma_f32_16x16x32_bf16 v[116:119], a[84:87], a[52:55], v[116:119]
    v_mfma_f32_16x16x32_bf16 v[68:71], a[24:27], a[4:7], v[68:71]
    v_mfma_f32_16x16x32_bf16 v[68:71], a[72:75], a[52:55], v[68:71]
    ds_read_b128 a[4:7], v6 offset:1024
    ds_read_b128 a[52:55], v6 offset:17408
    v_mfma_f32_16x16x32_bf16 v[72:75], a[24:27], a[8:11], v[72:75]
    v_mfma_f32_16x16x32_bf16 v[72:75], a[72:75], a[56:59], v[72:75]
    v_mfma_f32_16x16x32_bf16 v[120:123], a[36:39], a[8:11], v[120:123]
    v_mfma_f32_16x16x32_bf16 v[120:123], a[84:87], a[56:59], v[120:123]
    ds_read_b128 a[8:11], v6 offset:2048
    ds_read_b128 a[56:59], v6 offset:18432
    v_mfma_f32_16x16x32_bf16 v[124:127], a[36:39], a[12:15], v[124:127]
    v_mfma_f32_16x16x32_bf16 v[124:127], a[84:87], a[60:63], v[124:127]
    v_mfma_f32_16x16x32_bf16 v[76:79], a[24:27], a[12:15], v[76:79]
    v_mfma_f32_16x16x32_bf16 v[76:79], a[72:75], a[60:63], v[76:79]
    ds_read_b128 a[12:15], v6 offset:3072
    ds_read_b128 a[60:63], v6 offset:19456
    s_waitcnt lgkmcnt(7)
    v_mfma_f32_16x16x32_bf16 v[32:35], a[16:19], a[0:3], v[32:35]
    ds_read_b64_tr_b16 a[24:25], v7 offset:192
    s_waitcnt lgkmcnt(7)
    v_mfma_f32_16x16x32_bf16 v[32:35], a[64:67], a[48:51], v[32:35]
    ds_read_b64_tr_b16 a[26:27], v7 offset:3776
    v_mfma_f32_16x16x32_bf16 v[80:83], a[28:31], a[0:3], v[80:83]
    ds_read_b64_tr_b16 a[72:73], v7 offset:14528
    v_mfma_f32_16x16x32_bf16 v[80:83], a[76:79], a[48:51], v[80:83]
    ds_read_b64_tr_b16 a[74:75], v7 offset:18112
    s_waitcnt lgkmcnt(9)
    v_mfma_f32_16x16x32_bf16 v[84:87], a[28:31], a[4:7], v[84:87]
    ds_read_b64_tr_b16 a[36:37], v7 offset:7360
    s_waitcnt lgkmcnt(9)
    v_mfma_f32_16x16x32_bf16 v[84:87], a[76:79], a[52:55], v[84:87]
    ds_read_b64_tr_b16 a[38:39], v7 offset:10944
    v_mfma_f32_16x16x32_bf16 v[36:39], a[16:19], a[4:7], v[36:39]
    ds_read_b64_tr_b16 a[84:85], v7 offset:21696
    v_mfma_f32_16x16x32_bf16 v[36:39], a[64:67], a[52:55], v[36:39]
    ds_read_b64_tr_b16 a[86:87], v7 offset:25280
    s_waitcnt lgkmcnt(11)
    v_mfma_f32_16x16x32_bf16 v[40:43], a[16:19], a[8:11], v[40:43]
    s_waitcnt lgkmcnt(10)
    v_mfma_f32_16x16x32_bf16 v[40:43], a[64:67], a[56:59], v[40:43]
    v_mfma_f32_16x16x32_bf16 v[88:91], a[28:31], a[8:11], v[88:91]
    v_mfma_f32_16x16x32_bf16 v[88:91], a[76:79], a[56:59], v[88:91]
    s_waitcnt lgkmcnt(9)
    v_mfma_f32_16x16x32_bf16 v[92:95], a[28:31], a[12:15], v[92:95]
    s_waitcnt lgkmcnt(8)
    v_mfma_f32_16x16x32_bf16 v[92:95], a[76:79], a[60:63], v[92:95]
    v_mfma_f32_16x16x32_bf16 v[44:47], a[16:19], a[12:15], v[44:47]
    v_mfma_f32_16x16x32_bf16 v[44:47], a[64:67], a[60:63], v[44:47]
    s_add_u32 m0, s30, 24576
    s_add_u32 s41, s17, 1376256
    buffer_load_dwordx4 v22, s[8:11], s41 offen lds
    s_add_u32 m0, s30, 25472
    s_nop 0
    buffer_load_dwordx4 v22, s[8:11], s41 offen offset:128 lds
    s_add_u32 m0, s30, 32768
    s_add_u32 s41, s17, 2097152
    buffer_load_dwordx4 v22, s[8:11], s41 offen lds
    s_add_u32 m0, s30, 33664
    s_nop 0
    buffer_load_dwordx4 v22, s[8:11], s41 offen offset:128 lds
    s_add_u32 m0, s30, 40960
    s_add_u32 s41, s17, 2293760
    buffer_load_dwordx4 v22, s[8:11], s41 offen lds
    s_add_u32 m0, s30, 41856
    s_nop 0
    buffer_load_dwordx4 v22, s[8:11], s41 offen offset:128 lds
    s_add_u32 m0, s30, 49152
    s_add_u32 s41, s17, 3014656
    buffer_load_dwordx4 v22, s[8:11], s41 offen lds
    s_add_u32 m0, s30, 50048
    s_nop 0
    buffer_load_dwordx4 v22, s[8:11], s41 offen offset:128 lds
    s_add_u32 m0, s30, 90112
    s_add_u32 s41, s17, 1638400
    buffer_load_dwordx4 v22, s[8:11], s41 offen lds
    s_add_u32 m0, s30, 91008
    s_nop 0
    buffer_load_dwordx4 v22, s[8:11], s41 offen offset:128 lds
    s_waitcnt lgkmcnt(0)
    s_bitcmp1_b32 s33, 1
    s_cbranch_scc1 Lxh_170
    s_bitcmp1_b32 s33, 0
    s_cbranch_scc1 Lx1_169
    v_mfma_f32_16x16x32_bf16 v[144:147], a[16:19], v[152:155], v[144:147]
    v_mfma_f32_16x16x32_bf16 v[144:147], a[64:67], v[152:155], v[144:147]
    s_branch Lxe_172
Lx1_169:
    v_mfma_f32_16x16x32_bf16 v[144:147], a[20:23], v[152:155], v[144:147]
    v_mfma_f32_16x16x32_bf16 v[144:147], a[68:71], v[152:155], v[144:147]
    s_branch Lxe_172
Lxh_170:
    s_bitcmp1_b32 s33, 0
    s_cbranch_scc1 Lx3_171
    v_mfma_f32_16x16x32_bf16 v[144:147], a[24:27], v[152:155], v[144:147]
    v_mfma_f32_16x16x32_bf16 v[144:147], a[72:75], v[152:155], v[144:147]
    v_mfma_f32_16x16x32_bf16 v[148:151], a[28:31], v[152:155], v[148:151]
    v_mfma_f32_16x16x32_bf16 v[148:151], a[76:79], v[152:155], v[148:151]
    s_branch Lxe_172
Lx3_171:
    v_mfma_f32_16x16x32_bf16 v[144:147], a[32:35], v[152:155], v[144:147]
    v_mfma_f32_16x16x32_bf16 v[144:147], a[80:83], v[152:155], v[144:147]
    v_mfma_f32_16x16x32_bf16 v[148:151], a[36:39], v[152:155], v[148:151]
    v_mfma_f32_16x16x32_bf16 v[148:151], a[84:87], v[152:155], v[148:151]
Lxe_172:
    s_add_u32 s36, s36, 1
    s_cmp_ge_u32 s36, 3
    s_cselect_b32 s19, s47, s46
    s_cselect_b32 s36, 0, s36
    s_sub_u32 s37, 0, s37
    v_add_u32 v6, s37, v6
    v_add_u32 v7, s19, v7
    s_mov_b32 s101, 0
    s_waitcnt vmcnt(16)
Lca_154:
    v_max3_u32 v142, v128, v129, v130
    v_max3_u32 v142, v142, v132, v133
    v_max_u32 v142, v142, v131
    v_cmp_eq_u32 vcc, -1, v142
    s_cbranch_vccz Lca_154x
    s_add_u32 s101, s101, 1
    s_cmp_ge_u32 s101, 200000
    s_cbranch_scc1 Lca_154x
    buffer_load_dword v128, v20, s[20:23], s84 offen offset:0 sc1
    buffer_load_dword v129, v20, s[20:23], s84 offen offset:2048 sc1
    buffer_load_dword v130, v20, s[20:23], s85 offen offset:0 sc1
    buffer_load_dword v131, v20, s[20:23], s85 offen offset:2048 sc1
    buffer_load_dwordx2 v[132:133], v140, s[20:23], s49 offen offset:1536 sc1
    s_waitcnt vmcnt(0)
    s_branch Lca_154
Lca_154x:
    v_add_f32 v128, v128, v130
    v_add_f32 v129, v129, v131
    v_add_f32 v128, v128, v129
    ds_write_b32 v21, v128 offset:2048
    ds_write_b32 v21, v132
    ds_write_b32 v21, v133 offset:1024
    s_waitcnt lgkmcnt(0)
    s_barrier
    ds_read_b128 v[12:15], v30
    ds_read_b128 v[2:5], v31
    v_mfma_f32_16x16x32_bf16 v[60:63], a[20:23], a[12:15], v[60:63]
    v_mfma_f32_16x16x32_bf16 v[60:63], a[68:71], a[60:63], v[60:63]
    v_mfma_f32_16x16x32_bf16 v[56:59], a[20:23], a[8:11], v[56:59]
    v_mfma_f32_16x16x32_bf16 v[56:59], a[68:71], a[56:59], v[56:59]
    v_mfma_f32_16x16x32_bf16 v[52:55], a[20:23], a[4:7], v[52:55]
    v_mfma_f32_16x16x32_bf16 v[52:55], a[68:71], a[52:55], v[52:55]
    v_mfma_f32_16x16x32_bf16 v[48:51], a[20:23], a[0:3], v[48:51]
    v_mfma_f32_16x16x32_bf16 v[48:51], a[68:71], a[48:51], v[48:51]
    v_mfma_f32_16x16x32_bf16 v[96:99], a[32:35], a[0:3], v[96:99]
    v_mfma_f32_16x16x32_bf16 v[96:99], a[80:83], a[48:51], v[96:99]
    v_mfma_f32_16x16x32_bf16 v[100:103], a[32:35], a[4:7], v[100:103]
    v_mfma_f32_16x16x32_bf16 v[100:103], a[80:83], a[52:55], v[100:103]
    v_mfma_f32_16x16x32_bf16 v[104:107], a[32:35], a[8:11], v[104:107]
    v_mfma_f32_16x16x32_bf16 v[104:107], a[80:83], a[56:59], v[104:107]
    v_mfma_f32_16x16x32_bf16 v[108:111], a[32:35], a[12:15], v[108:111]
    v_mfma_f32_16x16x32_bf16 v[108:111], a[80:83], a[60:63], v[108:111]
    v_mfma_f32_16x16x32_bf16 v[64:67], a[24:27], a[0:3], v[64:67]
    v_mfma_f32_16x16x32_bf16 v[64:67], a[72:75], a[48:51], v[64:67]
    v_mfma_f32_16x16x32_bf16 v[112:115], a[36:39], a[0:3], v[112:115]
    v_mfma_f32_16x16x32_bf16 v[112:115], a[84:87], a[48:51], v[112:115]
    v_mfma_f32_16x16x32_bf16 v[116:119], a[36:39], a[4:7], v[116:119]
    v_mfma_f32_16x16x32_bf16 v[116:119], a[84:87], a[52:55], v[116:119]
    v_mfma_f32_16x16x32_bf16 v[68:71], a[24:27], a[4:7], v[68:71]
    v_mfma_f32_16x16x32_bf16 v[68:71], a[72:75], a[52:55], v[68:71]
    v_mfma_f32_16x16x32_bf16 v[72:75], a[24:27], a[8:11], v[72:75]
    v_mfma_f32_16x16x32_bf16 v[72:75], a[72:75], a[56:59], v[72:75]
    v_mfma_f32_16x16x32_bf16 v[120:123], a[36:39], a[8:11], v[120:123]
    v_mfma_f32_16x16x32_bf16 v[120:123], a[84:87], a[56:59], v[120:123]
    v_mfma_f32_16x16x32_bf16 v[124:127], a[36:39], a[12:15], v[124:127]
    v_mfma_f32_16x16x32_bf16 v[124:127], a[84:87], a[60:63], v[124:127]
    v_mfma_f32_16x16x32_bf16 v[76:79], a[24:27], a[12:15], v[76:79]
    v_mfma_f32_16x16x32_bf16 v[76:79], a[72:75], a[60:63], v[76:79]
    s_waitcnt lgkmcnt(1)
    v_add_f32 v144, v144, v12
    v_add_f32 v145, v145, v13
    v_add_f32 v146, v146, v14
    v_add_f32 v147, v147, v15
    s_waitcnt lgkmcnt(0)
    v_add_f32 v148, v148, v2
    v_add_f32 v149, v149, v3
    v_add_f32 v150, v150, v4
    v_add_f32 v151, v151, v5
    s_mov_b32 exec_lo, 0x10001
    s_mov_b32 exec_hi, 0x10001
    ds_write_b128 v30, v[144:147]
    ds_write_b128 v31, v[148:151]
    s_mov_b64 exec, -1
    s_add_u32 m0, s30, 57344
    s_add_u32 s41, s17, 3211264
    buffer_load_dwordx4 v22, s[8:11], s41 offen lds
    s_add_u32 m0, s30, 58240
    s_nop 0
    buffer_load_dwordx4 v22, s[8:11], s41 offen offset:128 lds
    s_add_u32 m0, s30, 65536
    s_add_u32 s41, s17, 0
    buffer_load_dwordx4 v22, s[8:11], s41 offen lds
    s_add_u32 m0, s30, 66432
    s_nop 0
    buffer_load_dwordx4 v22, s[8:11], s41 offen offset:128 lds
    s_add_u32 m0, s30, 73728
    s_add_u32 s41, s17, 720896
    buffer_load_dwordx4 v22, s[8:11], s41 offen lds
    s_add_u32 m0, s30, 74624
    s_nop 0
    buffer_load_dwordx4 v22, s[8:11], s41 offen offset:128 lds
    s_add_u32 m0, s30, 81920
    s_add_u32 s41, s17, 917504
    buffer_load_dwordx4 v22, s[8:11], s41 offen lds
    s_add_u32 m0, s30, 82816
    s_nop 0
    buffer_load_dwordx4 v22, s[8:11], s41 offen offset:128 lds
    s_waitcnt lgkmcnt(0)
    s_setprio 0
    s_barrier
    s_add_u32 s12, s70, 16777216
    s_addc_u32 s13, s71, 0
    s_and_b32 s13, s13, 0xffff
    s_mov_b32 s14, 14680064
    s_mov_b32 s15, 0x20000
    s_mul_i32 s86, s81, 7
    s_add_u32 s86, s86, 1
    s_lshr_b32 s86, s86, 1
    s_lshl_b32 s86, s86, 17
    s_add_u32 s86, s86, s82
    s_add_u32 s87, s86, 131072
    s_add_u32 s88, s86, 262144
    s_cmp_eq_u32 s83, 0
    s_mov_b32 s89, 393216
    s_cselect_b32 s89, s89, 4294836736
    v_lshlrev_b32 v20, 3, v0
    s_add_u32 s89, s89, s86
    s_mov_b32 s90, 3184710632
    s_mov_b32 s91, 3222493025
    v_lshrrev_b32 v144, 4, v0
    v_lshlrev_b32 v144, 4, v144
    v_add_u32 v144, 153600, v144
    v_and_b32 v148, 15, v0
    s_lshl_b32 s40, s33, 8
    s_add_u32 s40, s40, 153600
    v_lshl_add_u32 v148, v148, 2, s40
    ds_read_b32 v130, v148 offset:0
    ds_read_b32 v128, v148 offset:1024
    ds_read_b32 v134, v148 offset:64
    ds_read_b32 v132, v148 offset:1088
    ds_read_b32 v138, v148 offset:128
    ds_read_b32 v136, v148 offset:1152
    ds_read_b32 v142, v148 offset:192
    ds_read_b32 v140, v148 offset:1216
    s_waitcnt lgkmcnt(0)
    v_mul_f32 v129, v130, v130
    v_mul_f32 v131, v129, v130
    v_mul_f32 v131, s90, v131
    v_mul_f32 v130, s91, v130
    v_rcp_f32 v129, v129
    v_mul_f32 v133, v134, v134
    v_mul_f32 v135, v133, v134
    v_mul_f32 v135, s90, v135
    v_mul_f32 v134, s91, v134
    v_rcp_f32 v133, v133
    v_mul_f32 v137, v138, v138
    v_mul_f32 v139, v137, v138
    v_mul_f32 v139, s90, v139
    v_mul_f32 v138, s91, v138
    v_rcp_f32 v137, v137
    v_mul_f32 v141, v142, v142
    v_mul_f32 v143, v141, v142
    v_mul_f32 v143, s90, v143
    v_mul_f32 v142, s91, v142
    v_rcp_f32 v141, v141
    ds_read_b128 v[24:27], v144 offset:2304
    ds_read_b128 v[28:31], v144 offset:2752
    s_waitcnt lgkmcnt(0)
    v_pk_fma_f32 v[32:33], v[128:129], v[24:25], v[32:33] op_sel_hi:[0,1,1]
    v_pk_fma_f32 v[34:35], v[128:129], v[26:27], v[34:35] op_sel_hi:[0,1,1]
    v_pk_fma_f32 v[80:81], v[128:129], v[28:29], v[80:81] op_sel_hi:[0,1,1]
    v_pk_fma_f32 v[82:83], v[128:129], v[30:31], v[82:83] op_sel_hi:[0,1,1]
    v_pk_fma_f32 v[36:37], v[132:133], v[24:25], v[36:37] op_sel_hi:[0,1,1]
    v_pk_fma_f32 v[38:39], v[132:133], v[26:27], v[38:39] op_sel_hi:[0,1,1]
    v_pk_fma_f32 v[84:85], v[132:133], v[28:29], v[84:85] op_sel_hi:[0,1,1]
    v_pk_fma_f32 v[86:87], v[132:133], v[30:31], v[86:87] op_sel_hi:[0,1,1]
    v_pk_mul_f32 v[148:149], v[32:33], v[32:33]
    v_pk_mul_f32 v[150:151], v[34:35], v[34:35]
    v_pk_mul_f32 v[152:153], v[36:37], v[36:37]
    v_pk_mul_f32 v[154:155], v[38:39], v[38:39]
    v_pk_fma_f32 v[148:149], v[148:149], v[130:131], v[130:131] op_sel:[0,1,0] op_sel_hi:[1,1,0]
    v_pk_fma_f32 v[150:151], v[150:151], v[130:131], v[130:131] op_sel:[0,1,0] op_sel_hi:[1,1,0]
    v_pk_fma_f32 v[152:153], v[152:153], v[134:135], v[134:135] op_sel:[0,1,0] op_sel_hi:[1,1,0]
    v_pk_fma_f32 v[154:155], v[154:155], v[134:135], v[134:135] op_sel:[0,1,0] op_sel_hi:[1,1,0]
    v_pk_mul_f32 v[148:149], v[148:149], v[32:33]
    v_pk_mul_f32 v[150:151], v[150:151], v[34:35]
    v_pk_mul_f32 v[152:153], v[152:153], v[36:37]
    v_pk_mul_f32 v[154:155], v[154:155], v[38:39]
    v_exp_f32 v148, v148
    v_exp_f32 v149, v149
    v_exp_f32 v150, v150
    v_exp_f32 v151, v151
    v_pk_mul_f32 v[32:33], v[32:33], v[80:81]
    v_pk_mul_f32 v[34:35], v[34:35], v[82:83]
    v_exp_f32 v152, v152
    v_exp_f32 v153, v153
    v_exp_f32 v154, v154
    v_exp_f32 v155, v155
    v_pk_mul_f32 v[36:37], v[36:37], v[84:85]
    v_pk_mul_f32 v[38:39], v[38:39], v[86:87]
    v_pk_fma_f32 v[148:149], v[148:149], v[128:129], v[128:129] op_sel:[0,1,1] op_sel_hi:[1,1,1]
    v_pk_fma_f32 v[150:151], v[150:151], v[128:129], v[128:129] op_sel:[0,1,1] op_sel_hi:[1,1,1]
    v_pk_fma_f32 v[152:153], v[152:153], v[132:133], v[132:133] op_sel:[0,1,1] op_sel_hi:[1,1,1]
    v_pk_fma_f32 v[154:155], v[154:155], v[132:133], v[132:133] op_sel:[0,1,1] op_sel_hi:[1,1,1]
    v_rcp_f32 v148, v148
    v_rcp_f32 v149, v149
    v_rcp_f32 v150, v150
    v_rcp_f32 v151, v151
    v_rcp_f32 v152, v152
    v_rcp_f32 v153, v153
    v_rcp_f32 v154, v154
    v_rcp_f32 v155, v155
    v_pk_mul_f32 v[32:33], v[32:33], v[148:149]
    v_pk_mul_f32 v[34:35], v[34:35], v[150:151]
    v_pk_mul_f32 v[36:37], v[36:37], v[152:153]
    v_pk_mul_f32 v[38:39], v[38:39], v[154:155]
    v_cvt_pk_bf16_f32 v80, v32, v33
    v_cvt_pk_bf16_f32 v81, v34, v35
    v_cvt_pk_bf16_f32 v84, v36, v37
    v_cvt_pk_bf16_f32 v85, v38, v39
    v_pk_fma_f32 v[40:41], v[136:137], v[24:25], v[40:41] op_sel_hi:[0,1,1]
    v_pk_fma_f32 v[42:43], v[136:137], v[26:27], v[42:43] op_sel_hi:[0,1,1]
    v_pk_fma_f32 v[88:89], v[136:137], v[28:29], v[88:89] op_sel_hi:[0,1,1]
    v_pk_fma_f32 v[90:91], v[136:137], v[30:31], v[90:91] op_sel_hi:[0,1,1]
    v_pk_fma_f32 v[44:45], v[140:141], v[24:25], v[44:45] op_sel_hi:[0,1,1]
    v_pk_fma_f32 v[46:47], v[140:141], v[26:27], v[46:47] op_sel_hi:[0,1,1]
    v_pk_fma_f32 v[92:93], v[140:141], v[28:29], v[92:93] op_sel_hi:[0,1,1]
    v_pk_fma_f32 v[94:95], v[140:141], v[30:31], v[94:95] op_sel_hi:[0,1,1]
    v_pk_mul_f32 v[148:149], v[40:41], v[40:41]
    v_pk_mul_f32 v[150:151], v[42:43], v[42:43]
    v_pk_mul_f32 v[152:153], v[44:45], v[44:45]
    v_pk_mul_f32 v[154:155], v[46:47], v[46:47]
    v_pk_fma_f32 v[148:149], v[148:149], v[138:139], v[138:139] op_sel:[0,1,0] op_sel_hi:[1,1,0]
    v_pk_fma_f32 v[150:151], v[150:151], v[138:139], v[138:139] op_sel:[0,1,0] op_sel_hi:[1,1,0]
    v_pk_fma_f32 v[152:153], v[152:153], v[142:143], v[142:143] op_sel:[0,1,0] op_sel_hi:[1,1,0]
    v_pk_fma_f32 v[154:155], v[154:155], v[142:143], v[142:143] op_sel:[0,1,0] op_sel_hi:[1,1,0]
    v_pk_mul_f32 v[148:149], v[148:149], v[40:41]
    v_pk_mul_f32 v[150:151], v[150:151], v[42:43]
    v_pk_mul_f32 v[152:153], v[152:153], v[44:45]
    v_pk_mul_f32 v[154:155], v[154:155], v[46:47]
    v_exp_f32 v148, v148
    v_exp_f32 v149, v149
    v_exp_f32 v150, v150
    v_exp_f32 v151, v151
    v_pk_mul_f32 v[40:41], v[40:41], v[88:89]
    v_pk_mul_f32 v[42:43], v[42:43], v[90:91]
    v_exp_f32 v152, v152
    v_exp_f32 v153, v153
    v_exp_f32 v154, v154
    v_exp_f32 v155, v155
    v_pk_mul_f32 v[44:45], v[44:45], v[92:93]
    v_pk_mul_f32 v[46:47], v[46:47], v[94:95]
    v_pk_fma_f32 v[148:149], v[148:149], v[136:137], v[136:137] op_sel:[0,1,1] op_sel_hi:[1,1,1]
    v_pk_fma_f32 v[150:151], v[150:151], v[136:137], v[136:137] op_sel:[0,1,1] op_sel_hi:[1,1,1]
    v_pk_fma_f32 v[152:153], v[152:153], v[140:141], v[140:141] op_sel:[0,1,1] op_sel_hi:[1,1,1]
    v_pk_fma_f32 v[154:155], v[154:155], v[140:141], v[140:141] op_sel:[0,1,1] op_sel_hi:[1,1,1]
    v_rcp_f32 v148, v148
    v_rcp_f32 v149, v149
    v_rcp_f32 v150, v150
    v_rcp_f32 v151, v151
    v_rcp_f32 v152, v152
    v_rcp_f32 v153, v153
    v_rcp_f32 v154, v154
    v_rcp_f32 v155, v155
    v_pk_mul_f32 v[40:41], v[40:41], v[148:149]
    v_pk_mul_f32 v[42:43], v[42:43], v[150:151]
    v_pk_mul_f32 v[44:45], v[44:45], v[152:153]
    v_pk_mul_f32 v[46:47], v[46:47], v[154:155]
    v_cvt_pk_bf16_f32 v88, v40, v41
    v_cvt_pk_bf16_f32 v89, v42, v43
    v_cvt_pk_bf16_f32 v92, v44, v45
    v_cvt_pk_bf16_f32 v93, v46, v47
    ds_read_b128 v[24:27], v144 offset:2368
    ds_read_b128 v[28:31], v144 offset:2816
    s_waitcnt lgkmcnt(0)
    v_pk_fma_f32 v[48:49], v[128:129], v[24:25], v[48:49] op_sel_hi:[0,1,1]
    v_pk_fma_f32 v[50:51], v[128:129], v[26:27], v[50:51] op_sel_hi:[0,1,1]
    v_pk_fma_f32 v[96:97], v[128:129], v[28:29], v[96:97] op_sel_hi:[0,1,1]
    v_pk_fma_f32 v[98:99], v[128:129], v[30:31], v[98:99] op_sel_hi:[0,1,1]
    v_pk_fma_f32 v[52:53], v[132:133], v[24:25], v[52:53] op_sel_hi:[0,1,1]
    v_pk_fma_f32 v[54:55], v[132:133], v[26:27], v[54:55] op_sel_hi:[0,1,1]
    v_pk_fma_f32 v[100:101], v[132:133], v[28:29], v[100:101] op_sel_hi:[0,1,1]
    v_pk_fma_f32 v[102:103], v[132:133], v[30:31], v[102:103] op_sel_hi:[0,1,1]
    v_pk_mul_f32 v[148:149], v[48:49], v[48:49]
    v_pk_mul_f32 v[150:151], v[50:51], v[50:51]
    v_pk_mul_f32 v[152:153], v[52:53], v[52:53]
    v_pk_mul_f32 v[154:155], v[54:55], v[54:55]
    v_pk_fma_f32 v[148:149], v[148:149], v[130:131], v[130:131] op_sel:[0,1,0] op_sel_hi:[1,1,0]
    v_pk_fma_f32 v[150:151], v[150:151], v[130:131], v[130:131] op_sel:[0,1,0] op_sel_hi:[1,1,0]
    v_pk_fma_f32 v[152:153], v[152:153], v[134:135], v[134:135] op_sel:[0,1,0] op_sel_hi:[1,1,0]
    v_pk_fma_f32 v[154:155], v[154:155], v[134:135], v[134:135] op_sel:[0,1,0] op_sel_hi:[1,1,0]
    v_pk_mul_f32 v[148:149], v[148:149], v[48:49]
    v_pk_mul_f32 v[150:151], v[150:151], v[50:51]
    v_pk_mul_f32 v[152:153], v[152:153], v[52:53]
    v_pk_mul_f32 v[154:155], v[154:155], v[54:55]
    v_exp_f32 v148, v148
    v_exp_f32 v149, v149
    v_exp_f32 v150, v150
    v_exp_f32 v151, v151
    v_pk_mul_f32 v[48:49], v[48:49], v[96:97]
    v_pk_mul_f32 v[50:51], v[50:51], v[98:99]
    v_exp_f32 v152, v152
    v_exp_f32 v153, v153
    v_exp_f32 v154, v154
    v_exp_f32 v155, v155
    v_pk_mul_f32 v[52:53], v[52:53], v[100:101]
    v_pk_mul_f32 v[54:55], v[54:55], v[102:103]
    v_pk_fma_f32 v[148:149], v[148:149], v[128:129], v[128:129] op_sel:[0,1,1] op_sel_hi:[1,1,1]
    v_pk_fma_f32 v[150:151], v[150:151], v[128:129], v[128:129] op_sel:[0,1,1] op_sel_hi:[1,1,1]
    v_pk_fma_f32 v[152:153], v[152:153], v[132:133], v[132:133] op_sel:[0,1,1] op_sel_hi:[1,1,1]
    v_pk_fma_f32 v[154:155], v[154:155], v[132:133], v[132:133] op_sel:[0,1,1] op_sel_hi:[1,1,1]
    v_rcp_f32 v148, v148
    v_rcp_f32 v149, v149
    v_rcp_f32 v150, v150
    v_rcp_f32 v151, v151
    v_rcp_f32 v152, v152
    v_rcp_f32 v153, v153
    v_rcp_f32 v154, v154
    v_rcp_f32 v155, v155
    v_pk_mul_f32 v[48:49], v[48:49], v[148:149]
    v_pk_mul_f32 v[50:51], v[50:51], v[150:151]
    v_pk_mul_f32 v[52:53], v[52:53], v[152:153]
    v_pk_mul_f32 v[54:55], v[54:55], v[154:155]
    v_cvt_pk_bf16_f32 v82, v48, v49
    v_cvt_pk_bf16_f32 v83, v50, v51
    v_cvt_pk_bf16_f32 v86, v52, v53
    v_cvt_pk_bf16_f32 v87, v54, v55
    buffer_store_dwordx4 v[80:83], v1, s[12:15], s88 offen offset:0 sc1
    buffer_store_dwordx4 v[84:87], v1, s[12:15], s88 offen offset:1024 sc1
    v_pk_fma_f32 v[56:57], v[136:137], v[24:25], v[56:57] op_sel_hi:[0,1,1]
    v_pk_fma_f32 v[58:59], v[136:137], v[26:27], v[58:59] op_sel_hi:[0,1,1]
    v_pk_fma_f32 v[104:105], v[136:137], v[28:29], v[104:105] op_sel_hi:[0,1,1]
    v_pk_fma_f32 v[106:107], v[136:137], v[30:31], v[106:107] op_sel_hi:[0,1,1]
    v_pk_fma_f32 v[60:61], v[140:141], v[24:25], v[60:61] op_sel_hi:[0,1,1]
    v_pk_fma_f32 v[62:63], v[140:141], v[26:27], v[62:63] op_sel_hi:[0,1,1]
    v_pk_fma_f32 v[108:109], v[140:141], v[28:29], v[108:109] op_sel_hi:[0,1,1]
    v_pk_fma_f32 v[110:111], v[140:141], v[30:31], v[110:111] op_sel_hi:[0,1,1]
    v_pk_mul_f32 v[148:149], v[56:57], v[56:57]
    v_pk_mul_f32 v[150:151], v[58:59], v[58:59]
    v_pk_mul_f32 v[152:153], v[60:61], v[60:61]
    v_pk_mul_f32 v[154:155], v[62:63], v[62:63]
    v_pk_fma_f32 v[148:149], v[148:149], v[138:139], v[138:139] op_sel:[0,1,0] op_sel_hi:[1,1,0]
    v_pk_fma_f32 v[150:151], v[150:151], v[138:139], v[138:139] op_sel:[0,1,0] op_sel_hi:[1,1,0]
    v_pk_fma_f32 v[152:153], v[152:153], v[142:143], v[142:143] op_sel:[0,1,0] op_sel_hi:[1,1,0]
    v_pk_fma_f32 v[154:155], v[154:155], v[142:143], v[142:143] op_sel:[0,1,0] op_sel_hi:[1,1,0]
    v_pk_mul_f32 v[148:149], v[148:149], v[56:57]
    v_pk_mul_f32 v[150:151], v[150:151], v[58:59]
    v_pk_mul_f32 v[152:153], v[152:153], v[60:61]
    v_pk_mul_f32 v[154:155], v[154:155], v[62:63]
    v_exp_f32 v148, v148
    v_exp_f32 v149, v149
    v_exp_f32 v150, v150
    v_exp_f32 v151, v151
    v_pk_mul_f32 v[56:57], v[56:57], v[104:105]
    v_pk_mul_f32 v[58:59], v[58:59], v[106:107]
    v_exp_f32 v152, v152
    v_exp_f32 v153, v153
    v_exp_f32 v154, v154
    v_exp_f32 v155, v155
    v_pk_mul_f32 v[60:61], v[60:61], v[108:109]
    v_pk_mul_f32 v[62:63], v[62:63], v[110:111]
    v_pk_fma_f32 v[148:149], v[148:149], v[136:137], v[136:137] op_sel:[0,1,1] op_sel_hi:[1,1,1]
    v_pk_fma_f32 v[150:151], v[150:151], v[136:137], v[136:137] op_sel:[0,1,1] op_sel_hi:[1,1,1]
    v_pk_fma_f32 v[152:153], v[152:153], v[140:141], v[140:141] op_sel:[0,1,1] op_sel_hi:[1,1,1]
    v_pk_fma_f32 v[154:155], v[154:155], v[140:141], v[140:141] op_sel:[0,1,1] op_sel_hi:[1,1,1]
    v_rcp_f32 v148, v148
    v_rcp_f32 v149, v149
    v_rcp_f32 v150, v150
    v_rcp_f32 v151, v151
    v_rcp_f32 v152, v152
    v_rcp_f32 v153, v153
    v_rcp_f32 v154, v154
    v_rcp_f32 v155, v155
    v_pk_mul_f32 v[56:57], v[56:57], v[148:149]
    v_pk_mul_f32 v[58:59], v[58:59], v[150:151]
    v_pk_mul_f32 v[60:61], v[60:61], v[152:153]
    v_pk_mul_f32 v[62:63], v[62:63], v[154:155]
    v_cvt_pk_bf16_f32 v90, v56, v57
    v_cvt_pk_bf16_f32 v91, v58, v59
    v_cvt_pk_bf16_f32 v94, v60, v61
    v_cvt_pk_bf16_f32 v95, v62, v63
    buffer_store_dwordx4 v[88:91], v1, s[12:15], s88 offen offset:2048 sc1
    buffer_store_dwordx4 v[92:95], v1, s[12:15], s88 offen offset:3072 sc1
    ds_read_b128 v[24:27], v144 offset:2432
    ds_read_b128 v[28:31], v144 offset:2880
    s_waitcnt lgkmcnt(0)
    v_pk_fma_f32 v[64:65], v[128:129], v[24:25], v[64:65] op_sel_hi:[0,1,1]
    v_pk_fma_f32 v[66:67], v[128:129], v[26:27], v[66:67] op_sel_hi:[0,1,1]
    v_pk_fma_f32 v[112:113], v[128:129], v[28:29], v[112:113] op_sel_hi:[0,1,1]
    v_pk_fma_f32 v[114:115], v[128:129], v[30:31], v[114:115] op_sel_hi:[0,1,1]
    v_pk_fma_f32 v[68:69], v[132:133], v[24:25], v[68:69] op_sel_hi:[0,1,1]
    v_pk_fma_f32 v[70:71], v[132:133], v[26:27], v[70:71] op_sel_hi:[0,1,1]
    v_pk_fma_f32 v[116:117], v[132:133], v[28:29], v[116:117] op_sel_hi:[0,1,1]
    v_pk_fma_f32 v[118:119], v[132:133], v[30:31], v[118:119] op_sel_hi:[0,1,1]
    v_pk_mul_f32 v[148:149], v[64:65], v[64:65]
    v_pk_mul_f32 v[150:151], v[66:67], v[66:67]
    v_pk_mul_f32 v[152:153], v[68:69], v[68:69]
    v_pk_mul_f32 v[154:155], v[70:71], v[70:71]
    v_pk_fma_f32 v[148:149], v[148:149], v[130:131], v[130:131] op_sel:[0,1,0] op_sel_hi:[1,1,0]
    v_pk_fma_f32 v[150:151], v[150:151], v[130:131], v[130:131] op_sel:[0,1,0] op_sel_hi:[1,1,0]
    v_pk_fma_f32 v[152:153], v[152:153], v[134:135], v[134:135] op_sel:[0,1,0] op_sel_hi:[1,1,0]
    v_pk_fma_f32 v[154:155], v[154:155], v[134:135], v[134:135] op_sel:[0,1,0] op_sel_hi:[1,1,0]
    v_pk_mul_f32 v[148:149], v[148:149], v[64:65]
    v_pk_mul_f32 v[150:151], v[150:151], v[66:67]
    v_pk_mul_f32 v[152:153], v[152:153], v[68:69]
    v_pk_mul_f32 v[154:155], v[154:155], v[70:71]
    v_exp_f32 v148, v148
    v_exp_f32 v149, v149
    v_exp_f32 v150, v150
    v_exp_f32 v151, v151
    v_pk_mul_f32 v[64:65], v[64:65], v[112:113]
    v_pk_mul_f32 v[66:67], v[66:67], v[114:115]
    v_exp_f32 v152, v152
    v_exp_f32 v153, v153
    v_exp_f32 v154, v154
    v_exp_f32 v155, v155
    v_pk_mul_f32 v[68:69], v[68:69], v[116:117]
    v_pk_mul_f32 v[70:71], v[70:71], v[118:119]
    v_pk_fma_f32 v[148:149], v[148:149], v[128:129], v[128:129] op_sel:[0,1,1] op_sel_hi:[1,1,1]
    v_pk_fma_f32 v[150:151], v[150:151], v[128:129], v[128:129] op_sel:[0,1,1] op_sel_hi:[1,1,1]
    v_pk_fma_f32 v[152:153], v[152:153], v[132:133], v[132:133] op_sel:[0,1,1] op_sel_hi:[1,1,1]
    v_pk_fma_f32 v[154:155], v[154:155], v[132:133], v[132:133] op_sel:[0,1,1] op_sel_hi:[1,1,1]
    v_rcp_f32 v148, v148
    v_rcp_f32 v149, v149
    v_rcp_f32 v150, v150
    v_rcp_f32 v151, v151
    v_rcp_f32 v152, v152
    v_rcp_f32 v153, v153
    v_rcp_f32 v154, v154
    v_rcp_f32 v155, v155
    v_pk_mul_f32 v[64:65], v[64:65], v[148:149]
    v_pk_mul_f32 v[66:67], v[66:67], v[150:151]
    v_pk_mul_f32 v[68:69], v[68:69], v[152:153]
    v_pk_mul_f32 v[70:71], v[70:71], v[154:155]
    v_cvt_pk_bf16_f32 v112, v64, v65
    v_cvt_pk_bf16_f32 v113, v66, v67
    v_cvt_pk_bf16_f32 v116, v68, v69
    v_cvt_pk_bf16_f32 v117, v70, v71
    v_pk_fma_f32 v[72:73], v[136:137], v[24:25], v[72:73] op_sel_hi:[0,1,1]
    v_pk_fma_f32 v[74:75], v[136:137], v[26:27], v[74:75] op_sel_hi:[0,1,1]
    v_pk_fma_f32 v[120:121], v[136:137], v[28:29], v[120:121] op_sel_hi:[0,1,1]
    v_pk_fma_f32 v[122:123], v[136:137], v[30:31], v[122:123] op_sel_hi:[0,1,1]
    v_pk_fma_f32 v[76:77], v[140:141], v[24:25], v[76:77] op_sel_hi:[0,1,1]
    v_pk_fma_f32 v[78:79], v[140:141], v[26:27], v[78:79] op_sel_hi:[0,1,1]
    v_pk_fma_f32 v[124:125], v[140:141], v[28:29], v[124:125] op_sel_hi:[0,1,1]
    v_pk_fma_f32 v[126:127], v[140:141], v[30:31], v[126:127] op_sel_hi:[0,1,1]
    v_pk_mul_f32 v[148:149], v[72:73], v[72:73]
    v_pk_mul_f32 v[150:151], v[74:75], v[74:75]
    v_pk_mul_f32 v[152:153], v[76:77], v[76:77]
    v_pk_mul_f32 v[154:155], v[78:79], v[78:79]
    v_pk_fma_f32 v[148:149], v[148:149], v[138:139], v[138:139] op_sel:[0,1,0] op_sel_hi:[1,1,0]
    v_pk_fma_f32 v[150:151], v[150:151], v[138:139], v[138:139] op_sel:[0,1,0] op_sel_hi:[1,1,0]
    v_pk_fma_f32 v[152:153], v[152:153], v[142:143], v[142:143] op_sel:[0,1,0] op_sel_hi:[1,1,0]
    v_pk_fma_f32 v[154:155], v[154:155], v[142:143], v[142:143] op_sel:[0,1,0] op_sel_hi:[1,1,0]
    v_pk_mul_f32 v[148:149], v[148:149], v[72:73]
    v_pk_mul_f32 v[150:151], v[150:151], v[74:75]
    v_pk_mul_f32 v[152:153], v[152:153], v[76:77]
    v_pk_mul_f32 v[154:155], v[154:155], v[78:79]
    v_exp_f32 v148, v148
    v_exp_f32 v149, v149
    v_exp_f32 v150, v150
    v_exp_f32 v151, v151
    v_pk_mul_f32 v[72:73], v[72:73], v[120:121]
    v_pk_mul_f32 v[74:75], v[74:75], v[122:123]
    v_exp_f32 v152, v152
    v_exp_f32 v153, v153
    v_exp_f32 v154, v154
    v_exp_f32 v155, v155
    v_pk_mul_f32 v[76:77], v[76:77], v[124:125]
    v_pk_mul_f32 v[78:79], v[78:79], v[126:127]
    v_pk_fma_f32 v[148:149], v[148:149], v[136:137], v[136:137] op_sel:[0,1,1] op_sel_hi:[1,1,1]
    v_pk_fma_f32 v[150:151], v[150:151], v[136:137], v[136:137] op_sel:[0,1,1] op_sel_hi:[1,1,1]
    v_pk_fma_f32 v[152:153], v[152:153], v[140:141], v[140:141] op_sel:[0,1,1] op_sel_hi:[1,1,1]
    v_pk_fma_f32 v[154:155], v[154:155], v[140:141], v[140:141] op_sel:[0,1,1] op_sel_hi:[1,1,1]
    v_rcp_f32 v148, v148
    v_rcp_f32 v149, v149
    v_rcp_f32 v150, v150
    v_rcp_f32 v151, v151
    v_rcp_f32 v152, v152
    v_rcp_f32 v153, v153
    v_rcp_f32 v154, v154
    v_rcp_f32 v155, v155
    v_pk_mul_f32 v[72:73], v[72:73], v[148:149]
    v_pk_mul_f32 v[74:75], v[74:75], v[150:151]
    v_pk_mul_f32 v[76:77], v[76:77], v[152:153]
    v_pk_mul_f32 v[78:79], v[78:79], v[154:155]
    v_cvt_pk_bf16_f32 v120, v72, v73
    v_cvt_pk_bf16_f32 v121, v74, v75
    v_cvt_pk_bf16_f32 v124, v76, v77
    v_cvt_pk_bf16_f32 v125, v78, v79
    s_lshl_b32 s43, s80, 12
    s_lshr_b32 s41, s81, 4
    s_lshl_b32 s41, s41, 7
    s_add_u32 s43, s43, s41
    s_add_u32 s43, s43, 1343496
    s_lshl_b32 s42, s75, 7
    s_add_u32 s42, s42, 1343496
    s_cmp_lg_u32 s33, 0
    s_cselect_b32 s43, 2147418112, s43
    s_cselect_b32 s44, 2147418112, s42
    s_lshr_b32 s40, s64, 7
    s_sub_u32 s40, 3, s40
    s_and_b32 s40, s40, 7
    s_lshr_b32 s41, s40, 1
    s_sub_u32 s41, s73, s41
    s_sub_u32 s41, s41, 1
    s_and_b32 s41, s41, 3
    s_lshl_b32 s90, s41, 3
    s_and_b32 s91, s29, 7
    s_add_u32 s90, s90, s91
    s_cmp_eq_u32 s41, 3
    s_cselect_b32 s90, 99, s90
    s_cmp_lg_u32 s33, 3
    s_cselect_b32 s90, 99, s90
    s_and_b32 s91, s73, 4
    s_lshl_b32 s91, s91, 1
    s_add_u32 s40, s40, s91
    s_lshl_b32 s40, s40, 7
    v_lshrrev_b32 v25, 1, v0
    v_lshlrev_b32 v25, 11, v25
    v_add_u32 v25, s40, v25
    v_and_b32 v24, 0, v0
    v_lshlrev_b32 v24, 7, v24
    v_xor_b32 v25, v24, v25
    s_barrier
    s_add_u32 m0, s30, 98304
    s_add_u32 s41, s16, 524288
    buffer_load_dwordx4 v1, s[4:7], s41 offen sc1 lds
    buffer_load_dwordx4 v1, s[4:7], s41 offen offset:1024 sc1 lds
    s_add_u32 m0, s30, 106496
    s_add_u32 s41, s16, 917504
    buffer_load_dwordx4 v1, s[4:7], s41 offen sc1 lds
    buffer_load_dwordx4 v1, s[4:7], s41 offen offset:1024 sc1 lds
    s_add_u32 m0, s30, 114688
    s_add_u32 s41, s16, 2359296
    buffer_load_dwordx4 v1, s[4:7], s41 offen sc1 lds
    buffer_load_dwordx4 v1, s[4:7], s41 offen offset:1024 sc1 lds
    s_add_u32 m0, s30, 122880
    s_add_u32 s41, s16, 2752512
    buffer_load_dwordx4 v1, s[4:7], s41 offen sc1 lds
    buffer_load_dwordx4 v1, s[4:7], s41 offen offset:1024 sc1 lds
    s_add_u32 m0, s30, 131072
    s_add_u32 s41, s16, 4194304
    buffer_load_dwordx4 v1, s[4:7], s41 offen sc1 lds
    buffer_load_dwordx4 v1, s[4:7], s41 offen offset:1024 sc1 lds
    s_add_u32 m0, s30, 139264
    s_add_u32 s41, s16, 4587520
    buffer_load_dwordx4 v1, s[4:7], s41 offen sc1 lds
    buffer_load_dwordx4 v1, s[4:7], s41 offen offset:1024 sc1 lds
    s_waitcnt vmcnt(8)
    s_barrier
    s_add_u32 m0, s30, 147456
    s_add_u32 s41, s16, 6029312
    buffer_load_dwordx4 v1, s[4:7], s41 offen sc1 lds
    buffer_load_dwordx4 v1, s[4:7], s41 offen offset:1024 sc1 lds
    s_add_u32 m0, s30, 155648
    s_add_u32 s41, s16, 6422528
    buffer_load_dwordx4 v1, s[4:7], s41 offen sc1 lds
    buffer_load_dwordx4 v1, s[4:7], s41 offen offset:1024 sc1 lds
    s_cmp_lg_u32 s90, 0
    s_cbranch_scc1 Lc4_173
    s_add_u32 s41, s17, 327680
    buffer_load_dword v24, v25, s[8:11], s41 offen
Lc4_173:
    s_cmp_lg_u32 s90, 1
    s_cbranch_scc1 Lc4_174
    s_add_u32 s41, s17, 524288
    buffer_load_dword v24, v25, s[8:11], s41 offen
Lc4_174:
    s_waitcnt vmcnt(8)
    s_barrier
    s_add_u32 m0, s30, 98304
    s_add_u32 s41, s16, 0
    buffer_load_dwordx4 v1, s[4:7], s41 offen sc1 lds
    buffer_load_dwordx4 v1, s[4:7], s41 offen offset:1024 sc1 lds
    s_add_u32 m0, s30, 106496
    s_add_u32 s41, s16, 1441792
    buffer_load_dwordx4 v1, s[4:7], s41 offen sc1 lds
    buffer_load_dwordx4 v1, s[4:7], s41 offen offset:1024 sc1 lds
    s_add_u32 m0, s30, 0
    s_add_u32 s41, s17, 1835008
    buffer_load_dwordx4 v22, s[8:11], s41 offen lds
    s_add_u32 m0, s30, 896
    s_nop 0
    buffer_load_dwordx4 v22, s[8:11], s41 offen offset:128 lds
    buffer_store_dwordx2 v[112:113], v20, s[12:15], s89 offen offset:0 sc1
    buffer_store_dwordx2 v[116:117], v20, s[12:15], s89 offen offset:1024 sc1
    s_cmp_lg_u32 s90, 2
    s_cbranch_scc1 Lc4_175
    s_add_u32 s41, s17, 1245184
    buffer_load_dword v24, v25, s[8:11], s41 offen
Lc4_175:
    s_cmp_lg_u32 s90, 3
    s_cbranch_scc1 Lc4_176
    s_add_u32 s41, s17, 1441792
    buffer_load_dword v24, v25, s[8:11], s41 offen
Lc4_176:
    s_waitcnt vmcnt(12)
    s_barrier
    s_add_u32 m0, s30, 114688
    s_add_u32 s41, s16, 1835008
    buffer_load_dwordx4 v1, s[4:7], s41 offen sc1 lds
    buffer_load_dwordx4 v1, s[4:7], s41 offen offset:1024 sc1 lds
    s_add_u32 m0, s30, 122880
    s_add_u32 s41, s16, 3276800
    buffer_load_dwordx4 v1, s[4:7], s41 offen sc1 lds
    buffer_load_dwordx4 v1, s[4:7], s41 offen offset:1024 sc1 lds
    s_add_u32 m0, s30, 8192
    s_add_u32 s41, s17, 2555904
    buffer_load_dwordx4 v22, s[8:11], s41 offen lds
    s_add_u32 m0, s30, 9088
    s_nop 0
    buffer_load_dwordx4 v22, s[8:11], s41 offen offset:128 lds
    buffer_store_dwordx2 v[120:121], v20, s[12:15], s89 offen offset:2048 sc1
    buffer_store_dwordx2 v[124:125], v20, s[12:15], s89 offen offset:3072 sc1
    s_cmp_lg_u32 s90, 4
    s_cbranch_scc1 Lc4_177
    s_add_u32 s41, s17, 2162688
    buffer_load_dword v24, v25, s[8:11], s41 offen
Lc4_177:
    s_cmp_lg_u32 s90, 5
    s_cbranch_scc1 Lc4_178
    s_add_u32 s41, s17, 2359296
    buffer_load_dword v24, v25, s[8:11], s41 offen
Lc4_178:
    s_waitcnt vmcnt(16)
    s_barrier
    s_add_u32 m0, s30, 131072
    s_add_u32 s41, s16, 3670016
    buffer_load_dwordx4 v1, s[4:7], s41 offen sc1 lds
    buffer_load_dwordx4 v1, s[4:7], s41 offen offset:1024 sc1 lds
    s_add_u32 m0, s30, 139264
    s_add_u32 s41, s16, 5111808
    buffer_load_dwordx4 v1, s[4:7], s41 offen sc1 lds
    buffer_load_dwordx4 v1, s[4:7], s41 offen offset:1024 sc1 lds
    s_add_u32 m0, s30, 16384
    s_add_u32 s41, s17, 2752512
    buffer_load_dwordx4 v22, s[8:11], s41 offen lds
    s_add_u32 m0, s30, 17280
    s_nop 0
    buffer_load_dwordx4 v22, s[8:11], s41 offen offset:128 lds
    s_add_u32 m0, s30, 24576
    s_add_u32 s41, s17, 3473408
    buffer_load_dwordx4 v22, s[8:11], s41 offen lds
    s_add_u32 m0, s30, 25472
    s_nop 0
    buffer_load_dwordx4 v22, s[8:11], s41 offen offset:128 lds
    s_cmp_lg_u32 s90, 6
    s_cbranch_scc1 Lc4_179
    s_add_u32 s41, s17, 3080192
    buffer_load_dword v24, v25, s[8:11], s41 offen
Lc4_179:
    s_cmp_lg_u32 s90, 7
    s_cbranch_scc1 Lc4_180
    s_add_u32 s41, s17, 3276800
    buffer_load_dword v24, v25, s[8:11], s41 offen
Lc4_180:
    v_mov_b32 v13, 99
    s_mov_b64 exec, 1
    v_mov_b32 v13, 0
    buffer_atomic_umax v13, off, s[20:23], s44 offset:4 sc0 sc1
    s_mov_b64 exec, -1
    s_waitcnt vmcnt(21)
    s_barrier
    s_add_u32 m0, s30, 147456
    s_add_u32 s41, s16, 5505024
    buffer_load_dwordx4 v1, s[4:7], s41 offen sc1 lds
    buffer_load_dwordx4 v1, s[4:7], s41 offen offset:1024 sc1 lds
    s_add_u32 m0, s30, 155648
    s_add_u32 s41, s16, 6946816
    buffer_load_dwordx4 v1, s[4:7], s41 offen sc1 lds
    buffer_load_dwordx4 v1, s[4:7], s41 offen offset:1024 sc1 lds
    s_add_u32 m0, s30, 32768
    s_add_u32 s41, s17, 327680
    buffer_load_dwordx4 v22, s[8:11], s41 offen lds
    s_add_u32 m0, s30, 33664
    s_nop 0
    buffer_load_dwordx4 v22, s[8:11], s41 offen offset:128 lds
    s_add_u32 m0, s30, 40960
    s_add_u32 s41, s17, 524288
    buffer_load_dwordx4 v22, s[8:11], s41 offen lds
    s_cmp_lg_u32 s90, 8
    s_cbranch_scc1 Lc4_181
    s_add_u32 s41, s17, 65536
    buffer_load_dword v24, v25, s[8:11], s41 offen
Lc4_181:
    s_cmp_lg_u32 s90, 9
    s_cbranch_scc1 Lc4_182
    s_add_u32 s41, s17, 786432
    buffer_load_dword v24, v25, s[8:11], s41 offen
Lc4_182:
    s_waitcnt vmcnt(20)
    s_barrier
    s_add_u32 m0, s30, 41856
    s_add_u32 s41, s17, 524288
    buffer_load_dwordx4 v22, s[8:11], s41 offen offset:128 lds
    s_add_u32 m0, s30, 49152
    s_add_u32 s41, s17, 1245184
    buffer_load_dwordx4 v22, s[8:11], s41 offen lds
    s_add_u32 m0, s30, 50048
    s_nop 0
    buffer_load_dwordx4 v22, s[8:11], s41 offen offset:128 lds
    s_add_u32 m0, s30, 57344
    s_add_u32 s41, s17, 1441792
    buffer_load_dwordx4 v22, s[8:11], s41 offen lds
    s_add_u32 m0, s30, 58240
    s_nop 0
    buffer_load_dwordx4 v22, s[8:11], s41 offen offset:128 lds
    s_add_u32 m0, s30, 65536
    s_add_u32 s41, s17, 2162688
    buffer_load_dwordx4 v22, s[8:11], s41 offen lds
    s_add_u32 m0, s30, 66432
    s_nop 0
    buffer_load_dwordx4 v22, s[8:11], s41 offen offset:128 lds
    s_add_u32 m0, s30, 73728
    s_add_u32 s41, s17, 2359296
    buffer_load_dwordx4 v22, s[8:11], s41 offen lds
    s_cmp_lg_u32 s90, 10
    s_cbranch_scc1 Lc4_183
    s_add_u32 s41, s17, 983040
    buffer_load_dword v24, v25, s[8:11], s41 offen
Lc4_183:
    s_cmp_lg_u32 s90, 11
    s_cbranch_scc1 Lc4_184
    s_add_u32 s41, s17, 1703936
    buffer_load_dword v24, v25, s[8:11], s41 offen
Lc4_184:
    s_waitcnt vmcnt(24)
    s_waitcnt vmcnt(15)
    s_cmp_lg_u32 s33, 0
    s_cbranch_scc1 Lbok_185
    v_cmp_gt_u32 vcc, 16, v13
    s_cbranch_vccz Lbok_185
    s_mov_b64 exec, 1
    s_mov_b32 s101, 0
Lpoll_186:
    s_add_u32 s101, s101, 1
    s_cmp_ge_u32 s101, 200000
    s_cbranch_scc1 Lpoll_186x
    buffer_atomic_umax v13, off, s[20:23], s42 offset:4 sc0 sc1
    s_waitcnt vmcnt(0)
    v_cmp_gt_u32 vcc, 16, v13
    s_cbranch_vccnz Lpoll_186
Lpoll_186x:
    s_mov_b64 exec, -1
Lbok_185:
    s_barrier
    v_mov_b32 v2, 1
    v_mul_u32_u24 v3, 256, v0
    s_mov_b32 exec_lo, 0xffff
    s_mov_b32 exec_hi, 0
    buffer_atomic_add v2, v3, s[20:23], s43 offen sc1
    s_mov_b64 exec, -1
    s_add_u32 m0, s30, 98304
    s_add_u32 s41, s16, 655360
    buffer_load_dwordx4 v1, s[4:7], s41 offen sc1 lds
    buffer_load_dwordx4 v1, s[4:7], s41 offen offset:1024 sc1 lds
    s_add_u32 m0, s30, 106496
    s_add_u32 s41, s16, 1048576
    buffer_load_dwordx4 v1, s[4:7], s41 offen sc1 lds
    buffer_load_dwordx4 v1, s[4:7], s41 offen offset:1024 sc1 lds
    s_add_u32 m0, s30, 114688
    s_add_u32 s41, s16, 2490368
    buffer_load_dwordx4 v1, s[4:7], s41 offen sc1 lds
    buffer_load_dwordx4 v1, s[4:7], s41 offen offset:1024 sc1 lds
    s_add_u32 m0, s30, 122880
    s_add_u32 s41, s16, 2883584
    buffer_load_dwordx4 v1, s[4:7], s41 offen sc1 lds
    s_cmp_lg_u32 s90, 12
    s_cbranch_scc1 Lc4_187
    s_add_u32 s41, s17, 1900544
    buffer_load_dword v24, v25, s[8:11], s41 offen
Lc4_187:
    s_cmp_lg_u32 s90, 13
    s_cbranch_scc1 Lc4_188
    s_add_u32 s41, s17, 2621440
    buffer_load_dword v24, v25, s[8:11], s41 offen
Lc4_188:
    s_waitcnt vmcnt(19)
    s_barrier
    s_add_u32 m0, s30, 122880
    s_add_u32 s41, s16, 2883584
    buffer_load_dwordx4 v1, s[4:7], s41 offen offset:1024 sc1 lds
    s_add_u32 m0, s30, 131072
    s_add_u32 s41, s16, 4325376
    buffer_load_dwordx4 v1, s[4:7], s41 offen sc1 lds
    buffer_load_dwordx4 v1, s[4:7], s41 offen offset:1024 sc1 lds
    s_add_u32 m0, s30, 139264
    s_add_u32 s41, s16, 4718592
    buffer_load_dwordx4 v1, s[4:7], s41 offen sc1 lds
    buffer_load_dwordx4 v1, s[4:7], s41 offen offset:1024 sc1 lds
    s_add_u32 m0, s30, 74624
    s_add_u32 s41, s17, 2359296
    buffer_load_dwordx4 v22, s[8:11], s41 offen offset:128 lds
    s_add_u32 m0, s30, 81920
    s_add_u32 s41, s17, 3080192
    buffer_load_dwordx4 v22, s[8:11], s41 offen lds
    s_add_u32 m0, s30, 82816
    s_nop 0
    buffer_load_dwordx4 v22, s[8:11], s41 offen offset:128 lds
    s_cmp_lg_u32 s90, 14
    s_cbranch_scc1 Lc4_189
    s_add_u32 s41, s17, 2818048
    buffer_load_dword v24, v25, s[8:11], s41 offen
Lc4_189:
    s_cmp_lg_u32 s90, 15
    s_cbranch_scc1 Lc4_190
    s_add_u32 s41, s17, 3538944
    buffer_load_dword v24, v25, s[8:11], s41 offen
Lc4_190:
    s_waitcnt vmcnt(11)
    s_barrier
    s_add_u32 m0, s30, 147456
    s_add_u32 s41, s16, 6160384
    buffer_load_dwordx4 v1, s[4:7], s41 offen sc1 lds
    buffer_load_dwordx4 v1, s[4:7], s41 offen offset:1024 sc1 lds
    s_add_u32 m0, s30, 155648
    s_add_u32 s41, s16, 6553600
    buffer_load_dwordx4 v1, s[4:7], s41 offen sc1 lds
    buffer_load_dwordx4 v1, s[4:7], s41 offen offset:1024 sc1 lds
    s_add_u32 m0, s30, 90112
    s_add_u32 s41, s17, 3276800
    buffer_load_dwordx4 v22, s[8:11], s41 offen lds
    s_add_u32 m0, s30, 91008
    s_nop 0
    buffer_load_dwordx4 v22, s[8:11], s41 offen offset:128 lds
    s_add_u32 m0, s30, 0
    s_add_u32 s41, s17, 65536
    buffer_load_dwordx4 v22, s[8:11], s41 offen lds
    s_cmp_lg_u32 s90, 16
    s_cbranch_scc1 Lc4_191
    s_add_u32 s41, s17, 131072
    buffer_load_dword v24, v25, s[8:11], s41 offen
Lc4_191:
    s_cmp_lg_u32 s90, 17
    s_cbranch_scc1 Lc4_192
    s_add_u32 s41, s17, 393216
    buffer_load_dword v24, v25, s[8:11], s41 offen
Lc4_192:
    s_waitcnt vmcnt(14)
    s_barrier
    s_add_u32 m0, s30, 98304
    s_add_u32 s41, s16, 131072
    buffer_load_dwordx4 v1, s[4:7], s41 offen sc1 lds
    buffer_load_dwordx4 v1, s[4:7], s41 offen offset:1024 sc1 lds
    s_add_u32 m0, s30, 106496
    s_add_u32 s41, s16, 1572864
    buffer_load_dwordx4 v1, s[4:7], s41 offen sc1 lds
    buffer_load_dwordx4 v1, s[4:7], s41 offen offset:1024 sc1 lds
    s_add_u32 m0, s30, 896
    s_add_u32 s41, s17, 65536
    buffer_load_dwordx4 v22, s[8:11], s41 offen offset:128 lds
    s_add_u32 m0, s30, 8192
    s_add_u32 s41, s17, 786432
    buffer_load_dwordx4 v22, s[8:11], s41 offen lds
    s_add_u32 m0, s30, 9088
    s_nop 0
    buffer_load_dwordx4 v22, s[8:11], s41 offen offset:128 lds
    s_add_u32 m0, s30, 16384
    s_add_u32 s41, s17, 983040
    buffer_load_dwordx4 v22, s[8:11], s41 offen lds
    s_cmp_lg_u32 s90, 18
    s_cbranch_scc1 Lc4_193
    s_add_u32 s41, s17, 589824
    buffer_load_dword v24, v25, s[8:11], s41 offen
Lc4_193:
    s_cmp_lg_u32 s90, 19
    s_cbranch_scc1 Lc4_194
    s_add_u32 s41, s17, 851968
    buffer_load_dword v24, v25, s[8:11], s41 offen
Lc4_194:
    s_waitcnt vmcnt(17)
    s_barrier
    s_add_u32 m0, s30, 114688
    s_add_u32 s41, s16, 1966080
    buffer_load_dwordx4 v1, s[4:7], s41 offen sc1 lds
    buffer_load_dwordx4 v1, s[4:7], s41 offen offset:1024 sc1 lds
    s_add_u32 m0, s30, 122880
    s_add_u32 s41, s16, 3407872
    buffer_load_dwordx4 v1, s[4:7], s41 offen sc1 lds
    buffer_load_dwordx4 v1, s[4:7], s41 offen offset:1024 sc1 lds
    s_add_u32 m0, s30, 17280
    s_add_u32 s41, s17, 983040
    buffer_load_dwordx4 v22, s[8:11], s41 offen offset:128 lds
    s_add_u32 m0, s30, 24576
    s_add_u32 s41, s17, 1703936
    buffer_load_dwordx4 v22, s[8:11], s41 offen lds
    s_add_u32 m0, s30, 25472
    s_nop 0
    buffer_load_dwordx4 v22, s[8:11], s41 offen offset:128 lds
    s_cmp_lg_u32 s90, 20
    s_cbranch_scc1 Lc4_195
    s_add_u32 s41, s17, 1048576
    buffer_load_dword v24, v25, s[8:11], s41 offen
Lc4_195:
    s_cmp_lg_u32 s90, 21
    s_cbranch_scc1 Lc4_196
    s_add_u32 s41, s17, 1310720
    buffer_load_dword v24, v25, s[8:11], s41 offen
Lc4_196:
    s_waitcnt vmcnt(16)
    s_barrier
    s_add_u32 m0, s30, 131072
    s_add_u32 s41, s16, 3801088
    buffer_load_dwordx4 v1, s[4:7], s41 offen sc1 lds
    buffer_load_dwordx4 v1, s[4:7], s41 offen offset:1024 sc1 lds
    s_add_u32 m0, s30, 139264
    s_add_u32 s41, s16, 5242880
    buffer_load_dwordx4 v1, s[4:7], s41 offen sc1 lds
    buffer_load_dwordx4 v1, s[4:7], s41 offen offset:1024 sc1 lds
    s_add_u32 m0, s30, 32768
    s_add_u32 s41, s17, 1900544
    buffer_load_dwordx4 v22, s[8:11], s41 offen lds
    s_add_u32 m0, s30, 33664
    s_nop 0
    buffer_load_dwordx4 v22, s[8:11], s41 offen offset:128 lds
    s_add_u32 m0, s30, 40960
    s_add_u32 s41, s17, 2621440
    buffer_load_dwordx4 v22, s[8:11], s41 offen lds
    s_add_u32 m0, s30, 41856
    s_nop 0
    buffer_load_dwordx4 v22, s[8:11], s41 offen offset:128 lds
    s_cmp_lg_u32 s90, 22
    s_cbranch_scc1 Lc4_197
    s_add_u32 s41, s17, 1507328
    buffer_load_dword v24, v25, s[8:11], s41 offen
Lc4_197:
    s_cmp_lg_u32 s90, 23
    s_cbranch_scc1 Lc4_198
    s_add_u32 s41, s17, 1769472
    buffer_load_dword v24, v25, s[8:11], s41 offen
Lc4_198:
    v_mov_b32 v13, 99
    s_mov_b64 exec, 1
    v_mov_b32 v13, 0
    buffer_atomic_umax v13, off, s[20:23], s44 offset:0 sc0 sc1
    s_mov_b64 exec, -1
    s_waitcnt vmcnt(17)
    s_barrier
    s_add_u32 m0, s30, 147456
    s_add_u32 s41, s16, 5636096
    buffer_load_dwordx4 v1, s[4:7], s41 offen sc1 lds
    buffer_load_dwordx4 v1, s[4:7], s41 offen offset:1024 sc1 lds
    s_add_u32 m0, s30, 155648
    s_add_u32 s41, s16, 7077888
    buffer_load_dwordx4 v1, s[4:7], s41 offen sc1 lds
    buffer_load_dwordx4 v1, s[4:7], s41 offen offset:1024 sc1 lds
    s_add_u32 m0, s30, 49152
    s_add_u32 s41, s17, 2818048
    buffer_load_dwordx4 v22, s[8:11], s41 offen lds
    s_add_u32 m0, s30, 50048
    s_nop 0
    buffer_load_dwordx4 v22, s[8:11], s41 offen offset:128 lds
    s_add_u32 m0, s30, 57344
    s_add_u32 s41, s17, 3538944
    buffer_load_dwordx4 v22, s[8:11], s41 offen lds
    s_cmp_lg_u32 s90, 0
    s_cbranch_scc1 Lc4_199
    s_add_u32 s41, s17, 1966080
    buffer_load_dword v24, v25, s[8:11], s41 offen
Lc4_199:
    s_cmp_lg_u32 s90, 1
    s_cbranch_scc1 Lc4_200
    s_add_u32 s41, s17, 2228224
    buffer_load_dword v24, v25, s[8:11], s41 offen
Lc4_200:
    s_waitcnt vmcnt(16)
    s_barrier
    s_add_u32 m0, s30, 58240
    s_add_u32 s41, s17, 3538944
    buffer_load_dwordx4 v22, s[8:11], s41 offen offset:128 lds
    s_add_u32 m0, s30, 65536
    s_add_u32 s41, s17, 131072
    buffer_load_dwordx4 v22, s[8:11], s41 offen lds
    s_add_u32 m0, s30, 66432
    s_nop 0
    buffer_load_dwordx4 v22, s[8:11], s41 offen offset:128 lds
    s_add_u32 m0, s30, 73728
    s_add_u32 s41, s17, 393216
    buffer_load_dwordx4 v22, s[8:11], s41 offen lds
    s_add_u32 m0, s30, 74624
    s_nop 0
    buffer_load_dwordx4 v22, s[8:11], s41 offen offset:128 lds
    s_add_u32 m0, s30, 81920
    s_add_u32 s41, s17, 589824
    buffer_load_dwordx4 v22, s[8:11], s41 offen lds
    s_add_u32 m0, s30, 82816
    s_nop 0
    buffer_load_dwordx4 v22, s[8:11], s41 offen offset:128 lds
    s_add_u32 m0, s30, 90112
    s_add_u32 s41, s17, 851968
    buffer_load_dwordx4 v22, s[8:11], s41 offen lds
    s_cmp_lg_u32 s90, 2
    s_cbranch_scc1 Lc4_201
    s_add_u32 s41, s17, 2424832
    buffer_load_dword v24, v25, s[8:11], s41 offen
Lc4_201:
    s_cmp_lg_u32 s90, 3
    s_cbranch_scc1 Lc4_202
    s_add_u32 s41, s17, 2686976
    buffer_load_dword v24, v25, s[8:11], s41 offen
Lc4_202:
    s_waitcnt vmcnt(15)
    s_cmp_lg_u32 s33, 0
    s_cbranch_scc1 Lbok_203
    v_cmp_gt_u32 vcc, 16, v13
    s_cbranch_vccz Lbok_203
    s_mov_b64 exec, 1
    s_mov_b32 s101, 0
Lpoll_204:
    s_add_u32 s101, s101, 1
    s_cmp_ge_u32 s101, 200000
    s_cbranch_scc1 Lpoll_204x
    buffer_atomic_umax v13, off, s[20:23], s42 offset:0 sc0 sc1
    s_waitcnt vmcnt(0)
    v_cmp_gt_u32 vcc, 16, v13
    s_cbranch_vccnz Lpoll_204
Lpoll_204x:
    s_mov_b64 exec, -1
Lbok_203:
    s_barrier
    s_add_u32 m0, s30, 98304
    s_add_u32 s41, s16, 262144
    buffer_load_dwordx4 v1, s[4:7], s41 offen sc1 lds
    buffer_load_dwordx4 v1, s[4:7], s41 offen offset:1024 sc1 lds
    s_add_u32 m0, s30, 106496
    s_add_u32 s41, s16, 786432
    buffer_load_dwordx4 v1, s[4:7], s41 offen sc1 lds
    buffer_load_dwordx4 v1, s[4:7], s41 offen offset:1024 sc1 lds
    s_add_u32 m0, s30, 114688
    s_add_u32 s41, s16, 1179648
    buffer_load_dwordx4 v1, s[4:7], s41 offen sc1 lds
    buffer_load_dwordx4 v1, s[4:7], s41 offen offset:1024 sc1 lds
    s_add_u32 m0, s30, 122880
    s_add_u32 s41, s16, 1703936
    buffer_load_dwordx4 v1, s[4:7], s41 offen sc1 lds
    s_cmp_lg_u32 s90, 4
    s_cbranch_scc1 Lc4_205
    s_add_u32 s41, s17, 2883584
    buffer_load_dword v24, v25, s[8:11], s41 offen
Lc4_205:
    s_cmp_lg_u32 s90, 5
    s_cbranch_scc1 Lc4_206
    s_add_u32 s41, s17, 3145728
    buffer_load_dword v24, v25, s[8:11], s41 offen
Lc4_206:
    s_waitcnt vmcnt(14)
    s_barrier
    s_add_u32 m0, s30, 122880
    s_add_u32 s41, s16, 1703936
    buffer_load_dwordx4 v1, s[4:7], s41 offen offset:1024 sc1 lds
    s_add_u32 m0, s30, 91008
    s_add_u32 s41, s17, 851968
    buffer_load_dwordx4 v22, s[8:11], s41 offen offset:128 lds
    s_add_u32 m0, s30, 131072
    s_add_u32 s41, s16, 2097152
    buffer_load_dwordx4 v1, s[4:7], s41 offen sc1 lds
    buffer_load_dwordx4 v1, s[4:7], s41 offen offset:1024 sc1 lds
    s_add_u32 m0, s30, 139264
    s_add_u32 s41, s16, 2621440
    buffer_load_dwordx4 v1, s[4:7], s41 offen sc1 lds
    buffer_load_dwordx4 v1, s[4:7], s41 offen offset:1024 sc1 lds
    s_add_u32 m0, s30, 0
    s_add_u32 s41, s17, 1048576
    buffer_load_dwordx4 v22, s[8:11], s41 offen lds
    s_add_u32 m0, s30, 896
    s_nop 0
    buffer_load_dwordx4 v22, s[8:11], s41 offen offset:128 lds
    s_cmp_lg_u32 s90, 6
    s_cbranch_scc1 Lc4_207
    s_add_u32 s41, s17, 3342336
    buffer_load_dword v24, v25, s[8:11], s41 offen
Lc4_207:
    s_cmp_lg_u32 s90, 7
    s_cbranch_scc1 Lc4_208
    s_add_u32 s41, s17, 3604480
    buffer_load_dword v24, v25, s[8:11], s41 offen
Lc4_208:
    s_waitcnt vmcnt(11)
    s_barrier
    s_add_u32 m0, s30, 8192
    s_add_u32 s41, s17, 1310720
    buffer_load_dwordx4 v22, s[8:11], s41 offen lds
    s_add_u32 m0, s30, 9088
    s_nop 0
    buffer_load_dwordx4 v22, s[8:11], s41 offen offset:128 lds
    s_add_u32 m0, s30, 147456
    s_add_u32 s41, s16, 3014656
    buffer_load_dwordx4 v1, s[4:7], s41 offen sc1 lds
    buffer_load_dwordx4 v1, s[4:7], s41 offen offset:1024 sc1 lds
    s_add_u32 m0, s30, 155648
    s_add_u32 s41, s16, 3538944
    buffer_load_dwordx4 v1, s[4:7], s41 offen sc1 lds
    buffer_load_dwordx4 v1, s[4:7], s41 offen offset:1024 sc1 lds
    s_add_u32 m0, s30, 16384
    s_add_u32 s41, s17, 1507328
    buffer_load_dwordx4 v22, s[8:11], s41 offen lds
    s_cmp_lg_u32 s90, 8
    s_cbranch_scc1 Lc4_209
    s_add_u32 s41, s17, 196608
    buffer_load_dword v24, v25, s[8:11], s41 offen
Lc4_209:
    s_cmp_lg_u32 s90, 9
    s_cbranch_scc1 Lc4_210
    s_add_u32 s41, s17, 655360
    buffer_load_dword v24, v25, s[8:11], s41 offen
Lc4_210:
    s_waitcnt vmcnt(13)
    s_barrier
    s_add_u32 m0, s30, 17280
    s_add_u32 s41, s17, 1507328
    buffer_load_dwordx4 v22, s[8:11], s41 offen offset:128 lds
    s_add_u32 m0, s30, 24576
    s_add_u32 s41, s17, 1769472
    buffer_load_dwordx4 v22, s[8:11], s41 offen lds
    s_add_u32 m0, s30, 25472
    s_nop 0
    buffer_load_dwordx4 v22, s[8:11], s41 offen offset:128 lds
    s_add_u32 m0, s30, 98304
    s_add_u32 s41, s16, 3932160
    buffer_load_dwordx4 v1, s[4:7], s41 offen sc1 lds
    buffer_load_dwordx4 v1, s[4:7], s41 offen offset:1024 sc1 lds
    s_add_u32 m0, s30, 106496
    s_add_u32 s41, s16, 4456448
    buffer_load_dwordx4 v1, s[4:7], s41 offen sc1 lds
    buffer_load_dwordx4 v1, s[4:7], s41 offen offset:1024 sc1 lds
    s_add_u32 m0, s30, 32768
    s_add_u32 s41, s17, 1966080
    buffer_load_dwordx4 v22, s[8:11], s41 offen lds
    s_cmp_lg_u32 s90, 10
    s_cbranch_scc1 Lc4_211
    s_add_u32 s41, s17, 1114112
    buffer_load_dword v24, v25, s[8:11], s41 offen
Lc4_211:
    s_cmp_lg_u32 s90, 11
    s_cbranch_scc1 Lc4_212
    s_add_u32 s41, s17, 1572864
    buffer_load_dword v24, v25, s[8:11], s41 offen
Lc4_212:
    s_waitcnt vmcnt(13)
    s_barrier
    s_add_u32 m0, s30, 33664
    s_add_u32 s41, s17, 1966080
    buffer_load_dwordx4 v22, s[8:11], s41 offen offset:128 lds
    s_add_u32 m0, s30, 40960
    s_add_u32 s41, s17, 2228224
    buffer_load_dwordx4 v22, s[8:11], s41 offen lds
    s_add_u32 m0, s30, 41856
    s_nop 0
    buffer_load_dwordx4 v22, s[8:11], s41 offen offset:128 lds
    s_add_u32 m0, s30, 114688
    s_add_u32 s41, s16, 4849664
    buffer_load_dwordx4 v1, s[4:7], s41 offen sc1 lds
    buffer_load_dwordx4 v1, s[4:7], s41 offen offset:1024 sc1 lds
    s_add_u32 m0, s30, 122880
    s_add_u32 s41, s16, 5373952
    buffer_load_dwordx4 v1, s[4:7], s41 offen sc1 lds
    buffer_load_dwordx4 v1, s[4:7], s41 offen offset:1024 sc1 lds
    s_cmp_lg_u32 s90, 12
    s_cbranch_scc1 Lc4_213
    s_add_u32 s41, s17, 2031616
    buffer_load_dword v24, v25, s[8:11], s41 offen
Lc4_213:
    s_cmp_lg_u32 s90, 13
    s_cbranch_scc1 Lc4_214
    s_add_u32 s41, s17, 2490368
    buffer_load_dword v24, v25, s[8:11], s41 offen
Lc4_214:
    s_waitcnt vmcnt(12)
    s_barrier
    s_add_u32 m0, s30, 49152
    s_add_u32 s41, s17, 2424832
    buffer_load_dwordx4 v22, s[8:11], s41 offen lds
    s_add_u32 m0, s30, 50048
    s_nop 0
    buffer_load_dwordx4 v22, s[8:11], s41 offen offset:128 lds
    s_add_u32 m0, s30, 57344
    s_add_u32 s41, s17, 2686976
    buffer_load_dwordx4 v22, s[8:11], s41 offen lds
    s_add_u32 m0, s30, 58240
    s_nop 0
    buffer_load_dwordx4 v22, s[8:11], s41 offen offset:128 lds
    s_add_u32 m0, s30, 131072
    s_add_u32 s41, s16, 5767168
    buffer_load_dwordx4 v1, s[4:7], s41 offen sc1 lds
    buffer_load_dwordx4 v1, s[4:7], s41 offen offset:1024 sc1 lds
    s_add_u32 m0, s30, 139264
    s_add_u32 s41, s16, 6291456
    buffer_load_dwordx4 v1, s[4:7], s41 offen sc1 lds
    buffer_load_dwordx4 v1, s[4:7], s41 offen offset:1024 sc1 lds
    s_cmp_lg_u32 s90, 14
    s_cbranch_scc1 Lc4_215
    s_add_u32 s41, s17, 2949120
    buffer_load_dword v24, v25, s[8:11], s41 offen
Lc4_215:
    s_cmp_lg_u32 s90, 15
    s_cbranch_scc1 Lc4_216
    s_add_u32 s41, s17, 3407872
    buffer_load_dword v24, v25, s[8:11], s41 offen
Lc4_216:
    s_waitcnt vmcnt(12)
    s_barrier
    s_add_u32 m0, s30, 65536
    s_add_u32 s41, s17, 2883584
    buffer_load_dwordx4 v22, s[8:11], s41 offen lds
    s_add_u32 m0, s30, 66432
    s_nop 0
    buffer_load_dwordx4 v22, s[8:11], s41 offen offset:128 lds
    s_add_u32 m0, s30, 73728
    s_add_u32 s41, s17, 3145728
    buffer_load_dwordx4 v22, s[8:11], s41 offen lds
    s_add_u32 m0, s30, 74624
    s_nop 0
    buffer_load_dwordx4 v22, s[8:11], s41 offen offset:128 lds
    s_add_u32 m0, s30, 147456
    s_add_u32 s41, s16, 6684672
    buffer_load_dwordx4 v1, s[4:7], s41 offen sc1 lds
    buffer_load_dwordx4 v1, s[4:7], s41 offen offset:1024 sc1 lds
    s_add_u32 m0, s30, 155648
    s_add_u32 s41, s16, 7208960
    buffer_load_dwordx4 v1, s[4:7], s41 offen sc1 lds
    s_waitcnt vmcnt(11)
    s_barrier
    s_add_u32 m0, s30, 155648
    s_add_u32 s41, s16, 7208960
    buffer_load_dwordx4 v1, s[4:7], s41 offen offset:1024 sc1 lds
    s_add_u32 m0, s30, 81920
    s_add_u32 s41, s17, 3342336
    buffer_load_dwordx4 v22, s[8:11], s41 offen lds
    s_add_u32 m0, s30, 82816
    s_nop 0
    buffer_load_dwordx4 v22, s[8:11], s41 offen offset:128 lds
    s_add_u32 m0, s30, 90112
    s_add_u32 s41, s17, 3604480
    buffer_load_dwordx4 v22, s[8:11], s41 offen lds
    s_add_u32 m0, s30, 91008
    s_nop 0
    buffer_load_dwordx4 v22, s[8:11], s41 offen offset:128 lds
    s_add_u32 m0, s30, 98304
    s_add_u32 s41, s16, 393216
    buffer_load_dwordx4 v1, s[4:7], s41 offen sc1 lds
    buffer_load_dwordx4 v1, s[4:7], s41 offen offset:1024 sc1 lds
    s_add_u32 m0, s30, 106496
    s_add_u32 s41, s16, 1310720
    buffer_load_dwordx4 v1, s[4:7], s41 offen sc1 lds
    s_waitcnt vmcnt(11)
    s_barrier
    s_add_u32 m0, s30, 106496
    s_add_u32 s41, s16, 1310720
    buffer_load_dwordx4 v1, s[4:7], s41 offen offset:1024 sc1 lds
    s_add_u32 m0, s30, 0
    s_add_u32 s41, s17, 196608
    buffer_load_dwordx4 v22, s[8:11], s41 offen lds
    s_add_u32 m0, s30, 896
    s_nop 0
    buffer_load_dwordx4 v22, s[8:11], s41 offen offset:128 lds
    s_add_u32 m0, s30, 8192
    s_add_u32 s41, s17, 655360
    buffer_load_dwordx4 v22, s[8:11], s41 offen lds
    s_add_u32 m0, s30, 9088
    s_nop 0
    buffer_load_dwordx4 v22, s[8:11], s41 offen offset:128 lds
    s_add_u32 m0, s30, 114688
    s_add_u32 s41, s16, 2228224
    buffer_load_dwordx4 v1, s[4:7], s41 offen sc1 lds
    buffer_load_dwordx4 v1, s[4:7], s41 offen offset:1024 sc1 lds
    s_waitcnt vmcnt(10)
    s_barrier
    s_add_u32 m0, s30, 122880
    s_add_u32 s41, s16, 3145728
    buffer_load_dwordx4 v1, s[4:7], s41 offen sc1 lds
    buffer_load_dwordx4 v1, s[4:7], s41 offen offset:1024 sc1 lds
    s_add_u32 m0, s30, 16384
    s_add_u32 s41, s17, 1114112
    buffer_load_dwordx4 v22, s[8:11], s41 offen lds
    s_add_u32 m0, s30, 17280
    s_nop 0
    buffer_load_dwordx4 v22, s[8:11], s41 offen offset:128 lds
    s_add_u32 m0, s30, 24576
    s_add_u32 s41, s17, 1572864
    buffer_load_dwordx4 v22, s[8:11], s41 offen lds
    s_add_u32 m0, s30, 25472
    s_nop 0
    buffer_load_dwordx4 v22, s[8:11], s41 offen offset:128 lds
    s_add_u32 m0, s30, 131072
    s_add_u32 s41, s16, 4063232
    buffer_load_dwordx4 v1, s[4:7], s41 offen sc1 lds
    buffer_load_dwordx4 v1, s[4:7], s41 offen offset:1024 sc1 lds
    s_waitcnt vmcnt(10)
    s_barrier
    s_add_u32 m0, s30, 139264
    s_add_u32 s41, s16, 4980736
    buffer_load_dwordx4 v1, s[4:7], s41 offen sc1 lds
    buffer_load_dwordx4 v1, s[4:7], s41 offen offset:1024 sc1 lds
    s_add_u32 m0, s30, 32768
    s_add_u32 s41, s17, 2031616
    buffer_load_dwordx4 v22, s[8:11], s41 offen lds
    s_add_u32 m0, s30, 33664
    s_nop 0
    buffer_load_dwordx4 v22, s[8:11], s41 offen offset:128 lds
    s_add_u32 m0, s30, 40960
    s_add_u32 s41, s17, 2490368
    buffer_load_dwordx4 v22, s[8:11], s41 offen lds
    s_add_u32 m0, s30, 41856
    s_nop 0
    buffer_load_dwordx4 v22, s[8:11], s41 offen offset:128 lds
    s_add_u32 m0, s30, 147456
    s_add_u32 s41, s16, 5898240
    buffer_load_dwordx4 v1, s[4:7], s41 offen sc1 lds
    s_waitcnt vmcnt(9)
    s_barrier
    s_add_u32 m0, s30, 147456
    s_add_u32 s41, s16, 5898240
    buffer_load_dwordx4 v1, s[4:7], s41 offen offset:1024 sc1 lds
    s_add_u32 m0, s30, 155648
    s_add_u32 s41, s16, 6815744
    buffer_load_dwordx4 v1, s[4:7], s41 offen sc1 lds
    buffer_load_dwordx4 v1, s[4:7], s41 offen offset:1024 sc1 lds
    s_add_u32 m0, s30, 49152
    s_add_u32 s41, s17, 2949120
    buffer_load_dwordx4 v22, s[8:11], s41 offen lds
    s_add_u32 m0, s30, 50048
    s_nop 0
    buffer_load_dwordx4 v22, s[8:11], s41 offen offset:128 lds
    s_add_u32 m0, s30, 57344
    s_add_u32 s41, s17, 3407872
    buffer_load_dwordx4 v22, s[8:11], s41 offen lds
    s_add_u32 m0, s30, 58240
    s_nop 0
    buffer_load_dwordx4 v22, s[8:11], s41 offen offset:128 lds
    s_waitcnt vmcnt(8)
    s_barrier
    s_waitcnt vmcnt(0)
    s_barrier
    s_barrier
    s_lshl_b32 s42, s75, 7
    s_xor_b32 s40, s42, 128
    s_add_u32 s42, s42, 1409024
    s_add_u32 s40, s40, 1409024
    s_cmp_lg_u32 s33, 0
    s_cbranch_scc1 Lof_217
    v_mov_b32 v2, 1
    v_mul_u32_u24 v3, 128, v0
    s_mov_b32 exec_lo, 0x1
    s_mov_b32 exec_hi, 0
    buffer_atomic_add v2, v3, s[20:23], s40 offen sc1
    s_mov_b64 exec, -1
Lof_217:
    s_cmp_lg_u32 s33, 1
    s_cbranch_scc1 Low_218
    v_mov_b32 v2, 0
    s_mov_b64 exec, 1
    s_mov_b32 s101, 0
Lpoll_220:
    s_add_u32 s101, s101, 1
    s_cmp_ge_u32 s101, 200000
    s_cbranch_scc1 Lpoll_220x
    buffer_atomic_umax v2, off, s[20:23], s42 sc0 sc1
    s_waitcnt vmcnt(0)
    v_cmp_gt_u32 vcc, 1, v2
    s_cbranch_vccnz Lpoll_220
Lpoll_220x:
    s_mov_b64 exec, -1
Low_218:
    s_barrier
    s_endpgm
LLpath_1:
    s_mov_b32 s72, s50
    s_mov_b32 s73, s51
    s_mov_b32 s74, 0xe560
    s_mov_b32 s75, 0x20000
    s_lshl_b32 s79, s29, 12
    s_lshl_b32 s41, s33, 10
    s_add_u32 s79, s79, s41
    s_mov_b32 s4, s52
    s_and_b32 s5, s53, 0xffff
    s_mov_b32 s6, 4194304
    s_mov_b32 s7, 0x20000
    s_mov_b32 s8, s54
    s_and_b32 s9, s55, 0xffff
    s_mov_b32 s10, 6291456
    s_mov_b32 s11, 0x20000
    v_lshrrev_b32 v14, 3, v0
    v_bfe_u32 v15, v0, 4, 1
    s_lshl_b32 s40, s34, 1
    v_or_b32 v15, s40, v15
    v_lshlrev_b32 v15, 1, v15
    v_and_b32 v16, 7, v0
    v_xor_b32 v15, v16, v15
    s_lshl_b32 s40, s33, 3
    v_add_u32 v17, s40, v14
    v_mul_u32_u24 v17, 6144, v17
    v_lshl_add_u32 v17, v15, 4, v17
    s_lshl_b32 s40, s32, 7
    v_add_u32 v3, s40, v17
    v_add_u32 v4, 1024, v3
    v_add_u32 v5, 2048, v3
    s_mul_i32 s30, s33, 3072
    v_lshrrev_b32 v15, 1, v14
    v_xor_b32 v15, v16, v15
    v_lshlrev_b32 v17, 12, v14
    v_lshl_add_u32 v6, v15, 4, v17
    v_xor_b32 v15, 4, v15
    v_lshl_add_u32 v19, v15, 4, v17
    v_add_u32 v7, 31744, v19
    v_mov_b32 v8, v6
    v_add_u32 v9, 31744, v19
    s_lshl_b32 s16, s31, 18
    s_lshl_b32 s40, s33, 16
    s_add_u32 s16, s16, s40
    v_lshrrev_b32 v15, 1, v14
    s_lshl_b32 s40, s34, 2
    v_or_b32 v15, s40, v15
    v_xor_b32 v15, v16, v15
    v_lshlrev_b32 v17, 11, v14
    v_lshl_add_u32 v20, v15, 4, v17
    s_lshl_b32 s44, s31, 7
    s_sub_u32 s44, s44, 16
    s_max_i32 s44, s44, 0
    s_lshl_b32 s40, s34, 3
    s_add_u32 s44, s44, s40
    s_lshl_b32 s44, s44, 11
    s_lshl_b32 s18, s33, 12
    s_add_u32 s18, s18, 24576
    s_lshl_b32 s19, s33, 10
    s_add_u32 s19, s19, 40960
    s_mul_i32 s45, s28, 2
    s_lshr_b32 s40, s29, 5
    s_add_u32 s45, s45, s40
    v_lshrrev_b32 v2, 4, v0
    v_mul_u32_u24 v2, 32768, v2
    v_and_b32 v13, 15, v0
    v_lshl_add_u32 v2, v13, 2, v2
    s_lshl_b32 s40, s2, 7
    s_add_u32 s40, s40, 1310720
    s_cmp_lg_u32 s33, 0
    s_cselect_b32 s40, 2147418112, s40
    v_mov_b32 v13, 0
    buffer_store_dword v13, v2, s[20:23], s40 offen sc1
    s_lshl_b32 s40, s33, 6
    v_add_u32 v21, s40, v0
    s_lshl_b32 s40, s31, 7
    s_sub_u32 s40, s40, 16
    v_add_u32 v22, s40, v21
    v_max_i32 v22, 0, v22
    v_lshlrev_b32 v22, 3, v22
    s_lshl_b32 s49, s33, 12
    s_lshl_b32 s41, s32, 8
    s_add_u32 s49, s49, s41
    s_add_u32 s49, s49, 32768
    s_cmp_eq_u32 s33, 3
    s_cselect_b32 s49, 2146369536, s49
    v_lshrrev_b32 v24, 4, v0
    v_mul_u32_u24 v24, 12288, v24
    v_and_b32 v13, 15, v0
    v_lshl_add_u32 v24, v13, 4, v24
    s_barrier
    s_add_u32 s42, s45, 0
    s_and_b32 s42, s42, 15
    s_mul_i32 s43, s42, 393216
    s_lshl_b32 s42, s42, 7
    s_add_u32 m0, s30, 0
    s_add_u32 s41, s43, 0
    buffer_load_dwordx4 v3, s[8:11], s41 offen offset:0 lds
    buffer_load_dwordx4 v4, s[8:11], s41 offen offset:1024 lds
    buffer_load_dwordx4 v5, s[8:11], s41 offen offset:2048 lds
    s_add_u32 m0, s30, 12288
    s_add_u32 s41, s43, 196608
    buffer_load_dwordx4 v3, s[8:11], s41 offen offset:0 lds
    buffer_load_dwordx4 v4, s[8:11], s41 offen offset:1024 lds
    buffer_load_dwordx4 v5, s[8:11], s41 offen offset:2048 lds
    s_cmp_ge_u32 s33, 2
    s_cbranch_scc1 Lnh_2
    s_add_u32 m0, s19, 0
    s_add_u32 s41, s44, s42
    buffer_load_dwordx4 v20, s[4:7], s41 offen lds
Lnh_2:
    s_add_u32 m0, s18, 0
    s_add_u32 s41, s16, s42
    buffer_load_dwordx4 v6, s[4:7], s41 offen offset:0 lds
    buffer_load_dwordx4 v7, s[4:7], s41 offen offset:1024 lds
    buffer_load_dwordx4 v8, s[4:7], s41 offen offset:2048 lds
    buffer_load_dwordx4 v9, s[4:7], s41 offen offset:3072 lds
    s_add_u32 s42, s45, 1
    s_and_b32 s42, s42, 15
    s_mul_i32 s43, s42, 393216
    s_lshl_b32 s42, s42, 7
    s_add_u32 m0, s30, 43008
    s_add_u32 s41, s43, 0
    buffer_load_dwordx4 v3, s[8:11], s41 offen offset:0 lds
    buffer_load_dwordx4 v4, s[8:11], s41 offen offset:1024 lds
    buffer_load_dwordx4 v5, s[8:11], s41 offen offset:2048 lds
    s_add_u32 m0, s30, 55296
    s_add_u32 s41, s43, 196608
    buffer_load_dwordx4 v3, s[8:11], s41 offen offset:0 lds
    buffer_load_dwordx4 v4, s[8:11], s41 offen offset:1024 lds
    buffer_load_dwordx4 v5, s[8:11], s41 offen offset:2048 lds
    s_cmp_ge_u32 s33, 2
    s_cbranch_scc1 Lnh_3
    s_add_u32 m0, s19, 43008
    s_add_u32 s41, s44, s42
    buffer_load_dwordx4 v20, s[4:7], s41 offen lds
Lnh_3:
    s_add_u32 m0, s18, 43008
    s_add_u32 s41, s16, s42
    buffer_load_dwordx4 v6, s[4:7], s41 offen offset:0 lds
    buffer_load_dwordx4 v7, s[4:7], s41 offen offset:1024 lds
    buffer_load_dwordx4 v8, s[4:7], s41 offen offset:2048 lds
    buffer_load_dwordx4 v9, s[4:7], s41 offen offset:3072 lds
    s_add_u32 s12, s70, 4194304
    s_addc_u32 s13, s71, 0
    s_and_b32 s13, s13, 0xffff
    s_mov_b32 s14, 8388608
    s_mov_b32 s15, 0x20000
    s_lshl_b32 s40, s2, 14
    s_lshl_b32 s41, s33, 12
    s_add_u32 s40, s40, s41
    v_mov_b32 v28, -1
    v_mov_b32 v29, -1
    v_mov_b32 v30, -1
    v_mov_b32 v31, -1
    s_lshl_b32 s40, s32, 1
    s_add_u32 s40, s40, s35
    s_lshl_b32 s40, s40, 17
    s_lshl_b32 s41, s31, 13
    s_add_u32 s40, s40, s41
    s_lshl_b32 s41, s34, 12
    s_add_u32 s40, s40, s41
    buffer_store_dwordx4 v[28:31], v1, s[12:15], s40 offen offset:0 sc1
    buffer_store_dwordx4 v[28:31], v1, s[12:15], s40 offen offset:1024 sc1
    buffer_store_dwordx4 v[28:31], v1, s[12:15], s40 offen offset:2048 sc1
    buffer_store_dwordx4 v[28:31], v1, s[12:15], s40 offen offset:3072 sc1
    s_and_b32 s76, s28, 3
    s_lshl_b32 s76, s76, 2
    s_and_b32 s77, s29, 3
    s_add_u32 s76, s76, s77
    s_lshr_b32 s77, s28, 2
    s_lshl_b32 s77, s77, 3
    s_lshr_b32 s78, s29, 2
    s_add_u32 s77, s77, s78
    s_lshl_b32 s40, s77, 4
    s_add_u32 s40, s40, s76
    s_lshl_b32 s40, s40, 10
    s_mul_i32 s41, s34, 524288
    s_add_u32 s40, s40, s41
    s_add_u32 s40, s40, 262144
    s_cmp_lt_u32 s33, 2
    s_cselect_b32 s40, 2147418112, s40
    buffer_store_dwordx4 v[28:31], v1, s[20:23], s40 offen sc1
    s_bitcmp1_b32 s33, 0
    s_cselect_b32 s84, s62, s60
    s_cselect_b32 s85, s63, s61
    s_lshl_b32 s40, s2, 8
    s_lshl_b32 s41, s35, 7
    s_add_u32 s40, s40, s41
    s_add_u32 s40, s40, 60
    s_add_u32 s86, s84, s40
    s_addc_u32 s87, s85, 0
    s_mov_b32 s88, 0
    s_waitcnt vmcnt(15)
    s_barrier
    s_add_u32 s42, s45, 2
    s_and_b32 s42, s42, 15
    s_mul_i32 s43, s42, 393216
    s_lshl_b32 s42, s42, 7
    s_add_u32 m0, s30, 86016
    s_add_u32 s41, s43, 0
    buffer_load_dwordx4 v3, s[8:11], s41 offen offset:0 lds
    buffer_load_dwordx4 v4, s[8:11], s41 offen offset:1024 lds
    buffer_load_dwordx4 v5, s[8:11], s41 offen offset:2048 lds
    s_add_u32 m0, s30, 98304
    s_add_u32 s41, s43, 196608
    buffer_load_dwordx4 v3, s[8:11], s41 offen offset:0 lds
    buffer_load_dwordx4 v4, s[8:11], s41 offen offset:1024 lds
    buffer_load_dwordx4 v5, s[8:11], s41 offen offset:2048 lds
    s_cmp_ge_u32 s33, 2
    s_cbranch_scc1 Lnh_4
    s_add_u32 m0, s19, 86016
    s_add_u32 s41, s44, s42
    buffer_load_dwordx4 v20, s[4:7], s41 offen lds
Lnh_4:
    s_add_u32 m0, s18, 86016
    s_add_u32 s41, s16, s42
    buffer_load_dwordx4 v6, s[4:7], s41 offen offset:0 lds
    buffer_load_dwordx4 v7, s[4:7], s41 offen offset:1024 lds
    buffer_load_dwordx4 v8, s[4:7], s41 offen offset:2048 lds
    buffer_load_dwordx4 v9, s[4:7], s41 offen offset:3072 lds
    v_lshlrev_b32 v14, 2, v21
    v_add_u32 v15, 147456, v14
    ds_read_b32 v80, v15 offset:0
    ds_read_b32 v81, v15 offset:768
    ds_read_b32 v82, v15 offset:1536
    ds_read_b32 v83, v15 offset:2304
    ds_read_b32 v84, v15 offset:3072
    ds_read_b32 v85, v15 offset:3840
    ds_read_b32 v86, v15 offset:4608
    ds_read_b32 v87, v15 offset:5376
    v_add_u32 v15, 155648, v1
    ds_read_b128 v[88:91], v15
    s_mul_i32 s40, s31, 12288
    s_lshl_b32 s41, s32, 8
    s_add_u32 s40, s40, s41
    s_mul_i32 s41, s33, 3840
    s_add_u32 s40, s40, s41
    s_add_u32 s40, s40, 32768
    s_cmp_eq_u32 s33, 3
    s_cselect_b32 s40, 2147418112, s40
    s_waitcnt lgkmcnt(0)
    v_add_f32 v80, v80, v81
    v_add_f32 v82, v82, v83
    v_add_f32 v84, v84, v85
    v_add_f32 v86, v86, v87
    v_add_f32 v80, v80, v82
    v_add_f32 v84, v84, v86
    v_add_f32 v80, v80, v84
    buffer_store_dword v80, v14, s[20:23], s40 offen sc1
    s_and_b32 s40, s28, 1
    s_lshl_b32 s40, s40, 7
    s_lshr_b32 s41, s28, 1
    s_lshl_b32 s41, s41, 5
    s_add_u32 s40, s40, s41
    s_add_u32 s40, s40, s29
    s_lshl_b32 s40, s40, 6
    s_cmp_lg_u32 s33, 0
    s_cselect_b32 s40, 2147418112, s40
    s_mov_b64 exec, 15
    buffer_store_dwordx4 v[88:91], v1, s[20:23], s40 offen offset:0 sc1
    s_mov_b64 exec, -1
    s_waitcnt vmcnt(17)
    s_barrier
    s_add_u32 s42, s45, 3
    s_and_b32 s42, s42, 15
    s_mul_i32 s43, s42, 393216
    s_lshl_b32 s42, s42, 7
    s_add_u32 m0, s30, 0
    s_add_u32 s41, s43, 0
    buffer_load_dwordx4 v3, s[8:11], s41 offen offset:0 lds
    buffer_load_dwordx4 v4, s[8:11], s41 offen offset:1024 lds
    buffer_load_dwordx4 v5, s[8:11], s41 offen offset:2048 lds
    s_add_u32 m0, s30, 12288
    s_add_u32 s41, s43, 196608
    buffer_load_dwordx4 v3, s[8:11], s41 offen offset:0 lds
    buffer_load_dwordx4 v4, s[8:11], s41 offen offset:1024 lds
    buffer_load_dwordx4 v5, s[8:11], s41 offen offset:2048 lds
    s_cmp_ge_u32 s33, 2
    s_cbranch_scc1 Lnh_5
    s_add_u32 m0, s19, 0
    s_add_u32 s41, s44, s42
    buffer_load_dwordx4 v20, s[4:7], s41 offen lds
Lnh_5:
    s_add_u32 m0, s18, 0
    s_add_u32 s41, s16, s42
    buffer_load_dwordx4 v6, s[4:7], s41 offen offset:0 lds
    buffer_load_dwordx4 v7, s[4:7], s41 offen offset:1024 lds
    buffer_load_dwordx4 v8, s[4:7], s41 offen offset:2048 lds
    buffer_load_dwordx4 v9, s[4:7], s41 offen offset:3072 lds
    s_load_dwordx2 s[38:39], s[86:87], s88
    s_add_u32 s88, s88, 65536
    s_load_dwordx2 s[38:39], s[86:87], s88
    s_add_u32 s88, s88, 65536
    s_load_dwordx2 s[38:39], s[86:87], s88
    s_add_u32 s88, s88, 65536
    s_waitcnt vmcnt(12)
    s_barrier
    s_add_u32 s42, s45, 4
    s_and_b32 s42, s42, 15
    s_mul_i32 s43, s42, 393216
    s_lshl_b32 s42, s42, 7
    s_add_u32 m0, s30, 43008
    s_add_u32 s41, s43, 0
    buffer_load_dwordx4 v3, s[8:11], s41 offen offset:0 lds
    buffer_load_dwordx4 v4, s[8:11], s41 offen offset:1024 lds
    buffer_load_dwordx4 v5, s[8:11], s41 offen offset:2048 lds
    s_add_u32 m0, s30, 55296
    s_add_u32 s41, s43, 196608
    buffer_load_dwordx4 v3, s[8:11], s41 offen offset:0 lds
    buffer_load_dwordx4 v4, s[8:11], s41 offen offset:1024 lds
    buffer_load_dwordx4 v5, s[8:11], s41 offen offset:2048 lds
    s_cmp_ge_u32 s33, 2
    s_cbranch_scc1 Lnh_6
    s_add_u32 m0, s19, 43008
    s_add_u32 s41, s44, s42
    buffer_load_dwordx4 v20, s[4:7], s41 offen lds
Lnh_6:
    s_add_u32 m0, s18, 43008
    s_add_u32 s41, s16, s42
    buffer_load_dwordx4 v6, s[4:7], s41 offen offset:0 lds
    buffer_load_dwordx4 v7, s[4:7], s41 offen offset:1024 lds
    buffer_load_dwordx4 v8, s[4:7], s41 offen offset:2048 lds
    buffer_load_dwordx4 v9, s[4:7], s41 offen offset:3072 lds
    s_load_dwordx2 s[38:39], s[86:87], s88
    s_add_u32 s88, s88, 65536
    s_load_dwordx2 s[38:39], s[86:87], s88
    s_add_u32 s88, s88, 65536
    s_load_dwordx2 s[38:39], s[86:87], s88
    s_add_u32 s88, s88, 65536
    s_waitcnt vmcnt(10)
    s_barrier
    s_add_u32 s42, s45, 5
    s_and_b32 s42, s42, 15
    s_mul_i32 s43, s42, 393216
    s_lshl_b32 s42, s42, 7
    s_add_u32 m0, s30, 86016
    s_add_u32 s41, s43, 0
    buffer_load_dwordx4 v3, s[8:11], s41 offen offset:0 lds
    buffer_load_dwordx4 v4, s[8:11], s41 offen offset:1024 lds
    buffer_load_dwordx4 v5, s[8:11], s41 offen offset:2048 lds
    s_add_u32 m0, s30, 98304
    s_add_u32 s41, s43, 196608
    buffer_load_dwordx4 v3, s[8:11], s41 offen offset:0 lds
    buffer_load_dwordx4 v4, s[8:11], s41 offen offset:1024 lds
    buffer_load_dwordx4 v5, s[8:11], s41 offen offset:2048 lds
    s_cmp_ge_u32 s33, 2
    s_cbranch_scc1 Lnh_7
    s_add_u32 m0, s19, 86016
    s_add_u32 s41, s44, s42
    buffer_load_dwordx4 v20, s[4:7], s41 offen lds
Lnh_7:
    s_add_u32 m0, s18, 86016
    s_add_u32 s41, s16, s42
    buffer_load_dwordx4 v6, s[4:7], s41 offen offset:0 lds
    buffer_load_dwordx4 v7, s[4:7], s41 offen offset:1024 lds
    buffer_load_dwordx4 v8, s[4:7], s41 offen offset:2048 lds
    buffer_load_dwordx4 v9, s[4:7], s41 offen offset:3072 lds
    s_load_dwordx2 s[38:39], s[86:87], s88
    s_add_u32 s88, s88, 65536
    s_load_dwordx2 s[38:39], s[86:87], s88
    s_add_u32 s88, s88, 65536
    s_load_dwordx2 s[38:39], s[86:87], s88
    s_add_u32 s88, s88, 65536
    s_waitcnt vmcnt(10)
    s_barrier
    s_add_u32 s42, s45, 6
    s_and_b32 s42, s42, 15
    s_mul_i32 s43, s42, 393216
    s_lshl_b32 s42, s42, 7
    s_add_u32 m0, s30, 0
    s_add_u32 s41, s43, 0
    buffer_load_dwordx4 v3, s[8:11], s41 offen offset:0 lds
    buffer_load_dwordx4 v4, s[8:11], s41 offen offset:1024 lds
    buffer_load_dwordx4 v5, s[8:11], s41 offen offset:2048 lds
    s_add_u32 m0, s30, 12288
    s_add_u32 s41, s43, 196608
    buffer_load_dwordx4 v3, s[8:11], s41 offen offset:0 lds
    buffer_load_dwordx4 v4, s[8:11], s41 offen offset:1024 lds
    buffer_load_dwordx4 v5, s[8:11], s41 offen offset:2048 lds
    s_cmp_ge_u32 s33, 2
    s_cbranch_scc1 Lnh_8
    s_add_u32 m0, s19, 0
    s_add_u32 s41, s44, s42
    buffer_load_dwordx4 v20, s[4:7], s41 offen lds
Lnh_8:
    s_add_u32 m0, s18, 0
    s_add_u32 s41, s16, s42
    buffer_load_dwordx4 v6, s[4:7], s41 offen offset:0 lds
    buffer_load_dwordx4 v7, s[4:7], s41 offen offset:1024 lds
    buffer_load_dwordx4 v8, s[4:7], s41 offen offset:2048 lds
    buffer_load_dwordx4 v9, s[4:7], s41 offen offset:3072 lds
    s_load_dwordx2 s[38:39], s[86:87], s88
    s_add_u32 s88, s88, 65536
    s_load_dwordx2 s[38:39], s[86:87], s88
    s_add_u32 s88, s88, 65536
    s_load_dwordx2 s[38:39], s[86:87], s88
    s_add_u32 s88, s88, 65536
    s_waitcnt vmcnt(10)
    s_barrier
    s_add_u32 s42, s45, 7
    s_and_b32 s42, s42, 15
    s_mul_i32 s43, s42, 393216
    s_lshl_b32 s42, s42, 7
    s_add_u32 m0, s30, 43008
    s_add_u32 s41, s43, 0
    buffer_load_dwordx4 v3, s[8:11], s41 offen offset:0 lds
    buffer_load_dwordx4 v4, s[8:11], s41 offen offset:1024 lds
    buffer_load_dwordx4 v5, s[8:11], s41 offen offset:2048 lds
    s_add_u32 m0, s30, 55296
    s_add_u32 s41, s43, 196608
    buffer_load_dwordx4 v3, s[8:11], s41 offen offset:0 lds
    buffer_load_dwordx4 v4, s[8:11], s41 offen offset:1024 lds
    buffer_load_dwordx4 v5, s[8:11], s41 offen offset:2048 lds
    s_cmp_ge_u32 s33, 2
    s_cbranch_scc1 Lnh_9
    s_add_u32 m0, s19, 43008
    s_add_u32 s41, s44, s42
    buffer_load_dwordx4 v20, s[4:7], s41 offen lds
Lnh_9:
    s_add_u32 m0, s18, 43008
    s_add_u32 s41, s16, s42
    buffer_load_dwordx4 v6, s[4:7], s41 offen offset:0 lds
    buffer_load_dwordx4 v7, s[4:7], s41 offen offset:1024 lds
    buffer_load_dwordx4 v8, s[4:7], s41 offen offset:2048 lds
    buffer_load_dwordx4 v9, s[4:7], s41 offen offset:3072 lds
    s_mov_b32 s24, s68
    s_and_b32 s25, s69, 0xffff
    s_mov_b32 s26, 256
    s_mov_b32 s27, 0x20000
    s_and_b32 s40, s2, 15
    s_mul_i32 s40, s40, 16
    s_cmp_lg_u32 s33, 0
    s_cselect_b32 s40, 2147418112, s40
    v_mov_b32 v2, 1
    s_mov_b64 exec, 1
    buffer_atomic_add v2, off, s[24:27], s40 sc1
    s_mov_b64 exec, -1
    v_and_b32 v12, 15, v0
    v_mul_u32_u24 v12, 16, v12
    s_load_dwordx2 s[38:39], s[86:87], s88
    s_add_u32 s88, s88, 65536
    s_load_dwordx2 s[38:39], s[86:87], s88
    s_add_u32 s88, s88, 65536
    s_load_dwordx2 s[38:39], s[86:87], s88
    s_add_u32 s88, s88, 65536
    s_waitcnt vmcnt(11)
    s_barrier
    s_add_u32 s42, s45, 8
    s_and_b32 s42, s42, 15
    s_mul_i32 s43, s42, 393216
    s_lshl_b32 s42, s42, 7
    s_add_u32 m0, s30, 86016
    s_add_u32 s41, s43, 0
    buffer_load_dwordx4 v3, s[8:11], s41 offen offset:0 lds
    buffer_load_dwordx4 v4, s[8:11], s41 offen offset:1024 lds
    buffer_load_dwordx4 v5, s[8:11], s41 offen offset:2048 lds
    s_add_u32 m0, s30, 98304
    s_add_u32 s41, s43, 196608
    buffer_load_dwordx4 v3, s[8:11], s41 offen offset:0 lds
    buffer_load_dwordx4 v4, s[8:11], s41 offen offset:1024 lds
    buffer_load_dwordx4 v5, s[8:11], s41 offen offset:2048 lds
    s_cmp_ge_u32 s33, 2
    s_cbranch_scc1 Lnh_10
    s_add_u32 m0, s19, 86016
    s_add_u32 s41, s44, s42
    buffer_load_dwordx4 v20, s[4:7], s41 offen lds
Lnh_10:
    s_add_u32 m0, s18, 86016
    s_add_u32 s41, s16, s42
    buffer_load_dwordx4 v6, s[4:7], s41 offen offset:0 lds
    buffer_load_dwordx4 v7, s[4:7], s41 offen offset:1024 lds
    buffer_load_dwordx4 v8, s[4:7], s41 offen offset:2048 lds
    buffer_load_dwordx4 v9, s[4:7], s41 offen offset:3072 lds
    s_load_dwordx2 s[38:39], s[86:87], s88
    s_add_u32 s88, s88, 65536
    s_load_dwordx2 s[38:39], s[86:87], s88
    s_add_u32 s88, s88, 65536
    s_load_dwordx2 s[38:39], s[86:87], s88
    s_add_u32 s88, s88, 65536
    s_waitcnt vmcnt(11)
    s_barrier
    s_add_u32 s42, s45, 9
    s_and_b32 s42, s42, 15
    s_mul_i32 s43, s42, 393216
    s_lshl_b32 s42, s42, 7
    s_add_u32 m0, s30, 0
    s_add_u32 s41, s43, 0
    buffer_load_dwordx4 v3, s[8:11], s41 offen offset:0 lds
    buffer_load_dwordx4 v4, s[8:11], s41 offen offset:1024 lds
    buffer_load_dwordx4 v5, s[8:11], s41 offen offset:2048 lds
    s_add_u32 m0, s30, 12288
    s_add_u32 s41, s43, 196608
    buffer_load_dwordx4 v3, s[8:11], s41 offen offset:0 lds
    buffer_load_dwordx4 v4, s[8:11], s41 offen offset:1024 lds
    buffer_load_dwordx4 v5, s[8:11], s41 offen offset:2048 lds
    s_cmp_ge_u32 s33, 2
    s_cbranch_scc1 Lnh_11
    s_add_u32 m0, s19, 0
    s_add_u32 s41, s44, s42
    buffer_load_dwordx4 v20, s[4:7], s41 offen lds
Lnh_11:
    s_add_u32 m0, s18, 0
    s_add_u32 s41, s16, s42
    buffer_load_dwordx4 v6, s[4:7], s41 offen offset:0 lds
    buffer_load_dwordx4 v7, s[4:7], s41 offen offset:1024 lds
    buffer_load_dwordx4 v8, s[4:7], s41 offen offset:2048 lds
    buffer_load_dwordx4 v9, s[4:7], s41 offen offset:3072 lds
    s_load_dwordx2 s[38:39], s[86:87], s88
    s_add_u32 s88, s88, 65536
    s_load_dwordx2 s[38:39], s[86:87], s88
    s_add_u32 s88, s88, 65536
    s_load_dwordx2 s[38:39], s[86:87], s88
    s_add_u32 s88, s88, 65536
    s_waitcnt vmcnt(10)
    s_barrier
    s_add_u32 s42, s45, 10
    s_and_b32 s42, s42, 15
    s_mul_i32 s43, s42, 393216
    s_lshl_b32 s42, s42, 7
    s_add_u32 m0, s30, 43008
    s_add_u32 s41, s43, 0
    buffer_load_dwordx4 v3, s[8:11], s41 offen offset:0 lds
    buffer_load_dwordx4 v4, s[8:11], s41 offen offset:1024 lds
    buffer_load_dwordx4 v5, s[8:11], s41 offen offset:2048 lds
    s_add_u32 m0, s30, 55296
    s_add_u32 s41, s43, 196608
    buffer_load_dwordx4 v3, s[8:11], s41 offen offset:0 lds
    buffer_load_dwordx4 v4, s[8:11], s41 offen offset:1024 lds
    buffer_load_dwordx4 v5, s[8:11], s41 offen offset:2048 lds
    s_cmp_ge_u32 s33, 2
    s_cbranch_scc1 Lnh_12
    s_add_u32 m0, s19, 43008
    s_add_u32 s41, s44, s42
    buffer_load_dwordx4 v20, s[4:7], s41 offen lds
Lnh_12:
    s_add_u32 m0, s18, 43008
    s_add_u32 s41, s16, s42
    buffer_load_dwordx4 v6, s[4:7], s41 offen offset:0 lds
    buffer_load_dwordx4 v7, s[4:7], s41 offen offset:1024 lds
    buffer_load_dwordx4 v8, s[4:7], s41 offen offset:2048 lds
    buffer_load_dwordx4 v9, s[4:7], s41 offen offset:3072 lds
    s_load_dwordx2 s[38:39], s[86:87], s88
    s_add_u32 s88, s88, 65536
    s_load_dwordx2 s[38:39], s[86:87], s88
    s_add_u32 s88, s88, 65536
    s_load_dwordx2 s[38:39], s[86:87], s88
    s_add_u32 s88, s88, 65536
    s_waitcnt vmcnt(10)
    s_barrier
    s_add_u32 s42, s45, 11
    s_and_b32 s42, s42, 15
    s_mul_i32 s43, s42, 393216
    s_lshl_b32 s42, s42, 7
    s_add_u32 m0, s30, 86016
    s_add_u32 s41, s43, 0
    buffer_load_dwordx4 v3, s[8:11], s41 offen offset:0 lds
    buffer_load_dwordx4 v4, s[8:11], s41 offen offset:1024 lds
    buffer_load_dwordx4 v5, s[8:11], s41 offen offset:2048 lds
    s_add_u32 m0, s30, 98304
    s_add_u32 s41, s43, 196608
    buffer_load_dwordx4 v3, s[8:11], s41 offen offset:0 lds
    buffer_load_dwordx4 v4, s[8:11], s41 offen offset:1024 lds
    buffer_load_dwordx4 v5, s[8:11], s41 offen offset:2048 lds
    s_cmp_ge_u32 s33, 2
    s_cbranch_scc1 Lnh_13
    s_add_u32 m0, s19, 86016
    s_add_u32 s41, s44, s42
    buffer_load_dwordx4 v20, s[4:7], s41 offen lds
Lnh_13:
    s_add_u32 m0, s18, 86016
    s_add_u32 s41, s16, s42
    buffer_load_dwordx4 v6, s[4:7], s41 offen offset:0 lds
    buffer_load_dwordx4 v7, s[4:7], s41 offen offset:1024 lds
    buffer_load_dwordx4 v8, s[4:7], s41 offen offset:2048 lds
    buffer_load_dwordx4 v9, s[4:7], s41 offen offset:3072 lds
    s_cmp_lg_u32 s33, 0
    s_cselect_b32 s40, 2147418112, 0
    buffer_load_dword v13, v12, s[24:27], s40 offen sc1
    s_load_dwordx2 s[38:39], s[86:87], s88
    s_add_u32 s88, s88, 65536
    s_load_dwordx2 s[38:39], s[86:87], s88
    s_add_u32 s88, s88, 65536
    s_load_dwordx2 s[38:39], s[86:87], s88
    s_add_u32 s88, s88, 65536
    s_waitcnt vmcnt(11)
    s_barrier
    s_add_u32 s42, s45, 12
    s_and_b32 s42, s42, 15
    s_mul_i32 s43, s42, 393216
    s_lshl_b32 s42, s42, 7
    s_add_u32 m0, s30, 0
    s_add_u32 s41, s43, 0
    buffer_load_dwordx4 v3, s[8:11], s41 offen offset:0 lds
    buffer_load_dwordx4 v4, s[8:11], s41 offen offset:1024 lds
    buffer_load_dwordx4 v5, s[8:11], s41 offen offset:2048 lds
    s_add_u32 m0, s30, 12288
    s_add_u32 s41, s43, 196608
    buffer_load_dwordx4 v3, s[8:11], s41 offen offset:0 lds
    buffer_load_dwordx4 v4, s[8:11], s41 offen offset:1024 lds
    buffer_load_dwordx4 v5, s[8:11], s41 offen offset:2048 lds
    s_cmp_ge_u32 s33, 2
    s_cbranch_scc1 Lnh_14
    s_add_u32 m0, s19, 0
    s_add_u32 s41, s44, s42
    buffer_load_dwordx4 v20, s[4:7], s41 offen lds
Lnh_14:
    s_add_u32 m0, s18, 0
    s_add_u32 s41, s16, s42
    buffer_load_dwordx4 v6, s[4:7], s41 offen offset:0 lds
    buffer_load_dwordx4 v7, s[4:7], s41 offen offset:1024 lds
    buffer_load_dwordx4 v8, s[4:7], s41 offen offset:2048 lds
    buffer_load_dwordx4 v9, s[4:7], s41 offen offset:3072 lds
    s_load_dwordx2 s[38:39], s[86:87], s88
    s_add_u32 s88, s88, 65536
    s_load_dwordx2 s[38:39], s[86:87], s88
    s_add_u32 s88, s88, 65536
    s_load_dwordx2 s[38:39], s[86:87], s88
    s_add_u32 s88, s88, 65536
    s_waitcnt vmcnt(11)
    s_barrier
    s_add_u32 s42, s45, 13
    s_and_b32 s42, s42, 15
    s_mul_i32 s43, s42, 393216
    s_lshl_b32 s42, s42, 7
    s_add_u32 m0, s30, 43008
    s_add_u32 s41, s43, 0
    buffer_load_dwordx4 v3, s[8:11], s41 offen offset:0 lds
    buffer_load_dwordx4 v4, s[8:11], s41 offen offset:1024 lds
    buffer_load_dwordx4 v5, s[8:11], s41 offen offset:2048 lds
    s_add_u32 m0, s30, 55296
    s_add_u32 s41, s43, 196608
    buffer_load_dwordx4 v3, s[8:11], s41 offen offset:0 lds
    buffer_load_dwordx4 v4, s[8:11], s41 offen offset:1024 lds
    buffer_load_dwordx4 v5, s[8:11], s41 offen offset:2048 lds
    s_cmp_ge_u32 s33, 2
    s_cbranch_scc1 Lnh_15
    s_add_u32 m0, s19, 43008
    s_add_u32 s41, s44, s42
    buffer_load_dwordx4 v20, s[4:7], s41 offen lds
Lnh_15:
    s_add_u32 m0, s18, 43008
    s_add_u32 s41, s16, s42
    buffer_load_dwordx4 v6, s[4:7], s41 offen offset:0 lds
    buffer_load_dwordx4 v7, s[4:7], s41 offen offset:1024 lds
    buffer_load_dwordx4 v8, s[4:7], s41 offen offset:2048 lds
    buffer_load_dwordx4 v9, s[4:7], s41 offen offset:3072 lds
    s_waitcnt vmcnt(20)
    s_cmp_lg_u32 s33, 0
    s_cbranch_scc1 Lcok_16
    v_cmp_gt_u32 vcc, 16, v13
    s_cbranch_vccz Lcok_16
    s_mov_b32 s101, 0
Lpoll_17:
    s_add_u32 s101, s101, 1
    s_cmp_ge_u32 s101, 200000
    s_cbranch_scc1 Lpoll_17x
    s_sleep 2
    buffer_load_dword v13, v12, s[24:27], 0 offen sc1
    s_waitcnt vmcnt(0)
    v_cmp_gt_u32 vcc, 16, v13
    s_cbranch_vccnz Lpoll_17
Lpoll_17x:
Lcok_16:
    s_load_dwordx2 s[38:39], s[86:87], s88
    s_add_u32 s88, s88, 65536
    s_load_dwordx2 s[38:39], s[86:87], s88
    s_add_u32 s88, s88, 65536
    s_load_dwordx2 s[38:39], s[86:87], s88
    s_add_u32 s88, s88, 65536
    s_waitcnt vmcnt(10)
    s_barrier
    s_add_u32 s42, s45, 14
    s_and_b32 s42, s42, 15
    s_mul_i32 s43, s42, 393216
    s_lshl_b32 s42, s42, 7
    s_add_u32 m0, s30, 86016
    s_add_u32 s41, s43, 0
    buffer_load_dwordx4 v3, s[8:11], s41 offen offset:0 lds
    buffer_load_dwordx4 v4, s[8:11], s41 offen offset:1024 lds
    buffer_load_dwordx4 v5, s[8:11], s41 offen offset:2048 lds
    s_add_u32 m0, s30, 98304
    s_add_u32 s41, s43, 196608
    buffer_load_dwordx4 v3, s[8:11], s41 offen offset:0 lds
    buffer_load_dwordx4 v4, s[8:11], s41 offen offset:1024 lds
    buffer_load_dwordx4 v5, s[8:11], s41 offen offset:2048 lds
    s_cmp_ge_u32 s33, 2
    s_cbranch_scc1 Lnh_18
    s_add_u32 m0, s19, 86016
    s_add_u32 s41, s44, s42
    buffer_load_dwordx4 v20, s[4:7], s41 offen lds
Lnh_18:
    s_add_u32 m0, s18, 86016
    s_add_u32 s41, s16, s42
    buffer_load_dwordx4 v6, s[4:7], s41 offen offset:0 lds
    buffer_load_dwordx4 v7, s[4:7], s41 offen offset:1024 lds
    buffer_load_dwordx4 v8, s[4:7], s41 offen offset:2048 lds
    buffer_load_dwordx4 v9, s[4:7], s41 offen offset:3072 lds
    buffer_load_dwordx2 v[26:27], v22, s[20:23], 0 offen offset:0 sc1
    buffer_load_dwordx4 v[140:143], v24, s[20:23], s49 offen sc1
    s_add_u32 s49, s49, 49152
    buffer_load_dwordx4 v[144:147], v24, s[20:23], s49 offen sc1
    s_add_u32 s49, s49, 49152
    buffer_load_dwordx4 v[148:151], v24, s[20:23], s49 offen sc1
    s_add_u32 s49, s49, 49152
    buffer_load_dwordx4 v[152:155], v24, s[20:23], s49 offen sc1
    s_waitcnt vmcnt(15)
    s_barrier
    s_add_u32 s42, s45, 15
    s_and_b32 s42, s42, 15
    s_mul_i32 s43, s42, 393216
    s_lshl_b32 s42, s42, 7
    s_add_u32 m0, s30, 0
    s_add_u32 s41, s43, 0
    buffer_load_dwordx4 v3, s[8:11], s41 offen offset:0 lds
    buffer_load_dwordx4 v4, s[8:11], s41 offen offset:1024 lds
    buffer_load_dwordx4 v5, s[8:11], s41 offen offset:2048 lds
    s_add_u32 m0, s30, 12288
    s_add_u32 s41, s43, 196608
    buffer_load_dwordx4 v3, s[8:11], s41 offen offset:0 lds
    buffer_load_dwordx4 v4, s[8:11], s41 offen offset:1024 lds
    buffer_load_dwordx4 v5, s[8:11], s41 offen offset:2048 lds
    s_cmp_ge_u32 s33, 2
    s_cbranch_scc1 Lnh_19
    s_add_u32 m0, s19, 0
    s_add_u32 s41, s44, s42
    buffer_load_dwordx4 v20, s[4:7], s41 offen lds
Lnh_19:
    s_add_u32 m0, s18, 0
    s_add_u32 s41, s16, s42
    buffer_load_dwordx4 v6, s[4:7], s41 offen offset:0 lds
    buffer_load_dwordx4 v7, s[4:7], s41 offen offset:1024 lds
    buffer_load_dwordx4 v8, s[4:7], s41 offen offset:2048 lds
    buffer_load_dwordx4 v9, s[4:7], s41 offen offset:3072 lds
    s_and_b32 s76, s28, 3
    s_lshl_b32 s76, s76, 2
    s_and_b32 s77, s29, 3
    s_add_u32 s76, s76, s77
    s_lshr_b32 s77, s28, 2
    s_lshl_b32 s77, s77, 3
    s_lshr_b32 s78, s29, 2
    s_add_u32 s77, s77, s78
    s_mov_b32 s12, s56
    s_and_b32 s13, s57, 0xffff
    s_mov_b32 s14, 2097152
    s_mov_b32 s15, 0x20000
    v_bfe_u32 v37, v0, 4, 2
    v_lshlrev_b32 v37, 1, v37
    v_and_b32 v38, 7, v0
    v_xor_b32 v38, v38, v37
    v_lshrrev_b32 v36, 3, v0
    s_lshl_b32 s40, s33, 3
    v_add_u32 v36, s40, v36
    v_lshlrev_b32 v36, 11, v36
    v_lshl_add_u32 v36, v38, 4, v36
    s_lshl_b32 s40, s77, 7
    v_add_u32 v36, s40, v36
    s_lshl_b32 s40, s2, 13
    s_lshl_b32 s41, s33, 11
    s_add_u32 s40, s40, s41
    buffer_load_dwordx4 a[0:3], v1, s[12:15], s40 offen offset:0
    buffer_load_dwordx4 a[0:3], v1, s[12:15], s40 offen offset:1024
    buffer_load_dwordx4 a[4:7], v1, s[72:75], s79 offen
    s_waitcnt vmcnt(18)
    s_barrier
    s_waitcnt vmcnt(13)
    v_add_f32 v140, v140, v148
    v_add_f32 v141, v141, v149
    v_add_f32 v142, v142, v150
    v_add_f32 v143, v143, v151
    v_add_f32 v144, v144, v152
    v_add_f32 v145, v145, v153
    v_add_f32 v146, v146, v154
    v_add_f32 v147, v147, v155
    v_add_f32 v140, v140, v144
    v_add_f32 v141, v141, v145
    v_add_f32 v142, v142, v146
    v_add_f32 v143, v143, v147
    v_mov_b32 v144, v140
    v_mov_b32 v145, v141
    v_mov_b32 v146, v142
    v_mov_b32 v147, v143
    s_nop 1
    v_permlane16_swap_b32 v140, v144
    v_permlane16_swap_b32 v141, v145
    v_permlane16_swap_b32 v142, v146
    v_permlane16_swap_b32 v143, v147
    s_nop 1
    v_add_f32 v140, v140, v144
    v_add_f32 v141, v141, v145
    v_add_f32 v142, v142, v146
    v_add_f32 v143, v143, v147
    v_mov_b32 v144, v140
    v_mov_b32 v145, v141
    v_mov_b32 v146, v142
    v_mov_b32 v147, v143
    s_nop 1
    v_permlane32_swap_b32 v140, v144
    v_permlane32_swap_b32 v141, v145
    v_permlane32_swap_b32 v142, v146
    v_permlane32_swap_b32 v143, v147
    s_nop 1
    v_add_f32 v140, v140, v144
    v_add_f32 v141, v141, v145
    v_add_f32 v142, v142, v146
    v_add_f32 v143, v143, v147
    v_lshlrev_b32 v13, 2, v21
    v_add_u32 v13, 131072, v13
    ds_write_b32 v13, v26
    ds_write_b32 v13, v27 offset:1024
    s_lshl_b32 s40, s33, 8
    s_add_u32 s40, s40, 133120
    v_add_u32 v14, s40, v1
    s_mov_b64 exec, 0xffff
    ds_write_b128 v14, v[140:143]
    s_mov_b64 exec, -1
    s_waitcnt lgkmcnt(0)
    s_waitcnt vmcnt(3)
    s_barrier
    s_lshl_b32 s40, s33, 10
    s_add_u32 s40, s40, 45056
    s_mov_b32 s41, 720896
Lwl_20:
    s_mov_b32 m0, s40
    s_add_u32 s40, s40, 4096
    buffer_load_dwordx4 v36, s[12:15], s41 offen lds
    s_add_u32 s41, s41, 65536
    s_cmp_lt_u32 s41, 2097152
    s_cbranch_scc1 Lwl_20
    s_and_b32 s76, s28, 3
    s_lshl_b32 s76, s76, 2
    s_and_b32 s77, s29, 3
    s_add_u32 s76, s76, s77
    s_lshr_b32 s77, s28, 2
    s_lshl_b32 s77, s77, 3
    s_lshr_b32 s78, s29, 2
    s_add_u32 s77, s77, s78
    s_lshl_b32 s48, s76, 18
    s_lshl_b32 s40, s33, 16
    s_add_u32 s48, s48, s40
    s_lshl_b32 s40, s77, 7
    s_add_u32 s48, s48, s40
    v_and_b32 v40, 7, v0
    v_lshlrev_b32 v40, 12, v40
    v_bfe_u32 v41, v0, 4, 1
    v_lshl_add_u32 v40, v41, 5, v40
    v_lshrrev_b32 v41, 5, v0
    v_lshl_add_u32 v40, v41, 4, v40
    v_bfe_u32 v41, v0, 3, 1
    v_lshl_add_u32 v40, v41, 6, v40
    buffer_load_dwordx4 a[88:91], v40, s[4:7], s48 offen
    s_add_u32 s40, s48, 32768
    buffer_load_dwordx4 a[92:95], v40, s[4:7], s40 offen
    buffer_load_dwordx4 a[80:83], v40, s[4:7], s48 offen offset:2048
    s_add_u32 s40, s48, 32768
    buffer_load_dwordx4 a[84:87], v40, s[4:7], s40 offen offset:2048
    s_mov_b32 s17, 0
    s_lshl_b32 s16, s76, 13
    s_lshl_b32 s40, s33, 11
    s_add_u32 s16, s16, s40
    s_lshl_b32 s18, s76, 11
    s_lshl_b32 s40, s77, 7
    s_add_u32 s18, s18, s40
    s_add_u32 s18, s18, 1310720
    s_lshl_b32 s19, s76, 18
    s_lshl_b32 s40, s33, 16
    s_add_u32 s19, s19, s40
    s_lshl_b32 s40, s77, 7
    s_add_u32 s19, s19, s40
    s_add_u32 s4, s70, 4194304
    s_addc_u32 s5, s71, 0
    s_and_b32 s5, s5, 0xffff
    s_mov_b32 s6, 4194304
    s_mov_b32 s7, 0x20000
    s_mov_b64 s[46:47], 0
    s_mov_b32 s49, -2
    s_mov_b32 s37, 0
    s_mov_b32 s101, 0
    s_mov_b32 s39, 0
    s_mov_b64 s[80:81], 0
    s_mov_b64 s[82:83], 0
    v_mov_b32 v8, 163808
    s_mov_b32 s43, s18
    s_mov_b32 s44, 67372036
    s_mov_b32 s45, 67372036
    s_nop 0
    v_add_u32 v24, 0, v1
    v_xor_b32 v25, 1024, v24
    v_mov_b32 v4, 0
    v_mov_b32 v5, 0
    v_mov_b32 v2, 163788
Llw_21:
    ds_read_b32 v3, v2
    s_waitcnt lgkmcnt(0)
    v_cmp_gt_u32 vcc, 4, v3
    s_cbranch_vccnz Llw_21
    s_lshl_b32 s40, s33, 10
    s_add_u32 s40, s40, 0
    s_mov_b32 s41, 0
Lwl_22:
    s_mov_b32 m0, s40
    s_add_u32 s40, s40, 4096
    buffer_load_dwordx4 v36, s[12:15], s41 offen lds
    s_add_u32 s41, s41, 65536
    s_cmp_lt_u32 s41, 720896
    s_cbranch_scc1 Lwl_22
    s_lshr_b32 s40, s2, 1
    s_lshl_b32 s40, s40, 7
    s_and_b32 s41, s29, 3
    s_lshl_b32 s41, s41, 7
    s_add_u32 s41, s41, 16384
    v_mov_b32 v14, s40
    v_writelane_b32 v14, s41, 1
    s_cmp_lg_u32 s33, 1
    s_mov_b32 s40, 1409028
    s_cselect_b32 s40, 2147418112, s40
    v_mul_u32_u24 v14, 1, v14
    v_mov_b32 v15, 1
    s_mov_b64 exec, 1
    buffer_atomic_add v15, v14, s[20:23], s40 offen sc0 sc1
    s_mov_b64 exec, -1
    s_waitcnt vmcnt(1)
    v_mov_b32 v2, 163780
    v_mov_b32 v3, 1
    s_mov_b64 exec, 1
    ds_add_u32 v2, v3
    s_mov_b64 exec, -1
    v_accvgpr_read_b32 v128, a88
    v_accvgpr_read_b32 v129, a89
    v_accvgpr_read_b32 v130, a90
    v_accvgpr_read_b32 v131, a91
    v_accvgpr_read_b32 v132, a92
    v_accvgpr_read_b32 v133, a93
    v_accvgpr_read_b32 v134, a94
    v_accvgpr_read_b32 v135, a95
    v_accvgpr_read_b32 v136, a88
    v_accvgpr_read_b32 v137, a89
    v_accvgpr_read_b32 v138, a90
    v_accvgpr_read_b32 v139, a91
    v_mov_b32_dpp v128, v132 row_ror:8 row_mask:0xf bank_mask:0xc
    v_mov_b32_dpp v129, v133 row_ror:8 row_mask:0xf bank_mask:0xc
    v_mov_b32_dpp v130, v134 row_ror:8 row_mask:0xf bank_mask:0xc
    v_mov_b32_dpp v131, v135 row_ror:8 row_mask:0xf bank_mask:0xc
    v_mov_b32_dpp v132, v136 row_ror:8 row_mask:0xf bank_mask:0x3
    v_mov_b32_dpp v133, v137 row_ror:8 row_mask:0xf bank_mask:0x3
    v_mov_b32_dpp v134, v138 row_ror:8 row_mask:0xf bank_mask:0x3
    v_mov_b32_dpp v135, v139 row_ror:8 row_mask:0xf bank_mask:0x3
    v_permlane16_swap_b32 v128, v130
    v_permlane16_swap_b32 v129, v131
    v_permlane16_swap_b32 v132, v134
    v_permlane16_swap_b32 v133, v135
    s_nop 0
    v_lshlrev_b32 v32, 16, v128
    v_and_b32 v33, 0xffff0000, v128
    v_lshlrev_b32 v34, 16, v129
    v_and_b32 v35, 0xffff0000, v129
    v_lshlrev_b32 v36, 16, v130
    v_and_b32 v37, 0xffff0000, v130
    v_lshlrev_b32 v38, 16, v131
    v_and_b32 v39, 0xffff0000, v131
    v_lshlrev_b32 v40, 16, v132
    v_and_b32 v41, 0xffff0000, v132
    v_lshlrev_b32 v42, 16, v133
    v_and_b32 v43, 0xffff0000, v133
    v_lshlrev_b32 v44, 16, v134
    v_and_b32 v45, 0xffff0000, v134
    v_lshlrev_b32 v46, 16, v135
    v_and_b32 v47, 0xffff0000, v135
    v_accvgpr_read_b32 v128, a80
    v_accvgpr_read_b32 v129, a81
    v_accvgpr_read_b32 v130, a82
    v_accvgpr_read_b32 v131, a83
    v_accvgpr_read_b32 v132, a84
    v_accvgpr_read_b32 v133, a85
    v_accvgpr_read_b32 v134, a86
    v_accvgpr_read_b32 v135, a87
    v_accvgpr_read_b32 v136, a80
    v_accvgpr_read_b32 v137, a81
    v_accvgpr_read_b32 v138, a82
    v_accvgpr_read_b32 v139, a83
    v_mov_b32_dpp v128, v132 row_ror:8 row_mask:0xf bank_mask:0xc
    v_mov_b32_dpp v129, v133 row_ror:8 row_mask:0xf bank_mask:0xc
    v_mov_b32_dpp v130, v134 row_ror:8 row_mask:0xf bank_mask:0xc
    v_mov_b32_dpp v131, v135 row_ror:8 row_mask:0xf bank_mask:0xc
    v_mov_b32_dpp v132, v136 row_ror:8 row_mask:0xf bank_mask:0x3
    v_mov_b32_dpp v133, v137 row_ror:8 row_mask:0xf bank_mask:0x3
    v_mov_b32_dpp v134, v138 row_ror:8 row_mask:0xf bank_mask:0x3
    v_mov_b32_dpp v135, v139 row_ror:8 row_mask:0xf bank_mask:0x3
    v_permlane16_swap_b32 v128, v130
    v_permlane16_swap_b32 v129, v131
    v_permlane16_swap_b32 v132, v134
    v_permlane16_swap_b32 v133, v135
    s_nop 0
    v_lshlrev_b32 v48, 16, v128
    v_and_b32 v49, 0xffff0000, v128
    v_lshlrev_b32 v50, 16, v129
    v_and_b32 v51, 0xffff0000, v129
    v_lshlrev_b32 v52, 16, v130
    v_and_b32 v53, 0xffff0000, v130
    v_lshlrev_b32 v54, 16, v131
    v_and_b32 v55, 0xffff0000, v131
    v_lshlrev_b32 v56, 16, v132
    v_and_b32 v57, 0xffff0000, v132
    v_lshlrev_b32 v58, 16, v133
    v_and_b32 v59, 0xffff0000, v133
    v_lshlrev_b32 v60, 16, v134
    v_and_b32 v61, 0xffff0000, v134
    v_lshlrev_b32 v62, 16, v135
    v_and_b32 v63, 0xffff0000, v135
LP2_23:
    s_mov_b32 s36, 0
Lp2l_39:
    ds_read_b64 v[6:7], v8
    v_readfirstlane_b32 s40, v4
    v_readfirstlane_b32 s41, v5
    s_or_b64 s[46:47], s[46:47], s[40:41]
    s_and_b64 s[40:41], s[44:45], s[46:47]
    s_cbranch_scc1 Lp2go_40
    s_mov_b64 exec, 1
    buffer_atomic_umax_x2 v[4:5], off, s[20:23], s43 sc0 sc1
    s_mov_b64 exec, -1
    s_waitcnt lgkmcnt(0)
    v_readfirstlane_b32 s40, v6
    v_readfirstlane_b32 s41, v7
    s_or_b64 s[46:47], s[46:47], s[40:41]
    s_and_b64 s[40:41], s[44:45], s[46:47]
    s_cbranch_scc1 Lp2go_40
    s_waitcnt vmcnt(0)
    s_mov_b64 exec, 1
    ds_or_b64 v8, v[4:5]
    s_mov_b64 exec, -1
    s_add_u32 s101, s101, 1
    s_cmp_ge_u32 s101, 200000
    s_cselect_b32 s49, -1, s49
    s_cselect_b64 s[46:47], -1, s[46:47]
    s_branch Lp2l_39
Lp2go_40:
    s_and_b64 s[40:41], s[44:45], s[46:47]
    s_cbranch_scc0 Lp2l_39
    s_ff1_i32_b64 s42, s[40:41]
    s_bitset0_b64 s[44:45], s42
    s_lshr_b32 s42, s42, 2
    s_lshl_b32 s80, s42, 13
    s_lshl_b32 s40, s80, 5
    s_add_u32 s40, s40, s16
    s_add_u32 s41, s40, 131072
    buffer_load_dwordx4 v[64:67], v24, s[4:7], s40 offen sc1
    buffer_load_dwordx4 v[68:71], v25, s[4:7], s40 offen sc1
    buffer_load_dwordx4 v[72:75], v24, s[4:7], s41 offen sc1
    buffer_load_dwordx4 v[76:79], v25, s[4:7], s41 offen sc1
    s_and_b64 s[40:41], s[44:45], s[46:47]
    s_cbranch_scc0 Lp2ce_41
    s_ff1_i32_b64 s42, s[40:41]
    s_bitset0_b64 s[44:45], s42
    s_lshr_b32 s42, s42, 2
    s_lshl_b32 s81, s42, 13
    s_lshl_b32 s40, s81, 5
    s_add_u32 s40, s40, s16
    s_add_u32 s41, s40, 131072
    buffer_load_dwordx4 v[80:83], v24, s[4:7], s40 offen sc1
    buffer_load_dwordx4 v[84:87], v25, s[4:7], s40 offen sc1
    buffer_load_dwordx4 v[88:91], v24, s[4:7], s41 offen sc1
    buffer_load_dwordx4 v[92:95], v25, s[4:7], s41 offen sc1
    s_add_u32 s36, s36, 1
Lp2ce_41:
    s_mov_b64 exec, 1
    ds_or_b64 v8, v[4:5]
    s_mov_b64 exec, -1
    s_and_b32 s76, s28, 3
    s_lshl_b32 s76, s76, 2
    s_and_b32 s77, s29, 3
    s_add_u32 s76, s76, s77
    s_lshr_b32 s77, s28, 2
    s_lshl_b32 s77, s77, 3
    s_lshr_b32 s78, s29, 2
    s_add_u32 s77, s77, s78
    v_lshrrev_b32 v10, 5, v0
    v_lshlrev_b32 v10, 10, v10
    v_bfe_u32 v11, v0, 2, 3
    v_lshl_add_u32 v10, v11, 7, v10
    v_and_b32 v11, 3, v0
    v_lshl_add_u32 v10, v11, 3, v10
    v_bfe_u32 v11, v0, 3, 2
    v_lshl_add_u32 v26, v11, 5, v10
    v_xor_b32 v12, 1, v11
    v_lshl_add_u32 v27, v12, 5, v10
    v_xor_b32 v12, 2, v11
    v_lshl_add_u32 v28, v12, 5, v10
    v_xor_b32 v12, 3, v11
    v_lshl_add_u32 v29, v12, 5, v10
    s_cmp_eq_u32 s17, 0
    s_cbranch_scc1 Lnz_44
    v_mov_b32 v32, 0
    v_mov_b32 v33, 0
    v_mov_b32 v34, 0
    v_mov_b32 v35, 0
    v_mov_b32 v36, 0
    v_mov_b32 v37, 0
    v_mov_b32 v38, 0
    v_mov_b32 v39, 0
    v_mov_b32 v40, 0
    v_mov_b32 v41, 0
    v_mov_b32 v42, 0
    v_mov_b32 v43, 0
    v_mov_b32 v44, 0
    v_mov_b32 v45, 0
    v_mov_b32 v46, 0
    v_mov_b32 v47, 0
    v_mov_b32 v48, 0
    v_mov_b32 v49, 0
    v_mov_b32 v50, 0
    v_mov_b32 v51, 0
    v_mov_b32 v52, 0
    v_mov_b32 v53, 0
    v_mov_b32 v54, 0
    v_mov_b32 v55, 0
    v_mov_b32 v56, 0
    v_mov_b32 v57, 0
    v_mov_b32 v58, 0
    v_mov_b32 v59, 0
    v_mov_b32 v60, 0
    v_mov_b32 v61, 0
    v_mov_b32 v62, 0
    v_mov_b32 v63, 0
Lnz_44:
    v_mov_b32 v2, 163780
Llw_45:
    ds_read_b32 v3, v2
    s_waitcnt lgkmcnt(0)
    v_cmp_gt_u32 vcc, 4, v3
    s_cbranch_vccnz Llw_45
    v_readfirstlane_b32 s40, v6
    v_readfirstlane_b32 s41, v7
    s_or_b64 s[46:47], s[46:47], s[40:41]
    v_add_u32 v10, s80, v26
    v_add_u32 v11, s80, v27
    v_add_u32 v12, s80, v28
    v_add_u32 v13, s80, v29
    ds_read_b64_tr_b16 a[0:1], v10 offset:0
    ds_read_b64_tr_b16 a[2:3], v10 offset:2048
    ds_read_b64_tr_b16 a[4:5], v11 offset:0
    ds_read_b64_tr_b16 a[6:7], v11 offset:2048
    ds_read_b64_tr_b16 a[8:9], v12 offset:0
    ds_read_b64_tr_b16 a[10:11], v12 offset:2048
    ds_read_b64_tr_b16 a[12:13], v13 offset:0
    ds_read_b64_tr_b16 a[14:15], v13 offset:2048
    ds_read_b64_tr_b16 a[16:17], v10 offset:4096
    ds_read_b64_tr_b16 a[18:19], v10 offset:6144
    ds_read_b64_tr_b16 a[20:21], v11 offset:4096
    ds_read_b64_tr_b16 a[22:23], v11 offset:6144
    ds_read_b64_tr_b16 a[24:25], v12 offset:4096
    ds_read_b64_tr_b16 a[26:27], v12 offset:6144
    ds_read_b64_tr_b16 a[28:29], v13 offset:4096
    ds_read_b64_tr_b16 a[30:31], v13 offset:6144
    s_cmp_lt_u32 s36, 1
    s_cbranch_scc1 Lwn_47
    s_waitcnt vmcnt(4)
    s_branch Lp2w2_36
Lwn_47:
    s_waitcnt vmcnt(0)
    s_branch Lp2w2_36
Lp2s0_25:
    v_add_u32 v10, s81, v26
    v_add_u32 v11, s81, v27
    v_add_u32 v12, s81, v28
    v_add_u32 v13, s81, v29
    s_cmp_lg_u32 s36, 1
    s_cbranch_scc1 Lp2alt_54
    s_andn2_b64 s[40:41], s[44:45], s[46:47]
    s_cbranch_scc1 Lp2alt_54
    s_and_b64 s[40:41], s[44:45], s[46:47]
    s_cbranch_scc0 Lp2alt_54
    s_ff1_i32_b64 s42, s[40:41]
    s_bitset0_b64 s[44:45], s42
    s_lshr_b32 s42, s42, 2
    s_lshl_b32 s82, s42, 13
    s_lshl_b32 s40, s82, 5
    s_add_u32 s40, s40, s16
    s_add_u32 s41, s40, 131072
    s_waitcnt lgkmcnt(14)
    v_mfma_f32_16x16x32_bf16 v[32:35], a[0:3], v[64:67], v[32:35]
    buffer_load_dwordx4 v[96:99], v24, s[4:7], s40 offen sc1
    v_mfma_f32_16x16x32_bf16 v[48:51], a[0:3], v[68:71], v[48:51]
    ds_read_b64_tr_b16 a[0:1], v10 offset:0
    ds_read_b64_tr_b16 a[2:3], v10 offset:2048
    s_waitcnt lgkmcnt(14)
    v_mfma_f32_16x16x32_bf16 v[36:39], a[4:7], v[64:67], v[36:39]
    buffer_load_dwordx4 v[100:103], v25, s[4:7], s40 offen sc1
    v_mfma_f32_16x16x32_bf16 v[52:55], a[4:7], v[68:71], v[52:55]
    ds_read_b64_tr_b16 a[4:5], v11 offset:0
    ds_read_b64_tr_b16 a[6:7], v11 offset:2048
    s_waitcnt lgkmcnt(14)
    v_mfma_f32_16x16x32_bf16 v[40:43], a[8:11], v[64:67], v[40:43]
    buffer_load_dwordx4 v[104:107], v24, s[4:7], s41 offen sc1
    v_mfma_f32_16x16x32_bf16 v[56:59], a[8:11], v[68:71], v[56:59]
    ds_read_b64_tr_b16 a[8:9], v12 offset:0
    ds_read_b64_tr_b16 a[10:11], v12 offset:2048
    s_waitcnt lgkmcnt(14)
    v_mfma_f32_16x16x32_bf16 v[44:47], a[12:15], v[64:67], v[44:47]
    buffer_load_dwordx4 v[108:111], v25, s[4:7], s41 offen sc1
    v_mfma_f32_16x16x32_bf16 v[60:63], a[12:15], v[68:71], v[60:63]
    ds_read_b64_tr_b16 a[12:13], v13 offset:0
    ds_read_b64_tr_b16 a[14:15], v13 offset:2048
    s_waitcnt lgkmcnt(14)
    v_mfma_f32_16x16x32_bf16 v[32:35], a[16:19], v[72:75], v[32:35]
    v_mfma_f32_16x16x32_bf16 v[48:51], a[16:19], v[76:79], v[48:51]
    ds_read_b64_tr_b16 a[16:17], v10 offset:4096
    ds_read_b64_tr_b16 a[18:19], v10 offset:6144
    s_waitcnt lgkmcnt(14)
    v_mfma_f32_16x16x32_bf16 v[36:39], a[20:23], v[72:75], v[36:39]
    v_mfma_f32_16x16x32_bf16 v[52:55], a[20:23], v[76:79], v[52:55]
    ds_read_b64_tr_b16 a[20:21], v11 offset:4096
    ds_read_b64_tr_b16 a[22:23], v11 offset:6144
    s_waitcnt vmcnt(4)
    s_waitcnt lgkmcnt(14)
    v_mfma_f32_16x16x32_bf16 v[40:43], a[24:27], v[72:75], v[40:43]
    v_max3_u32 v18, v80, v81, v82
    v_max3_u32 v19, v83, v84, v85
    v_mfma_f32_16x16x32_bf16 v[56:59], a[24:27], v[76:79], v[56:59]
    v_max3_u32 v20, v86, v87, v88
    v_max3_u32 v18, v18, v89, v90
    ds_read_b64_tr_b16 a[24:25], v12 offset:4096
    ds_read_b64_tr_b16 a[26:27], v12 offset:6144
    s_waitcnt lgkmcnt(14)
    v_mfma_f32_16x16x32_bf16 v[44:47], a[28:31], v[72:75], v[44:47]
    v_max3_u32 v19, v19, v91, v92
    v_max3_u32 v20, v20, v93, v94
    v_mfma_f32_16x16x32_bf16 v[60:63], a[28:31], v[76:79], v[60:63]
    v_max3_u32 v18, v18, v19, v95
    v_max_u32 v18, v18, v20
    v_cmp_lt_u32 vcc, s49, v18
    ds_read_b64_tr_b16 a[28:29], v13 offset:4096
    ds_read_b64_tr_b16 a[30:31], v13 offset:6144
    s_cbranch_vccnz Lp2f1_32
Lp2s1_26:
    v_add_u32 v10, s82, v26
    v_add_u32 v11, s82, v27
    v_add_u32 v12, s82, v28
    v_add_u32 v13, s82, v29
    s_cmp_lg_u32 s36, 1
    s_cbranch_scc1 Lp2alt_70
    s_andn2_b64 s[40:41], s[44:45], s[46:47]
    s_cbranch_scc1 Lp2alt_70
    s_and_b64 s[40:41], s[44:45], s[46:47]
    s_cbranch_scc0 Lp2alt_70
    s_ff1_i32_b64 s42, s[40:41]
    s_bitset0_b64 s[44:45], s42
    s_lshr_b32 s42, s42, 2
    s_lshl_b32 s80, s42, 13
    s_lshl_b32 s40, s80, 5
    s_add_u32 s40, s40, s16
    s_add_u32 s41, s40, 131072
    s_waitcnt lgkmcnt(14)
    v_mfma_f32_16x16x32_bf16 v[32:35], a[0:3], v[80:83], v[32:35]
    buffer_load_dwordx4 v[64:67], v24, s[4:7], s40 offen sc1
    v_mfma_f32_16x16x32_bf16 v[48:51], a[0:3], v[84:87], v[48:51]
    ds_read_b64_tr_b16 a[0:1], v10 offset:0
    ds_read_b64_tr_b16 a[2:3], v10 offset:2048
    s_waitcnt lgkmcnt(14)
    v_mfma_f32_16x16x32_bf16 v[36:39], a[4:7], v[80:83], v[36:39]
    buffer_load_dwordx4 v[68:71], v25, s[4:7], s40 offen sc1
    v_mfma_f32_16x16x32_bf16 v[52:55], a[4:7], v[84:87], v[52:55]
    ds_read_b64_tr_b16 a[4:5], v11 offset:0
    ds_read_b64_tr_b16 a[6:7], v11 offset:2048
    s_waitcnt lgkmcnt(14)
    v_mfma_f32_16x16x32_bf16 v[40:43], a[8:11], v[80:83], v[40:43]
    buffer_load_dwordx4 v[72:75], v24, s[4:7], s41 offen sc1
    v_mfma_f32_16x16x32_bf16 v[56:59], a[8:11], v[84:87], v[56:59]
    ds_read_b64_tr_b16 a[8:9], v12 offset:0
    ds_read_b64_tr_b16 a[10:11], v12 offset:2048
    s_waitcnt lgkmcnt(14)
    v_mfma_f32_16x16x32_bf16 v[44:47], a[12:15], v[80:83], v[44:47]
    buffer_load_dwordx4 v[76:79], v25, s[4:7], s41 offen sc1
    v_mfma_f32_16x16x32_bf16 v[60:63], a[12:15], v[84:87], v[60:63]
    ds_read_b64_tr_b16 a[12:13], v13 offset:0
    ds_read_b64_tr_b16 a[14:15], v13 offset:2048
    s_waitcnt lgkmcnt(14)
    v_mfma_f32_16x16x32_bf16 v[32:35], a[16:19], v[88:91], v[32:35]
    v_mfma_f32_16x16x32_bf16 v[48:51], a[16:19], v[92:95], v[48:51]
    ds_read_b64_tr_b16 a[16:17], v10 offset:4096
    ds_read_b64_tr_b16 a[18:19], v10 offset:6144
    s_waitcnt lgkmcnt(14)
    v_mfma_f32_16x16x32_bf16 v[36:39], a[20:23], v[88:91], v[36:39]
    v_mfma_f32_16x16x32_bf16 v[52:55], a[20:23], v[92:95], v[52:55]
    ds_read_b64_tr_b16 a[20:21], v11 offset:4096
    ds_read_b64_tr_b16 a[22:23], v11 offset:6144
    s_waitcnt vmcnt(4)
    s_waitcnt lgkmcnt(14)
    v_mfma_f32_16x16x32_bf16 v[40:43], a[24:27], v[88:91], v[40:43]
    v_max3_u32 v18, v96, v97, v98
    v_max3_u32 v19, v99, v100, v101
    v_mfma_f32_16x16x32_bf16 v[56:59], a[24:27], v[92:95], v[56:59]
    v_max3_u32 v20, v102, v103, v104
    v_max3_u32 v18, v18, v105, v106
    ds_read_b64_tr_b16 a[24:25], v12 offset:4096
    ds_read_b64_tr_b16 a[26:27], v12 offset:6144
    s_waitcnt lgkmcnt(14)
    v_mfma_f32_16x16x32_bf16 v[44:47], a[28:31], v[88:91], v[44:47]
    v_max3_u32 v19, v19, v107, v108
    v_max3_u32 v20, v20, v109, v110
    v_mfma_f32_16x16x32_bf16 v[60:63], a[28:31], v[92:95], v[60:63]
    v_max3_u32 v18, v18, v19, v111
    v_max_u32 v18, v18, v20
    v_cmp_lt_u32 vcc, s49, v18
    ds_read_b64_tr_b16 a[28:29], v13 offset:4096
    ds_read_b64_tr_b16 a[30:31], v13 offset:6144
    s_cbranch_vccnz Lp2f2_33
Lp2s2_27:
    v_add_u32 v10, s80, v26
    v_add_u32 v11, s80, v27
    v_add_u32 v12, s80, v28
    v_add_u32 v13, s80, v29
    s_cmp_lg_u32 s36, 1
    s_cbranch_scc1 Lp2alt_86
    s_andn2_b64 s[40:41], s[44:45], s[46:47]
    s_cbranch_scc1 Lp2alt_86
    s_and_b64 s[40:41], s[44:45], s[46:47]
    s_cbranch_scc0 Lp2alt_86
    s_ff1_i32_b64 s42, s[40:41]
    s_bitset0_b64 s[44:45], s42
    s_lshr_b32 s42, s42, 2
    s_lshl_b32 s81, s42, 13
    s_lshl_b32 s40, s81, 5
    s_add_u32 s40, s40, s16
    s_add_u32 s41, s40, 131072
    s_waitcnt lgkmcnt(14)
    v_mfma_f32_16x16x32_bf16 v[32:35], a[0:3], v[96:99], v[32:35]
    buffer_load_dwordx4 v[80:83], v24, s[4:7], s40 offen sc1
    v_mfma_f32_16x16x32_bf16 v[48:51], a[0:3], v[100:103], v[48:51]
    ds_read_b64_tr_b16 a[0:1], v10 offset:0
    ds_read_b64_tr_b16 a[2:3], v10 offset:2048
    s_waitcnt lgkmcnt(14)
    v_mfma_f32_16x16x32_bf16 v[36:39], a[4:7], v[96:99], v[36:39]
    buffer_load_dwordx4 v[84:87], v25, s[4:7], s40 offen sc1
    v_mfma_f32_16x16x32_bf16 v[52:55], a[4:7], v[100:103], v[52:55]
    ds_read_b64_tr_b16 a[4:5], v11 offset:0
    ds_read_b64_tr_b16 a[6:7], v11 offset:2048
    s_waitcnt lgkmcnt(14)
    v_mfma_f32_16x16x32_bf16 v[40:43], a[8:11], v[96:99], v[40:43]
    buffer_load_dwordx4 v[88:91], v24, s[4:7], s41 offen sc1
    v_mfma_f32_16x16x32_bf16 v[56:59], a[8:11], v[100:103], v[56:59]
    ds_read_b64_tr_b16 a[8:9], v12 offset:0
    ds_read_b64_tr_b16 a[10:11], v12 offset:2048
    s_waitcnt lgkmcnt(14)
    v_mfma_f32_16x16x32_bf16 v[44:47], a[12:15], v[96:99], v[44:47]
    buffer_load_dwordx4 v[92:95], v25, s[4:7], s41 offen sc1
    v_mfma_f32_16x16x32_bf16 v[60:63], a[12:15], v[100:103], v[60:63]
    ds_read_b64_tr_b16 a[12:13], v13 offset:0
    ds_read_b64_tr_b16 a[14:15], v13 offset:2048
    s_waitcnt lgkmcnt(14)
    v_mfma_f32_16x16x32_bf16 v[32:35], a[16:19], v[104:107], v[32:35]
    v_mfma_f32_16x16x32_bf16 v[48:51], a[16:19], v[108:111], v[48:51]
    ds_read_b64_tr_b16 a[16:17], v10 offset:4096
    ds_read_b64_tr_b16 a[18:19], v10 offset:6144
    s_waitcnt lgkmcnt(14)
    v_mfma_f32_16x16x32_bf16 v[36:39], a[20:23], v[104:107], v[36:39]
    v_mfma_f32_16x16x32_bf16 v[52:55], a[20:23], v[108:111], v[52:55]
    ds_read_b64_tr_b16 a[20:21], v11 offset:4096
    ds_read_b64_tr_b16 a[22:23], v11 offset:6144
    s_waitcnt vmcnt(4)
    s_waitcnt lgkmcnt(14)
    v_mfma_f32_16x16x32_bf16 v[40:43], a[24:27], v[104:107], v[40:43]
    v_max3_u32 v18, v64, v65, v66
    v_max3_u32 v19, v67, v68, v69
    v_mfma_f32_16x16x32_bf16 v[56:59], a[24:27], v[108:111], v[56:59]
    v_max3_u32 v20, v70, v71, v72
    v_max3_u32 v18, v18, v73, v74
    ds_read_b64_tr_b16 a[24:25], v12 offset:4096
    ds_read_b64_tr_b16 a[26:27], v12 offset:6144
    s_waitcnt lgkmcnt(14)
    v_mfma_f32_16x16x32_bf16 v[44:47], a[28:31], v[104:107], v[44:47]
    v_max3_u32 v19, v19, v75, v76
    v_max3_u32 v20, v20, v77, v78
    v_mfma_f32_16x16x32_bf16 v[60:63], a[28:31], v[108:111], v[60:63]
    v_max3_u32 v18, v18, v19, v79
    v_max_u32 v18, v18, v20
    v_cmp_lt_u32 vcc, s49, v18
    ds_read_b64_tr_b16 a[28:29], v13 offset:4096
    ds_read_b64_tr_b16 a[30:31], v13 offset:6144
    s_cbranch_vccnz Lp2f0_31
    s_branch Lp2s0_25
Lp2done_34:
    s_waitcnt lgkmcnt(0)
    s_barrier
    s_lshl_b32 s40, s3, 12
    s_xor_b32 s41, s40, 16384
    s_add_u32 s40, s40, 122880
    s_add_u32 s41, s41, 122880
    v_add_u32 v10, s40, v1
    v_add_u32 v11, s41, v1
    ds_write_b128 v10, v[48:51] offset:0
    ds_write_b128 v10, v[52:55] offset:1024
    ds_write_b128 v10, v[56:59] offset:2048
    ds_write_b128 v10, v[60:63] offset:3072
    s_add_u32 s12, s70, 8388608
    s_addc_u32 s13, s71, 0
    s_and_b32 s13, s13, 0xffff
    s_mov_b32 s14, 4194304
    s_mov_b32 s15, 0x20000
    s_lshl_b32 s49, s77, 18
    s_add_u32 s49, s49, s16
    s_add_u32 s41, s49, 131072
    s_lshl_b32 s48, s77, 14
    s_lshl_b32 s40, s76, 10
    s_add_u32 s48, s48, s40
    s_lshl_b32 s40, s33, 8
    s_add_u32 s48, s48, s40
    s_lshl_b32 s40, s17, 7
    s_add_u32 s48, s48, s40
    s_add_u32 s48, s48, 786432
    v_lshlrev_b32 v3, 3, v0
    s_waitcnt lgkmcnt(0)
    s_barrier
    ds_read_b128 v[48:51], v11 offset:0
    ds_read_b128 v[52:55], v11 offset:1024
    ds_read_b128 v[56:59], v11 offset:2048
    ds_read_b128 v[60:63], v11 offset:3072
    s_waitcnt lgkmcnt(3)
    v_add_f32 v32, v32, v48
    v_add_f32 v33, v33, v49
    v_add_f32 v34, v34, v50
    v_add_f32 v35, v35, v51
    v_cvt_pk_bf16_f32 v64, v32, v33
    v_cvt_pk_bf16_f32 v65, v34, v35
    s_waitcnt lgkmcnt(2)
    v_add_f32 v36, v36, v52
    v_add_f32 v37, v37, v53
    v_add_f32 v38, v38, v54
    v_add_f32 v39, v39, v55
    v_cvt_pk_bf16_f32 v66, v36, v37
    v_cvt_pk_bf16_f32 v67, v38, v39
    buffer_store_dwordx4 v[64:67], v24, s[12:15], s49 offen sc1
    s_waitcnt lgkmcnt(1)
    v_add_f32 v40, v40, v56
    v_add_f32 v41, v41, v57
    v_add_f32 v42, v42, v58
    v_add_f32 v43, v43, v59
    v_cvt_pk_bf16_f32 v68, v40, v41
    v_cvt_pk_bf16_f32 v69, v42, v43
    s_waitcnt lgkmcnt(0)
    v_add_f32 v44, v44, v60
    v_add_f32 v45, v45, v61
    v_add_f32 v46, v46, v62
    v_add_f32 v47, v47, v63
    v_cvt_pk_bf16_f32 v70, v44, v45
    v_cvt_pk_bf16_f32 v71, v46, v47
    buffer_store_dwordx4 v[68:71], v24, s[12:15], s41 offen sc1
    v_lshlrev_b32 v32, 16, v64
    v_and_b32 v33, 0xffff0000, v64
    v_lshlrev_b32 v34, 16, v65
    v_and_b32 v35, 0xffff0000, v65
    v_lshlrev_b32 v36, 16, v66
    v_and_b32 v37, 0xffff0000, v66
    v_lshlrev_b32 v38, 16, v67
    v_and_b32 v39, 0xffff0000, v67
    v_lshlrev_b32 v40, 16, v68
    v_and_b32 v41, 0xffff0000, v68
    v_lshlrev_b32 v42, 16, v69
    v_and_b32 v43, 0xffff0000, v69
    v_lshlrev_b32 v44, 16, v70
    v_and_b32 v45, 0xffff0000, v70
    v_lshlrev_b32 v46, 16, v71
    v_and_b32 v47, 0xffff0000, v71
    v_add_f32 v80, v32, v33
    v_add_f32 v82, v34, v35
    v_add_f32 v80, v80, v36
    v_add_f32 v82, v82, v37
    v_add_f32 v80, v80, v38
    v_add_f32 v82, v82, v39
    v_add_f32 v80, v80, v40
    v_add_f32 v82, v82, v41
    v_add_f32 v80, v80, v42
    v_add_f32 v82, v82, v43
    v_add_f32 v80, v80, v44
    v_add_f32 v82, v82, v45
    v_add_f32 v80, v80, v46
    v_add_f32 v82, v82, v47
    v_add_f32 v80, v80, v82
    v_mov_b32 v82, v80
    s_nop 1
    v_permlane16_swap_b32 v80, v82
    s_nop 1
    v_add_f32 v80, v80, v82
    v_mov_b32 v82, v80
    s_nop 1
    v_permlane32_swap_b32 v80, v82
    s_nop 1
    v_add_f32 v80, v80, v82
    v_mul_f32 v83, 1015021568, v80
    v_sub_f32 v32, v32, v83
    v_sub_f32 v33, v33, v83
    v_sub_f32 v34, v34, v83
    v_sub_f32 v35, v35, v83
    v_sub_f32 v36, v36, v83
    v_sub_f32 v37, v37, v83
    v_sub_f32 v38, v38, v83
    v_sub_f32 v39, v39, v83
    v_sub_f32 v40, v40, v83
    v_sub_f32 v41, v41, v83
    v_sub_f32 v42, v42, v83
    v_sub_f32 v43, v43, v83
    v_sub_f32 v44, v44, v83
    v_sub_f32 v45, v45, v83
    v_sub_f32 v46, v46, v83
    v_sub_f32 v47, v47, v83
    v_mul_f32 v81, v32, v32
    v_mul_f32 v82, v33, v33
    v_fmac_f32 v81, v34, v34
    v_fmac_f32 v82, v35, v35
    v_fmac_f32 v81, v36, v36
    v_fmac_f32 v82, v37, v37
    v_fmac_f32 v81, v38, v38
    v_fmac_f32 v82, v39, v39
    v_fmac_f32 v81, v40, v40
    v_fmac_f32 v82, v41, v41
    v_fmac_f32 v81, v42, v42
    v_fmac_f32 v82, v43, v43
    v_fmac_f32 v81, v44, v44
    v_fmac_f32 v82, v45, v45
    v_fmac_f32 v81, v46, v46
    v_fmac_f32 v82, v47, v47
    v_add_f32 v81, v81, v82
    v_mov_b32 v82, v81
    s_nop 1
    v_permlane16_swap_b32 v81, v82
    s_nop 1
    v_add_f32 v81, v81, v82
    v_mov_b32 v82, v81
    s_nop 1
    v_permlane32_swap_b32 v81, v82
    s_nop 1
    v_add_f32 v81, v81, v82
    v_min_u32 v80, -2, v80
    v_min_u32 v81, -2, v81
    s_mov_b64 exec, 0xffff
    buffer_store_dwordx2 v[80:81], v3, s[20:23], s48 offen sc1
    s_mov_b64 exec, -1
    s_lshr_b32 s43, s76, 1
    s_lshl_b32 s43, s43, 12
    s_add_u32 s43, s43, 1343488
    s_cmp_eq_u32 s3, 5
    s_cselect_b64 exec, 3, 0
    v_lshlrev_b32 v14, 2, v0
    v_add_u32 v14, 163792, v14
    ds_write_b32 v14, v15
    s_mov_b64 exec, -1
    s_waitcnt lgkmcnt(0)
    s_waitcnt vmcnt(1)
    s_barrier
    s_cmp_lt_u32 s3, 4
    s_cbranch_scc1 LXB_24
    s_cmp_lg_u32 s33, 0
    s_cbranch_scc1 Lof_95
    v_mov_b32 v2, 1
    v_mul_u32_u24 v3, 128, v0
    s_mov_b32 exec_lo, 0xffffffff
    s_mov_b32 exec_hi, 0
    buffer_atomic_add v2, v3, s[20:23], s43 offen sc1
    s_mov_b64 exec, -1
Lof_95:
    s_and_b32 s80, s28, 1
    s_lshl_b32 s80, s80, 2
    s_and_b32 s81, s29, 3
    s_add_u32 s80, s80, s81
    s_lshr_b32 s81, s28, 1
    s_lshl_b32 s81, s81, 3
    s_lshr_b32 s40, s29, 2
    s_add_u32 s81, s81, s40
    s_and_b32 s83, s81, 1
    s_lshl_b32 s82, s80, 14
    s_lshl_b32 s30, s33, 12
    s_add_u32 s82, s82, s30
    v_add_u32 v6, s30, v1
    v_lshrrev_b32 v7, 2, v0
    v_mul_u32_u24 v7, 224, v7
    v_and_b32 v10, 3, v0
    v_lshl_add_u32 v7, v10, 3, v7
    s_lshl_b32 s42, s80, 12
    s_and_b32 s41, s81, 31
    s_lshl_b32 s41, s41, 7
    s_add_u32 s42, s42, s41
    s_add_u32 s42, s42, 1343488
    s_bitcmp1_b32 s33, 0
    s_cselect_b32 s40, s62, s60
    s_cselect_b32 s41, s63, s61
    s_mov_b32 s8, s40
    s_and_b32 s9, s41, 0xffff
    s_mov_b32 s10, 7340032
    s_mov_b32 s11, 0x20000
    s_bfm_b32 s40, s81, 0
    s_and_b32 s40, s40, 0x98891199
    s_bcnt1_i32_b32 s40, s40
    s_lshl_b32 s41, s35, 2
    s_add_u32 s41, s41, s80
    s_mul_i32 s89, s80, 12
    s_add_u32 s89, s89, s40
    s_mul_i32 s89, s89, 4864
    s_add_u32 s89, s89, 2064384
    s_bitcmp1_b32 0x98891199, s81
    s_cselect_b32 s40, 38, 0
    s_cmp_ge_u32 s33, 2
    s_cselect_b32 s40, 0, s40
    s_cmp_ge_u32 s80, 8
    s_cselect_b32 s40, 0, s40
    v_lshlrev_b32 v29, 7, v0
    v_cmp_gt_u32 vcc, s40, v0
    v_mov_b32 v25, 2147418112
    s_nop 0
    v_cndmask_b32 v29, v25, v29, vcc
    s_bitcmp1_b32 s3, 0
    s_cselect_b32 s41, 3670016, 0
    s_lshl_b32 s40, s2, 9
    s_lshr_b32 s88, s3, 1
    s_lshl_b32 s88, s88, 7
    s_add_u32 s40, s40, s88
    s_add_u32 s40, s40, 60
    s_add_u32 s41, s41, s40
    s_add_u32 s86, s64, s41
    s_addc_u32 s87, s65, 0
    s_mov_b32 s88, 0
    s_add_u32 s4, s70, 8388608
    s_addc_u32 s5, s71, 0
    s_and_b32 s5, s5, 0xffff
    s_mov_b32 s6, 4194304
    s_mov_b32 s7, 0x20000
    s_mov_b32 s16, s82
    v_mov_b32 v8, 0
    v_mov_b32 v9, 0
    v_mov_b32 v10, 0
    v_mov_b32 v11, 0
    v_mov_b32 v12, 0
    v_mov_b32 v13, 0
    v_mov_b32 v14, 0
    v_mov_b32 v15, 0
    v_mov_b32 v16, 0x3f803f80
    v_mov_b32 v17, 0x3f803f80
    v_mov_b32 v18, 0x3f803f80
    v_mov_b32 v19, 0x3f803f80
    v_mov_b32 v28, 0
    v_mov_b32 v30, 163792
    ds_read_b32 v30, v30
    s_waitcnt lgkmcnt(0)
    v_readfirstlane_b32 s41, v30
    s_and_b32 s40, s80, 3
    s_lshl_b32 s85, 4368, s40
    s_lshl_b32 s44, s81, 2
    s_add_u32 s44, s44, s40
    s_lshl_b32 s44, s44, 11
    s_add_u32 s44, s44, 106496
    s_cmp_lg_u32 s41, 0
    s_cselect_b32 s85, 0, s85
    s_cselect_b32 s45, 0, 16
    s_or_b32 s85, s85, 8
    s_mov_b32 s40, 155648
    s_cmp_eq_u32 s33, 1
    s_cselect_b32 s40, 155712, s40
    s_cmp_eq_u32 s33, 2
    s_cselect_b32 s40, 155776, s40
    s_cmp_eq_u32 s33, 3
    s_cselect_b32 s40, 155840, s40
    v_and_b32 v30, 48, v0
    v_add_u32 v30, s40, v30
    s_mov_b32 s40, 156096
    s_cmp_eq_u32 s33, 1
    s_cselect_b32 s40, 156160, s40
    s_cmp_eq_u32 s33, 2
    s_cselect_b32 s40, 156224, s40
    s_cmp_eq_u32 s33, 3
    s_cselect_b32 s40, 156288, s40
    v_and_b32 v31, 48, v0
    v_add_u32 v31, s40, v31
    s_lshl_b32 s43, s80, 12
    s_lshr_b32 s41, s81, 4
    s_lshl_b32 s41, s41, 7
    s_add_u32 s43, s43, s41
    s_add_u32 s43, s43, 1376256
    s_cmp_lg_u32 s33, 1
    s_cbranch_scc1 Low_96
    v_mov_b32 v2, 0
    s_mov_b64 exec, 1
    s_mov_b32 s101, 0
Lpoll_99:
    s_add_u32 s101, s101, 1
    s_cmp_ge_u32 s101, 200000
    s_cbranch_scc1 Lpoll_99x
    buffer_atomic_umax v2, off, s[20:23], s42 sc0 sc1
    s_waitcnt vmcnt(0)
    v_cmp_gt_u32 vcc, 32, v2
    s_cbranch_vccnz Lpoll_99
Lpoll_99x:
    s_mov_b64 exec, -1
Lep_98:
Low_96:
    s_cmp_lg_u32 s33, 0
    s_cbranch_scc1 Low_100
    s_waitcnt vmcnt(1)
    s_branch Lox_101
Low_100:
    s_waitcnt vmcnt(0)
Lox_101:
    s_barrier
    s_add_u32 s30, s30, 86016
    s_mov_b32 s18, s30
    s_mov_b32 m0, s18
    s_nop 0
    buffer_load_dwordx4 v1, s[4:7], s16 offen offset:0 sc1 lds
    buffer_load_dwordx4 v1, s[4:7], s16 offen offset:1024 sc1 lds
    buffer_load_dwordx4 v1, s[4:7], s16 offen offset:2048 sc1 lds
    buffer_load_dwordx4 v1, s[4:7], s16 offen offset:3072 sc1 lds
    s_add_u32 s16, s16, 131072
    s_add_u32 s18, s18, 16384
    s_cmp_ge_u32 s18, 151552
    s_cselect_b32 s18, s30, s18
    s_mov_b32 m0, s18
    s_nop 0
    buffer_load_dwordx4 v1, s[4:7], s16 offen offset:0 sc1 lds
    buffer_load_dwordx4 v1, s[4:7], s16 offen offset:1024 sc1 lds
    buffer_load_dwordx4 v1, s[4:7], s16 offen offset:2048 sc1 lds
    buffer_load_dwordx4 v1, s[4:7], s16 offen offset:3072 sc1 lds
    s_add_u32 s16, s16, 131072
    s_add_u32 s18, s18, 16384
    s_cmp_ge_u32 s18, 151552
    s_cselect_b32 s18, s30, s18
    s_mov_b32 m0, s18
    s_nop 0
    buffer_load_dwordx4 v1, s[4:7], s16 offen offset:0 sc1 lds
    buffer_load_dwordx4 v1, s[4:7], s16 offen offset:1024 sc1 lds
    buffer_load_dwordx4 v1, s[4:7], s16 offen offset:2048 sc1 lds
    buffer_load_dwordx4 v1, s[4:7], s16 offen offset:3072 sc1 lds
    s_add_u32 s16, s16, 131072
    s_add_u32 s18, s18, 16384
    s_cmp_ge_u32 s18, 151552
    s_cselect_b32 s18, s30, s18
    s_mov_b32 m0, s18
    s_nop 0
    buffer_load_dwordx4 v1, s[4:7], s16 offen offset:0 sc1 lds
    buffer_load_dwordx4 v1, s[4:7], s16 offen offset:1024 sc1 lds
    buffer_load_dwordx4 v1, s[4:7], s16 offen offset:2048 sc1 lds
    buffer_load_dwordx4 v1, s[4:7], s16 offen offset:3072 sc1 lds
    s_add_u32 s16, s16, 131072
    s_add_u32 s18, s18, 16384
    s_cmp_ge_u32 s18, 151552
    s_cselect_b32 s18, s30, s18
    v_add_u32 v6, 86016, v6
    v_add_u32 v7, 57344, v7
    s_mov_b32 s36, 2
    s_mov_b32 s37, 4294934528
    s_mov_b32 s46, 28672
    s_mov_b32 s47, 4294909952
    s_mov_b32 s38, 16
    s_waitcnt vmcnt(8) lgkmcnt(0)
    s_barrier
    s_add_u32 s36, s36, 1
    s_cmp_ge_u32 s36, 3
    s_cselect_b32 s19, s47, s46
    s_cselect_b32 s36, 0, s36
    s_sub_u32 s37, 0, s37
    s_sub_u32 s38, s38, 1
    ds_read_b128 a[0:3], v6 offset:0
    ds_read_b128 a[48:51], v6 offset:16384
    ds_read_b64_tr_b16 a[16:17], v7 offset:0
    ds_read_b64_tr_b16 a[18:19], v7 offset:3584
    ds_read_b64_tr_b16 a[64:65], v7 offset:14336
    ds_read_b64_tr_b16 a[66:67], v7 offset:17920
    ds_read_b64_tr_b16 a[32:33], v7 offset:7168
    ds_read_b64_tr_b16 a[34:35], v7 offset:10752
    ds_read_b64_tr_b16 a[80:81], v7 offset:21504
    ds_read_b64_tr_b16 a[82:83], v7 offset:25088
    ds_read_b128 a[4:7], v6 offset:1024
    ds_read_b128 a[52:55], v6 offset:17408
    ds_read_b128 a[8:11], v6 offset:2048
    ds_read_b128 a[56:59], v6 offset:18432
    s_waitcnt lgkmcnt(10)
    v_mfma_f32_16x16x32_bf16 v[32:35], a[16:19], a[0:3], 0
    ds_read_b128 a[12:15], v6 offset:3072
    ds_read_b128 a[60:63], v6 offset:19456
    ds_read_b64_tr_b16 a[20:21], v7 offset:32
    s_waitcnt lgkmcnt(11)
    v_mfma_f32_16x16x32_bf16 v[32:35], a[64:67], a[48:51], v[32:35]
    ds_read_b64_tr_b16 a[22:23], v7 offset:3616
    ds_read_b64_tr_b16 a[68:69], v7 offset:14368
    s_waitcnt lgkmcnt(11)
    v_mfma_f32_16x16x32_bf16 v[96:99], a[32:35], a[0:3], 0
    ds_read_b64_tr_b16 a[70:71], v7 offset:17952
    ds_read_b64_tr_b16 a[36:37], v7 offset:7200
    s_waitcnt lgkmcnt(11)
    v_mfma_f32_16x16x32_bf16 v[96:99], a[80:83], a[48:51], v[96:99]
    ds_read_b64_tr_b16 a[38:39], v7 offset:10784
    ds_read_b64_tr_b16 a[84:85], v7 offset:21536
    s_waitcnt lgkmcnt(12)
    v_mfma_f32_16x16x32_bf16 v[100:103], a[32:35], a[4:7], 0
    ds_read_b64_tr_b16 a[86:87], v7 offset:25120
    ds_read_b64_tr_b16 a[24:25], v7 offset:64
    s_waitcnt lgkmcnt(13)
    v_mfma_f32_16x16x32_bf16 v[100:103], a[80:83], a[52:55], v[100:103]
    ds_read_b64_tr_b16 a[26:27], v7 offset:3648
    ds_read_b64_tr_b16 a[72:73], v7 offset:14400
    v_mfma_f32_16x16x32_bf16 v[36:39], a[16:19], a[4:7], 0
    ds_read_b64_tr_b16 a[74:75], v7 offset:17984
    ds_read_b64_tr_b16 a[40:41], v7 offset:7232
    ds_read_b64_tr_b16 a[42:43], v7 offset:10816
    v_mfma_f32_16x16x32_bf16 v[36:39], a[64:67], a[52:55], v[36:39]
    ds_read_b64_tr_b16 a[88:89], v7 offset:21568
    ds_read_b64_tr_b16 a[90:91], v7 offset:25152
    s_waitcnt lgkmcnt(14)
    v_mfma_f32_16x16x32_bf16 v[40:43], a[16:19], a[8:11], 0
    ds_read_b64_tr_b16 a[28:29], v7 offset:96
    ds_read_b64_tr_b16 a[30:31], v7 offset:3680
    v_mfma_f32_16x16x32_bf16 v[40:43], a[64:67], a[56:59], v[40:43]
    ds_read_b64_tr_b16 a[76:77], v7 offset:14432
    ds_read_b64_tr_b16 a[78:79], v7 offset:18016
    v_mfma_f32_16x16x32_bf16 v[104:107], a[32:35], a[8:11], 0
    ds_read_b64_tr_b16 a[44:45], v7 offset:7264
    ds_read_b64_tr_b16 a[46:47], v7 offset:10848
    v_mfma_f32_16x16x32_bf16 v[104:107], a[80:83], a[56:59], v[104:107]
    ds_read_b64_tr_b16 a[92:93], v7 offset:21600
    ds_read_b64_tr_b16 a[94:95], v7 offset:25184
    v_mfma_f32_16x16x32_bf16 v[108:111], a[32:35], a[12:15], 0
    v_mfma_f32_16x16x32_bf16 v[108:111], a[80:83], a[60:63], v[108:111]
    v_add_u32 v6, s37, v6
    v_add_u32 v7, s19, v7
    v_mfma_f32_16x16x32_bf16 v[44:47], a[16:19], a[12:15], 0
    v_mfma_f32_16x16x32_bf16 v[44:47], a[64:67], a[60:63], v[44:47]
    s_waitcnt vmcnt(0) lgkmcnt(0)
    s_barrier
    s_mov_b32 m0, s18
    s_nop 0
    buffer_load_dwordx4 v1, s[4:7], s16 offen offset:0 sc1 lds
    buffer_load_dwordx4 v1, s[4:7], s16 offen offset:1024 sc1 lds
    buffer_load_dwordx4 v1, s[4:7], s16 offen offset:2048 sc1 lds
    buffer_load_dwordx4 v1, s[4:7], s16 offen offset:3072 sc1 lds
    s_add_u32 s16, s16, 131072
    s_add_u32 s18, s18, 16384
    s_cmp_ge_u32 s18, 151552
    s_cselect_b32 s18, s30, s18
    s_mov_b32 m0, s18
    s_nop 0
    buffer_load_dwordx4 v1, s[4:7], s16 offen offset:0 sc1 lds
    buffer_load_dwordx4 v1, s[4:7], s16 offen offset:1024 sc1 lds
    buffer_load_dwordx4 v1, s[4:7], s16 offen offset:2048 sc1 lds
    buffer_load_dwordx4 v1, s[4:7], s16 offen offset:3072 sc1 lds
    s_add_u32 s16, s16, 131072
    s_add_u32 s18, s18, 16384
    s_cmp_ge_u32 s18, 151552
    s_cselect_b32 s18, s30, s18
    buffer_load_dword v24, v29, s[8:11], s89 offen
    s_add_u32 s89, s89, 458752
    s_load_dwordx2 s[90:91], s[86:87], s88
    s_add_u32 s88, s88, 131072
    s_min_u32 s88, s88, 3538944
    s_load_dwordx2 s[90:91], s[86:87], s88
    s_add_u32 s88, s88, 131072
    s_min_u32 s88, s88, 3538944
    s_bitcmp1_b32 s85, s38
    s_cbranch_scc0 Lxe_106
    s_setprio 2
    s_bitcmp1_b32 s33, 1
    s_cbranch_scc1 Lxh_104
    s_bitcmp1_b32 s33, 0
    s_cbranch_scc1 Lx1_103
    v_mfma_f32_16x16x32_bf16 v[8:11], a[16:19], v[16:19], v[8:11]
    v_mfma_f32_16x16x32_bf16 v[8:11], a[64:67], v[16:19], v[8:11]
    v_mfma_f32_16x16x32_bf16 v[12:15], a[32:35], v[16:19], v[12:15]
    v_mfma_f32_16x16x32_bf16 v[12:15], a[80:83], v[16:19], v[12:15]
    s_branch Lxe_106
Lx1_103:
    v_mfma_f32_16x16x32_bf16 v[8:11], a[20:23], v[16:19], v[8:11]
    v_mfma_f32_16x16x32_bf16 v[8:11], a[68:71], v[16:19], v[8:11]
    v_mfma_f32_16x16x32_bf16 v[12:15], a[36:39], v[16:19], v[12:15]
    v_mfma_f32_16x16x32_bf16 v[12:15], a[84:87], v[16:19], v[12:15]
    s_branch Lxe_106
Lxh_104:
    s_bitcmp1_b32 s33, 0
    s_cbranch_scc1 Lx3_105
    v_mfma_f32_16x16x32_bf16 v[8:11], a[24:27], v[16:19], v[8:11]
    v_mfma_f32_16x16x32_bf16 v[8:11], a[72:75], v[16:19], v[8:11]
    v_mfma_f32_16x16x32_bf16 v[12:15], a[40:43], v[16:19], v[12:15]
    v_mfma_f32_16x16x32_bf16 v[12:15], a[88:91], v[16:19], v[12:15]
    s_branch Lxe_106
Lx3_105:
    v_mfma_f32_16x16x32_bf16 v[8:11], a[28:31], v[16:19], v[8:11]
    v_mfma_f32_16x16x32_bf16 v[8:11], a[76:79], v[16:19], v[8:11]
    v_mfma_f32_16x16x32_bf16 v[12:15], a[44:47], v[16:19], v[12:15]
    v_mfma_f32_16x16x32_bf16 v[12:15], a[92:95], v[16:19], v[12:15]
Lxe_106:
    s_setprio 0
    s_add_u32 s36, s36, 1
    s_cmp_ge_u32 s36, 3
    s_cselect_b32 s19, s47, s46
    s_cselect_b32 s36, 0, s36
    s_sub_u32 s37, 0, s37
    s_sub_u32 s38, s38, 1
    ds_read_b64_tr_b16 a[16:17], v7 offset:0
    ds_read_b64_tr_b16 a[18:19], v7 offset:3584
    ds_read_b64_tr_b16 a[64:65], v7 offset:14336
    ds_read_b64_tr_b16 a[66:67], v7 offset:17920
    ds_read_b64_tr_b16 a[32:33], v7 offset:7168
    ds_read_b64_tr_b16 a[34:35], v7 offset:10752
    ds_read_b64_tr_b16 a[80:81], v7 offset:21504
    ds_read_b64_tr_b16 a[82:83], v7 offset:25088
    v_mfma_f32_16x16x32_bf16 v[60:63], a[20:23], a[12:15], 0
    v_mfma_f32_16x16x32_bf16 v[60:63], a[68:71], a[60:63], v[60:63]
    v_mfma_f32_16x16x32_bf16 v[56:59], a[20:23], a[8:11], 0
    v_mfma_f32_16x16x32_bf16 v[56:59], a[68:71], a[56:59], v[56:59]
    v_mfma_f32_16x16x32_bf16 v[52:55], a[20:23], a[4:7], 0
    v_mfma_f32_16x16x32_bf16 v[52:55], a[68:71], a[52:55], v[52:55]
    v_mfma_f32_16x16x32_bf16 v[48:51], a[20:23], a[0:3], 0
    v_mfma_f32_16x16x32_bf16 v[48:51], a[68:71], a[48:51], v[48:51]
    ds_read_b64_tr_b16 a[20:21], v7 offset:32
    v_mfma_f32_16x16x32_bf16 v[112:115], a[36:39], a[0:3], 0
    ds_read_b64_tr_b16 a[22:23], v7 offset:3616
    v_mfma_f32_16x16x32_bf16 v[112:115], a[84:87], a[48:51], v[112:115]
    ds_read_b64_tr_b16 a[68:69], v7 offset:14368
    v_mfma_f32_16x16x32_bf16 v[116:119], a[36:39], a[4:7], 0
    ds_read_b64_tr_b16 a[70:71], v7 offset:17952
    v_mfma_f32_16x16x32_bf16 v[116:119], a[84:87], a[52:55], v[116:119]
    v_mfma_f32_16x16x32_bf16 v[120:123], a[36:39], a[8:11], 0
    v_mfma_f32_16x16x32_bf16 v[120:123], a[84:87], a[56:59], v[120:123]
    v_mfma_f32_16x16x32_bf16 v[124:127], a[36:39], a[12:15], 0
    v_mfma_f32_16x16x32_bf16 v[124:127], a[84:87], a[60:63], v[124:127]
    ds_read_b64_tr_b16 a[36:37], v7 offset:7200
    v_mfma_f32_16x16x32_bf16 v[76:79], a[24:27], a[12:15], 0
    ds_read_b64_tr_b16 a[38:39], v7 offset:10784
    v_mfma_f32_16x16x32_bf16 v[76:79], a[72:75], a[60:63], v[76:79]
    ds_read_b64_tr_b16 a[84:85], v7 offset:21536
    v_mfma_f32_16x16x32_bf16 v[72:75], a[24:27], a[8:11], 0
    ds_read_b64_tr_b16 a[86:87], v7 offset:25120
    v_mfma_f32_16x16x32_bf16 v[72:75], a[72:75], a[56:59], v[72:75]
    v_mfma_f32_16x16x32_bf16 v[68:71], a[24:27], a[4:7], 0
    v_mfma_f32_16x16x32_bf16 v[68:71], a[72:75], a[52:55], v[68:71]
    v_mfma_f32_16x16x32_bf16 v[64:67], a[24:27], a[0:3], 0
    v_mfma_f32_16x16x32_bf16 v[64:67], a[72:75], a[48:51], v[64:67]
    ds_read_b64_tr_b16 a[24:25], v7 offset:64
    v_mfma_f32_16x16x32_bf16 v[128:131], a[40:43], a[0:3], 0
    ds_read_b64_tr_b16 a[26:27], v7 offset:3648
    v_mfma_f32_16x16x32_bf16 v[128:131], a[88:91], a[48:51], v[128:131]
    ds_read_b64_tr_b16 a[72:73], v7 offset:14400
    v_mfma_f32_16x16x32_bf16 v[132:135], a[40:43], a[4:7], 0
    ds_read_b64_tr_b16 a[74:75], v7 offset:17984
    v_mfma_f32_16x16x32_bf16 v[132:135], a[88:91], a[52:55], v[132:135]
    v_mfma_f32_16x16x32_bf16 v[136:139], a[40:43], a[8:11], 0
    v_mfma_f32_16x16x32_bf16 v[136:139], a[88:91], a[56:59], v[136:139]
    v_mfma_f32_16x16x32_bf16 v[140:143], a[40:43], a[12:15], 0
    v_mfma_f32_16x16x32_bf16 v[140:143], a[88:91], a[60:63], v[140:143]
    ds_read_b64_tr_b16 a[40:41], v7 offset:7232
    v_mfma_f32_16x16x32_bf16 v[80:83], a[28:31], a[0:3], 0
    ds_read_b64_tr_b16 a[42:43], v7 offset:10816
    v_mfma_f32_16x16x32_bf16 v[80:83], a[76:79], a[48:51], v[80:83]
    ds_read_b64_tr_b16 a[88:89], v7 offset:21568
    v_mfma_f32_16x16x32_bf16 v[144:147], a[44:47], a[0:3], 0
    ds_read_b64_tr_b16 a[90:91], v7 offset:25152
    v_mfma_f32_16x16x32_bf16 v[144:147], a[92:95], a[48:51], v[144:147]
    ds_read_b128 a[0:3], v6 offset:0
    ds_read_b128 a[48:51], v6 offset:16384
    v_mfma_f32_16x16x32_bf16 v[148:151], a[44:47], a[4:7], 0
    v_mfma_f32_16x16x32_bf16 v[148:151], a[92:95], a[52:55], v[148:151]
    v_mfma_f32_16x16x32_bf16 v[84:87], a[28:31], a[4:7], 0
    v_mfma_f32_16x16x32_bf16 v[84:87], a[76:79], a[52:55], v[84:87]
    ds_read_b128 a[4:7], v6 offset:1024
    ds_read_b128 a[52:55], v6 offset:17408
    v_mfma_f32_16x16x32_bf16 v[88:91], a[28:31], a[8:11], 0
    v_mfma_f32_16x16x32_bf16 v[88:91], a[76:79], a[56:59], v[88:91]
    v_mfma_f32_16x16x32_bf16 v[152:155], a[44:47], a[8:11], 0
    v_mfma_f32_16x16x32_bf16 v[152:155], a[92:95], a[56:59], v[152:155]
    ds_read_b128 a[8:11], v6 offset:2048
    ds_read_b128 a[56:59], v6 offset:18432
    v_mfma_f32_16x16x32_bf16 v[156:159], a[44:47], a[12:15], 0
    v_mfma_f32_16x16x32_bf16 v[156:159], a[92:95], a[60:63], v[156:159]
    v_mfma_f32_16x16x32_bf16 v[92:95], a[28:31], a[12:15], 0
    v_mfma_f32_16x16x32_bf16 v[92:95], a[76:79], a[60:63], v[92:95]
    ds_read_b128 a[12:15], v6 offset:3072
    ds_read_b128 a[60:63], v6 offset:19456
    s_waitcnt lgkmcnt(7)
    v_mfma_f32_16x16x32_bf16 v[32:35], a[16:19], a[0:3], v[32:35]
    ds_read_b64_tr_b16 a[28:29], v7 offset:96
    s_waitcnt lgkmcnt(7)
    v_mfma_f32_16x16x32_bf16 v[32:35], a[64:67], a[48:51], v[32:35]
    ds_read_b64_tr_b16 a[30:31], v7 offset:3680
    v_mfma_f32_16x16x32_bf16 v[96:99], a[32:35], a[0:3], v[96:99]
    ds_read_b64_tr_b16 a[76:77], v7 offset:14432
    v_mfma_f32_16x16x32_bf16 v[96:99], a[80:83], a[48:51], v[96:99]
    ds_read_b64_tr_b16 a[78:79], v7 offset:18016
    s_waitcnt lgkmcnt(9)
    v_mfma_f32_16x16x32_bf16 v[100:103], a[32:35], a[4:7], v[100:103]
    ds_read_b64_tr_b16 a[44:45], v7 offset:7264
    s_waitcnt lgkmcnt(9)
    v_mfma_f32_16x16x32_bf16 v[100:103], a[80:83], a[52:55], v[100:103]
    ds_read_b64_tr_b16 a[46:47], v7 offset:10848
    v_mfma_f32_16x16x32_bf16 v[36:39], a[16:19], a[4:7], v[36:39]
    ds_read_b64_tr_b16 a[92:93], v7 offset:21600
    v_mfma_f32_16x16x32_bf16 v[36:39], a[64:67], a[52:55], v[36:39]
    ds_read_b64_tr_b16 a[94:95], v7 offset:25184
    s_waitcnt lgkmcnt(11)
    v_mfma_f32_16x16x32_bf16 v[40:43], a[16:19], a[8:11], v[40:43]
    s_waitcnt lgkmcnt(10)
    v_mfma_f32_16x16x32_bf16 v[40:43], a[64:67], a[56:59], v[40:43]
    v_mfma_f32_16x16x32_bf16 v[104:107], a[32:35], a[8:11], v[104:107]
    v_mfma_f32_16x16x32_bf16 v[104:107], a[80:83], a[56:59], v[104:107]
    s_waitcnt lgkmcnt(9)
    v_mfma_f32_16x16x32_bf16 v[108:111], a[32:35], a[12:15], v[108:111]
    s_waitcnt lgkmcnt(8)
    v_mfma_f32_16x16x32_bf16 v[108:111], a[80:83], a[60:63], v[108:111]
    v_add_u32 v6, s37, v6
    v_add_u32 v7, s19, v7
    v_mfma_f32_16x16x32_bf16 v[44:47], a[16:19], a[12:15], v[44:47]
    v_mfma_f32_16x16x32_bf16 v[44:47], a[64:67], a[60:63], v[44:47]
    s_waitcnt vmcnt(1) lgkmcnt(0)
    s_barrier
Lp3loop_102:
    s_mov_b32 m0, s18
    s_nop 0
    buffer_load_dwordx4 v1, s[4:7], s16 offen offset:0 sc1 lds
    buffer_load_dwordx4 v1, s[4:7], s16 offen offset:1024 sc1 lds
    buffer_load_dwordx4 v1, s[4:7], s16 offen offset:2048 sc1 lds
    buffer_load_dwordx4 v1, s[4:7], s16 offen offset:3072 sc1 lds
    s_add_u32 s16, s16, 131072
    s_add_u32 s18, s18, 16384
    s_cmp_ge_u32 s18, 151552
    s_cselect_b32 s18, s30, s18
    s_mov_b32 m0, s18
    s_nop 0
    buffer_load_dwordx4 v1, s[4:7], s16 offen offset:0 sc1 lds
    buffer_load_dwordx4 v1, s[4:7], s16 offen offset:1024 sc1 lds
    buffer_load_dwordx4 v1, s[4:7], s16 offen offset:2048 sc1 lds
    buffer_load_dwordx4 v1, s[4:7], s16 offen offset:3072 sc1 lds
    s_add_u32 s16, s16, 131072
    s_add_u32 s18, s18, 16384
    s_cmp_ge_u32 s18, 151552
    s_cselect_b32 s18, s30, s18
    buffer_load_dword v24, v29, s[8:11], s89 offen
    s_add_u32 s89, s89, 458752
    s_load_dwordx2 s[90:91], s[86:87], s88
    s_add_u32 s88, s88, 131072
    s_min_u32 s88, s88, 3538944
    s_load_dwordx2 s[90:91], s[86:87], s88
    s_add_u32 s88, s88, 131072
    s_min_u32 s88, s88, 3538944
    s_bitcmp1_b32 s85, s38
    s_cbranch_scc0 Lxe_113
    s_setprio 2
    s_bitcmp1_b32 s33, 1
    s_cbranch_scc1 Lxh_111
    s_bitcmp1_b32 s33, 0
    s_cbranch_scc1 Lx1_110
    v_mfma_f32_16x16x32_bf16 v[8:11], a[16:19], v[16:19], v[8:11]
    v_mfma_f32_16x16x32_bf16 v[8:11], a[64:67], v[16:19], v[8:11]
    v_mfma_f32_16x16x32_bf16 v[12:15], a[32:35], v[16:19], v[12:15]
    v_mfma_f32_16x16x32_bf16 v[12:15], a[80:83], v[16:19], v[12:15]
    s_branch Lxe_113
Lx1_110:
    v_mfma_f32_16x16x32_bf16 v[8:11], a[20:23], v[16:19], v[8:11]
    v_mfma_f32_16x16x32_bf16 v[8:11], a[68:71], v[16:19], v[8:11]
    v_mfma_f32_16x16x32_bf16 v[12:15], a[36:39], v[16:19], v[12:15]
    v_mfma_f32_16x16x32_bf16 v[12:15], a[84:87], v[16:19], v[12:15]
    s_branch Lxe_113
Lxh_111:
    s_bitcmp1_b32 s33, 0
    s_cbranch_scc1 Lx3_112
    v_mfma_f32_16x16x32_bf16 v[8:11], a[24:27], v[16:19], v[8:11]
    v_mfma_f32_16x16x32_bf16 v[8:11], a[72:75], v[16:19], v[8:11]
    v_mfma_f32_16x16x32_bf16 v[12:15], a[40:43], v[16:19], v[12:15]
    v_mfma_f32_16x16x32_bf16 v[12:15], a[88:91], v[16:19], v[12:15]
    s_branch Lxe_113
Lx3_112:
    v_mfma_f32_16x16x32_bf16 v[8:11], a[28:31], v[16:19], v[8:11]
    v_mfma_f32_16x16x32_bf16 v[8:11], a[76:79], v[16:19], v[8:11]
    v_mfma_f32_16x16x32_bf16 v[12:15], a[44:47], v[16:19], v[12:15]
    v_mfma_f32_16x16x32_bf16 v[12:15], a[92:95], v[16:19], v[12:15]
Lxe_113:
    s_setprio 0
    s_bitcmp1_b32 s45, s38
    s_cbranch_scc1 Lhk_107
Lhkb_108:
    s_add_u32 s36, s36, 1
    s_cmp_ge_u32 s36, 3
    s_cselect_b32 s19, s47, s46
    s_cselect_b32 s36, 0, s36
    s_sub_u32 s37, 0, s37
    s_sub_u32 s38, s38, 1
    s_cmp_lg_u32 s38, 2
    ds_read_b64_tr_b16 a[16:17], v7 offset:0
    ds_read_b64_tr_b16 a[18:19], v7 offset:3584
    ds_read_b64_tr_b16 a[64:65], v7 offset:14336
    ds_read_b64_tr_b16 a[66:67], v7 offset:17920
    ds_read_b64_tr_b16 a[32:33], v7 offset:7168
    ds_read_b64_tr_b16 a[34:35], v7 offset:10752
    ds_read_b64_tr_b16 a[80:81], v7 offset:21504
    ds_read_b64_tr_b16 a[82:83], v7 offset:25088
    v_mfma_f32_16x16x32_bf16 v[60:63], a[20:23], a[12:15], v[60:63]
    v_mfma_f32_16x16x32_bf16 v[60:63], a[68:71], a[60:63], v[60:63]
    v_mfma_f32_16x16x32_bf16 v[56:59], a[20:23], a[8:11], v[56:59]
    v_mfma_f32_16x16x32_bf16 v[56:59], a[68:71], a[56:59], v[56:59]
    v_mfma_f32_16x16x32_bf16 v[52:55], a[20:23], a[4:7], v[52:55]
    v_mfma_f32_16x16x32_bf16 v[52:55], a[68:71], a[52:55], v[52:55]
    v_mfma_f32_16x16x32_bf16 v[48:51], a[20:23], a[0:3], v[48:51]
    v_mfma_f32_16x16x32_bf16 v[48:51], a[68:71], a[48:51], v[48:51]
    ds_read_b64_tr_b16 a[20:21], v7 offset:32
    v_mfma_f32_16x16x32_bf16 v[112:115], a[36:39], a[0:3], v[112:115]
    ds_read_b64_tr_b16 a[22:23], v7 offset:3616
    v_mfma_f32_16x16x32_bf16 v[112:115], a[84:87], a[48:51], v[112:115]
    ds_read_b64_tr_b16 a[68:69], v7 offset:14368
    v_mfma_f32_16x16x32_bf16 v[116:119], a[36:39], a[4:7], v[116:119]
    ds_read_b64_tr_b16 a[70:71], v7 offset:17952
    v_mfma_f32_16x16x32_bf16 v[116:119], a[84:87], a[52:55], v[116:119]
    v_mfma_f32_16x16x32_bf16 v[120:123], a[36:39], a[8:11], v[120:123]
    v_mfma_f32_16x16x32_bf16 v[120:123], a[84:87], a[56:59], v[120:123]
    v_mfma_f32_16x16x32_bf16 v[124:127], a[36:39], a[12:15], v[124:127]
    v_mfma_f32_16x16x32_bf16 v[124:127], a[84:87], a[60:63], v[124:127]
    ds_read_b64_tr_b16 a[36:37], v7 offset:7200
    v_mfma_f32_16x16x32_bf16 v[76:79], a[24:27], a[12:15], v[76:79]
    ds_read_b64_tr_b16 a[38:39], v7 offset:10784
    v_mfma_f32_16x16x32_bf16 v[76:79], a[72:75], a[60:63], v[76:79]
    ds_read_b64_tr_b16 a[84:85], v7 offset:21536
    v_mfma_f32_16x16x32_bf16 v[72:75], a[24:27], a[8:11], v[72:75]
    ds_read_b64_tr_b16 a[86:87], v7 offset:25120
    v_mfma_f32_16x16x32_bf16 v[72:75], a[72:75], a[56:59], v[72:75]
    v_mfma_f32_16x16x32_bf16 v[68:71], a[24:27], a[4:7], v[68:71]
    v_mfma_f32_16x16x32_bf16 v[68:71], a[72:75], a[52:55], v[68:71]
    v_mfma_f32_16x16x32_bf16 v[64:67], a[24:27], a[0:3], v[64:67]
    v_mfma_f32_16x16x32_bf16 v[64:67], a[72:75], a[48:51], v[64:67]
    ds_read_b64_tr_b16 a[24:25], v7 offset:64
    v_mfma_f32_16x16x32_bf16 v[128:131], a[40:43], a[0:3], v[128:131]
    ds_read_b64_tr_b16 a[26:27], v7 offset:3648
    v_mfma_f32_16x16x32_bf16 v[128:131], a[88:91], a[48:51], v[128:131]
    ds_read_b64_tr_b16 a[72:73], v7 offset:14400
    v_mfma_f32_16x16x32_bf16 v[132:135], a[40:43], a[4:7], v[132:135]
    ds_read_b64_tr_b16 a[74:75], v7 offset:17984
    v_mfma_f32_16x16x32_bf16 v[132:135], a[88:91], a[52:55], v[132:135]
    v_mfma_f32_16x16x32_bf16 v[136:139], a[40:43], a[8:11], v[136:139]
    v_mfma_f32_16x16x32_bf16 v[136:139], a[88:91], a[56:59], v[136:139]
    v_mfma_f32_16x16x32_bf16 v[140:143], a[40:43], a[12:15], v[140:143]
    v_mfma_f32_16x16x32_bf16 v[140:143], a[88:91], a[60:63], v[140:143]
    ds_read_b64_tr_b16 a[40:41], v7 offset:7232
    v_mfma_f32_16x16x32_bf16 v[80:83], a[28:31], a[0:3], v[80:83]
    ds_read_b64_tr_b16 a[42:43], v7 offset:10816
    v_mfma_f32_16x16x32_bf16 v[80:83], a[76:79], a[48:51], v[80:83]
    ds_read_b64_tr_b16 a[88:89], v7 offset:21568
    v_mfma_f32_16x16x32_bf16 v[144:147], a[44:47], a[0:3], v[144:147]
    ds_read_b64_tr_b16 a[90:91], v7 offset:25152
    v_mfma_f32_16x16x32_bf16 v[144:147], a[92:95], a[48:51], v[144:147]
    ds_read_b128 a[0:3], v6 offset:0
    ds_read_b128 a[48:51], v6 offset:16384
    v_mfma_f32_16x16x32_bf16 v[148:151], a[44:47], a[4:7], v[148:151]
    v_mfma_f32_16x16x32_bf16 v[148:151], a[92:95], a[52:55], v[148:151]
    v_mfma_f32_16x16x32_bf16 v[84:87], a[28:31], a[4:7], v[84:87]
    v_mfma_f32_16x16x32_bf16 v[84:87], a[76:79], a[52:55], v[84:87]
    ds_read_b128 a[4:7], v6 offset:1024
    ds_read_b128 a[52:55], v6 offset:17408
    v_mfma_f32_16x16x32_bf16 v[88:91], a[28:31], a[8:11], v[88:91]
    v_mfma_f32_16x16x32_bf16 v[88:91], a[76:79], a[56:59], v[88:91]
    v_mfma_f32_16x16x32_bf16 v[152:155], a[44:47], a[8:11], v[152:155]
    v_mfma_f32_16x16x32_bf16 v[152:155], a[92:95], a[56:59], v[152:155]
    ds_read_b128 a[8:11], v6 offset:2048
    ds_read_b128 a[56:59], v6 offset:18432
    v_mfma_f32_16x16x32_bf16 v[156:159], a[44:47], a[12:15], v[156:159]
    v_mfma_f32_16x16x32_bf16 v[156:159], a[92:95], a[60:63], v[156:159]
    v_mfma_f32_16x16x32_bf16 v[92:95], a[28:31], a[12:15], v[92:95]
    v_mfma_f32_16x16x32_bf16 v[92:95], a[76:79], a[60:63], v[92:95]
    ds_read_b128 a[12:15], v6 offset:3072
    ds_read_b128 a[60:63], v6 offset:19456
    s_waitcnt lgkmcnt(7)
    v_mfma_f32_16x16x32_bf16 v[32:35], a[16:19], a[0:3], v[32:35]
    ds_read_b64_tr_b16 a[28:29], v7 offset:96
    s_waitcnt lgkmcnt(7)
    v_mfma_f32_16x16x32_bf16 v[32:35], a[64:67], a[48:51], v[32:35]
    ds_read_b64_tr_b16 a[30:31], v7 offset:3680
    v_mfma_f32_16x16x32_bf16 v[96:99], a[32:35], a[0:3], v[96:99]
    ds_read_b64_tr_b16 a[76:77], v7 offset:14432
    v_mfma_f32_16x16x32_bf16 v[96:99], a[80:83], a[48:51], v[96:99]
    ds_read_b64_tr_b16 a[78:79], v7 offset:18016
    s_waitcnt lgkmcnt(9)
    v_mfma_f32_16x16x32_bf16 v[100:103], a[32:35], a[4:7], v[100:103]
    ds_read_b64_tr_b16 a[44:45], v7 offset:7264
    s_waitcnt lgkmcnt(9)
    v_mfma_f32_16x16x32_bf16 v[100:103], a[80:83], a[52:55], v[100:103]
    ds_read_b64_tr_b16 a[46:47], v7 offset:10848
    v_mfma_f32_16x16x32_bf16 v[36:39], a[16:19], a[4:7], v[36:39]
    ds_read_b64_tr_b16 a[92:93], v7 offset:21600
    v_mfma_f32_16x16x32_bf16 v[36:39], a[64:67], a[52:55], v[36:39]
    ds_read_b64_tr_b16 a[94:95], v7 offset:25184
    s_waitcnt lgkmcnt(11)
    v_mfma_f32_16x16x32_bf16 v[40:43], a[16:19], a[8:11], v[40:43]
    s_waitcnt lgkmcnt(10)
    v_mfma_f32_16x16x32_bf16 v[40:43], a[64:67], a[56:59], v[40:43]
    v_mfma_f32_16x16x32_bf16 v[104:107], a[32:35], a[8:11], v[104:107]
    v_mfma_f32_16x16x32_bf16 v[104:107], a[80:83], a[56:59], v[104:107]
    s_waitcnt lgkmcnt(9)
    v_mfma_f32_16x16x32_bf16 v[108:111], a[32:35], a[12:15], v[108:111]
    s_waitcnt lgkmcnt(8)
    v_mfma_f32_16x16x32_bf16 v[108:111], a[80:83], a[60:63], v[108:111]
    v_add_u32 v6, s37, v6
    v_add_u32 v7, s19, v7
    v_mfma_f32_16x16x32_bf16 v[44:47], a[16:19], a[12:15], v[44:47]
    v_mfma_f32_16x16x32_bf16 v[44:47], a[64:67], a[60:63], v[44:47]
    s_waitcnt vmcnt(1) lgkmcnt(0)
    s_barrier
    s_cbranch_scc1 Lp3loop_102
    s_mov_b32 m0, s18
    s_nop 0
    buffer_load_dwordx4 v1, s[4:7], s16 offen offset:0 sc1 lds
    buffer_load_dwordx4 v1, s[4:7], s16 offen offset:1024 sc1 lds
    buffer_load_dwordx4 v1, s[4:7], s16 offen offset:2048 sc1 lds
    buffer_load_dwordx4 v1, s[4:7], s16 offen offset:3072 sc1 lds
    s_add_u32 s16, s16, 131072
    s_add_u32 s18, s18, 16384
    s_cmp_ge_u32 s18, 151552
    s_cselect_b32 s18, s30, s18
    s_mov_b32 m0, s18
    s_nop 0
    buffer_load_dwordx4 v1, s[4:7], s16 offen offset:0 sc1 lds
    buffer_load_dwordx4 v1, s[4:7], s16 offen offset:1024 sc1 lds
    buffer_load_dwordx4 v1, s[4:7], s16 offen offset:2048 sc1 lds
    buffer_load_dwordx4 v1, s[4:7], s16 offen offset:3072 sc1 lds
    s_add_u32 s16, s16, 131072
    s_add_u32 s18, s18, 16384
    s_cmp_ge_u32 s18, 151552
    s_cselect_b32 s18, s30, s18
    s_load_dwordx2 s[90:91], s[86:87], s88
    s_add_u32 s88, s88, 131072
    s_min_u32 s88, s88, 3538944
    s_load_dwordx2 s[90:91], s[86:87], s88
    s_add_u32 s88, s88, 131072
    s_min_u32 s88, s88, 3538944
    s_setprio 2
    s_bitcmp1_b32 s33, 1
    s_cbranch_scc1 Lxh_115
    s_bitcmp1_b32 s33, 0
    s_cbranch_scc1 Lx1_114
    v_mfma_f32_16x16x32_bf16 v[8:11], a[16:19], v[16:19], v[8:11]
    v_mfma_f32_16x16x32_bf16 v[8:11], a[64:67], v[16:19], v[8:11]
    v_mfma_f32_16x16x32_bf16 v[12:15], a[32:35], v[16:19], v[12:15]
    v_mfma_f32_16x16x32_bf16 v[12:15], a[80:83], v[16:19], v[12:15]
    s_branch Lxe_117
Lx1_114:
    v_mfma_f32_16x16x32_bf16 v[8:11], a[20:23], v[16:19], v[8:11]
    v_mfma_f32_16x16x32_bf16 v[8:11], a[68:71], v[16:19], v[8:11]
    v_mfma_f32_16x16x32_bf16 v[12:15], a[36:39], v[16:19], v[12:15]
    v_mfma_f32_16x16x32_bf16 v[12:15], a[84:87], v[16:19], v[12:15]
    s_branch Lxe_117
Lxh_115:
    s_bitcmp1_b32 s33, 0
    s_cbranch_scc1 Lx3_116
    v_mfma_f32_16x16x32_bf16 v[8:11], a[24:27], v[16:19], v[8:11]
    v_mfma_f32_16x16x32_bf16 v[8:11], a[72:75], v[16:19], v[8:11]
    v_mfma_f32_16x16x32_bf16 v[12:15], a[40:43], v[16:19], v[12:15]
    v_mfma_f32_16x16x32_bf16 v[12:15], a[88:91], v[16:19], v[12:15]
    s_branch Lxe_117
Lx3_116:
    v_mfma_f32_16x16x32_bf16 v[8:11], a[28:31], v[16:19], v[8:11]
    v_mfma_f32_16x16x32_bf16 v[8:11], a[76:79], v[16:19], v[8:11]
    v_mfma_f32_16x16x32_bf16 v[12:15], a[44:47], v[16:19], v[12:15]
    v_mfma_f32_16x16x32_bf16 v[12:15], a[92:95], v[16:19], v[12:15]
Lxe_117:
    s_setprio 0
    s_add_u32 s36, s36, 1
    s_cmp_ge_u32 s36, 3
    s_cselect_b32 s19, s47, s46
    s_cselect_b32 s36, 0, s36
    s_sub_u32 s37, 0, s37
    ds_read_b64_tr_b16 a[16:17], v7 offset:0
    ds_read_b64_tr_b16 a[18:19], v7 offset:3584
    ds_read_b64_tr_b16 a[64:65], v7 offset:14336
    ds_read_b64_tr_b16 a[66:67], v7 offset:17920
    ds_read_b64_tr_b16 a[32:33], v7 offset:7168
    ds_read_b64_tr_b16 a[34:35], v7 offset:10752
    ds_read_b64_tr_b16 a[80:81], v7 offset:21504
    ds_read_b64_tr_b16 a[82:83], v7 offset:25088
    v_mfma_f32_16x16x32_bf16 v[60:63], a[20:23], a[12:15], v[60:63]
    v_mfma_f32_16x16x32_bf16 v[60:63], a[68:71], a[60:63], v[60:63]
    v_mfma_f32_16x16x32_bf16 v[56:59], a[20:23], a[8:11], v[56:59]
    v_mfma_f32_16x16x32_bf16 v[56:59], a[68:71], a[56:59], v[56:59]
    v_mfma_f32_16x16x32_bf16 v[52:55], a[20:23], a[4:7], v[52:55]
    v_mfma_f32_16x16x32_bf16 v[52:55], a[68:71], a[52:55], v[52:55]
    v_mfma_f32_16x16x32_bf16 v[48:51], a[20:23], a[0:3], v[48:51]
    v_mfma_f32_16x16x32_bf16 v[48:51], a[68:71], a[48:51], v[48:51]
    ds_read_b64_tr_b16 a[20:21], v7 offset:32
    v_mfma_f32_16x16x32_bf16 v[112:115], a[36:39], a[0:3], v[112:115]
    ds_read_b64_tr_b16 a[22:23], v7 offset:3616
    v_mfma_f32_16x16x32_bf16 v[112:115], a[84:87], a[48:51], v[112:115]
    ds_read_b64_tr_b16 a[68:69], v7 offset:14368
    v_mfma_f32_16x16x32_bf16 v[116:119], a[36:39], a[4:7], v[116:119]
    ds_read_b64_tr_b16 a[70:71], v7 offset:17952
    v_mfma_f32_16x16x32_bf16 v[116:119], a[84:87], a[52:55], v[116:119]
    v_mfma_f32_16x16x32_bf16 v[120:123], a[36:39], a[8:11], v[120:123]
    v_mfma_f32_16x16x32_bf16 v[120:123], a[84:87], a[56:59], v[120:123]
    v_mfma_f32_16x16x32_bf16 v[124:127], a[36:39], a[12:15], v[124:127]
    v_mfma_f32_16x16x32_bf16 v[124:127], a[84:87], a[60:63], v[124:127]
    ds_read_b64_tr_b16 a[36:37], v7 offset:7200
    v_mfma_f32_16x16x32_bf16 v[76:79], a[24:27], a[12:15], v[76:79]
    ds_read_b64_tr_b16 a[38:39], v7 offset:10784
    v_mfma_f32_16x16x32_bf16 v[76:79], a[72:75], a[60:63], v[76:79]
    ds_read_b64_tr_b16 a[84:85], v7 offset:21536
    v_mfma_f32_16x16x32_bf16 v[72:75], a[24:27], a[8:11], v[72:75]
    ds_read_b64_tr_b16 a[86:87], v7 offset:25120
    v_mfma_f32_16x16x32_bf16 v[72:75], a[72:75], a[56:59], v[72:75]
    v_mfma_f32_16x16x32_bf16 v[68:71], a[24:27], a[4:7], v[68:71]
    v_mfma_f32_16x16x32_bf16 v[68:71], a[72:75], a[52:55], v[68:71]
    v_mfma_f32_16x16x32_bf16 v[64:67], a[24:27], a[0:3], v[64:67]
    v_mfma_f32_16x16x32_bf16 v[64:67], a[72:75], a[48:51], v[64:67]
    ds_read_b64_tr_b16 a[24:25], v7 offset:64
    v_mfma_f32_16x16x32_bf16 v[128:131], a[40:43], a[0:3], v[128:131]
    ds_read_b64_tr_b16 a[26:27], v7 offset:3648
    v_mfma_f32_16x16x32_bf16 v[128:131], a[88:91], a[48:51], v[128:131]
    ds_read_b64_tr_b16 a[72:73], v7 offset:14400
    v_mfma_f32_16x16x32_bf16 v[132:135], a[40:43], a[4:7], v[132:135]
    ds_read_b64_tr_b16 a[74:75], v7 offset:17984
    v_mfma_f32_16x16x32_bf16 v[132:135], a[88:91], a[52:55], v[132:135]
    v_mfma_f32_16x16x32_bf16 v[136:139], a[40:43], a[8:11], v[136:139]
    v_mfma_f32_16x16x32_bf16 v[136:139], a[88:91], a[56:59], v[136:139]
    v_mfma_f32_16x16x32_bf16 v[140:143], a[40:43], a[12:15], v[140:143]
    v_mfma_f32_16x16x32_bf16 v[140:143], a[88:91], a[60:63], v[140:143]
    ds_read_b64_tr_b16 a[40:41], v7 offset:7232
    v_mfma_f32_16x16x32_bf16 v[80:83], a[28:31], a[0:3], v[80:83]
    ds_read_b64_tr_b16 a[42:43], v7 offset:10816
    v_mfma_f32_16x16x32_bf16 v[80:83], a[76:79], a[48:51], v[80:83]
    ds_read_b64_tr_b16 a[88:89], v7 offset:21568
    v_mfma_f32_16x16x32_bf16 v[144:147], a[44:47], a[0:3], v[144:147]
    ds_read_b64_tr_b16 a[90:91], v7 offset:25152
    v_mfma_f32_16x16x32_bf16 v[144:147], a[92:95], a[48:51], v[144:147]
    ds_read_b128 a[0:3], v6 offset:0
    ds_read_b128 a[48:51], v6 offset:16384
    v_mfma_f32_16x16x32_bf16 v[148:151], a[44:47], a[4:7], v[148:151]
    v_mfma_f32_16x16x32_bf16 v[148:151], a[92:95], a[52:55], v[148:151]
    v_mfma_f32_16x16x32_bf16 v[84:87], a[28:31], a[4:7], v[84:87]
    v_mfma_f32_16x16x32_bf16 v[84:87], a[76:79], a[52:55], v[84:87]
    ds_read_b128 a[4:7], v6 offset:1024
    ds_read_b128 a[52:55], v6 offset:17408
    v_mfma_f32_16x16x32_bf16 v[88:91], a[28:31], a[8:11], v[88:91]
    v_mfma_f32_16x16x32_bf16 v[88:91], a[76:79], a[56:59], v[88:91]
    v_mfma_f32_16x16x32_bf16 v[152:155], a[44:47], a[8:11], v[152:155]
    v_mfma_f32_16x16x32_bf16 v[152:155], a[92:95], a[56:59], v[152:155]
    ds_read_b128 a[8:11], v6 offset:2048
    ds_read_b128 a[56:59], v6 offset:18432
    v_mfma_f32_16x16x32_bf16 v[156:159], a[44:47], a[12:15], v[156:159]
    v_mfma_f32_16x16x32_bf16 v[156:159], a[92:95], a[60:63], v[156:159]
    v_mfma_f32_16x16x32_bf16 v[92:95], a[28:31], a[12:15], v[92:95]
    v_mfma_f32_16x16x32_bf16 v[92:95], a[76:79], a[60:63], v[92:95]
    ds_read_b128 a[12:15], v6 offset:3072
    ds_read_b128 a[60:63], v6 offset:19456
    s_waitcnt lgkmcnt(7)
    v_mfma_f32_16x16x32_bf16 v[32:35], a[16:19], a[0:3], v[32:35]
    ds_read_b64_tr_b16 a[28:29], v7 offset:96
    s_waitcnt lgkmcnt(7)
    v_mfma_f32_16x16x32_bf16 v[32:35], a[64:67], a[48:51], v[32:35]
    ds_read_b64_tr_b16 a[30:31], v7 offset:3680
    v_mfma_f32_16x16x32_bf16 v[96:99], a[32:35], a[0:3], v[96:99]
    ds_read_b64_tr_b16 a[76:77], v7 offset:14432
    v_mfma_f32_16x16x32_bf16 v[96:99], a[80:83], a[48:51], v[96:99]
    ds_read_b64_tr_b16 a[78:79], v7 offset:18016
    s_waitcnt lgkmcnt(9)
    v_mfma_f32_16x16x32_bf16 v[100:103], a[32:35], a[4:7], v[100:103]
    ds_read_b64_tr_b16 a[44:45], v7 offset:7264
    s_waitcnt lgkmcnt(9)
    v_mfma_f32_16x16x32_bf16 v[100:103], a[80:83], a[52:55], v[100:103]
    ds_read_b64_tr_b16 a[46:47], v7 offset:10848
    v_mfma_f32_16x16x32_bf16 v[36:39], a[16:19], a[4:7], v[36:39]
    ds_read_b64_tr_b16 a[92:93], v7 offset:21600
    v_mfma_f32_16x16x32_bf16 v[36:39], a[64:67], a[52:55], v[36:39]
    ds_read_b64_tr_b16 a[94:95], v7 offset:25184
    s_waitcnt lgkmcnt(11)
    v_mfma_f32_16x16x32_bf16 v[40:43], a[16:19], a[8:11], v[40:43]
    s_waitcnt lgkmcnt(10)
    v_mfma_f32_16x16x32_bf16 v[40:43], a[64:67], a[56:59], v[40:43]
    v_mfma_f32_16x16x32_bf16 v[104:107], a[32:35], a[8:11], v[104:107]
    v_mfma_f32_16x16x32_bf16 v[104:107], a[80:83], a[56:59], v[104:107]
    s_waitcnt lgkmcnt(9)
    v_mfma_f32_16x16x32_bf16 v[108:111], a[32:35], a[12:15], v[108:111]
    s_waitcnt lgkmcnt(8)
    v_mfma_f32_16x16x32_bf16 v[108:111], a[80:83], a[60:63], v[108:111]
    v_add_u32 v6, s37, v6
    v_add_u32 v7, s19, v7
    v_mfma_f32_16x16x32_bf16 v[44:47], a[16:19], a[12:15], v[44:47]
    v_mfma_f32_16x16x32_bf16 v[44:47], a[64:67], a[60:63], v[44:47]
    s_waitcnt vmcnt(0) lgkmcnt(0)
    s_barrier
    s_setprio 2
    s_bitcmp1_b32 s33, 1
    s_cbranch_scc1 Lxh_119
    s_bitcmp1_b32 s33, 0
    s_cbranch_scc1 Lx1_118
    v_mfma_f32_16x16x32_bf16 v[8:11], a[16:19], v[16:19], v[8:11]
    v_mfma_f32_16x16x32_bf16 v[8:11], a[64:67], v[16:19], v[8:11]
    v_mfma_f32_16x16x32_bf16 v[12:15], a[32:35], v[16:19], v[12:15]
    v_mfma_f32_16x16x32_bf16 v[12:15], a[80:83], v[16:19], v[12:15]
    s_branch Lxe_121
Lx1_118:
    v_mfma_f32_16x16x32_bf16 v[8:11], a[20:23], v[16:19], v[8:11]
    v_mfma_f32_16x16x32_bf16 v[8:11], a[68:71], v[16:19], v[8:11]
    v_mfma_f32_16x16x32_bf16 v[12:15], a[36:39], v[16:19], v[12:15]
    v_mfma_f32_16x16x32_bf16 v[12:15], a[84:87], v[16:19], v[12:15]
    s_branch Lxe_121
Lxh_119:
    s_bitcmp1_b32 s33, 0
    s_cbranch_scc1 Lx3_120
    v_mfma_f32_16x16x32_bf16 v[8:11], a[24:27], v[16:19], v[8:11]
    v_mfma_f32_16x16x32_bf16 v[8:11], a[72:75], v[16:19], v[8:11]
    v_mfma_f32_16x16x32_bf16 v[12:15], a[40:43], v[16:19], v[12:15]
    v_mfma_f32_16x16x32_bf16 v[12:15], a[88:91], v[16:19], v[12:15]
    s_branch Lxe_121
Lx3_120:
    v_mfma_f32_16x16x32_bf16 v[8:11], a[28:31], v[16:19], v[8:11]
    v_mfma_f32_16x16x32_bf16 v[8:11], a[76:79], v[16:19], v[8:11]
    v_mfma_f32_16x16x32_bf16 v[12:15], a[44:47], v[16:19], v[12:15]
    v_mfma_f32_16x16x32_bf16 v[12:15], a[92:95], v[16:19], v[12:15]
Lxe_121:
    s_setprio 0
    s_add_u32 s36, s36, 1
    s_cmp_ge_u32 s36, 3
    s_cselect_b32 s19, s47, s46
    s_cselect_b32 s36, 0, s36
    s_sub_u32 s37, 0, s37
    ds_read_b64_tr_b16 a[16:17], v7 offset:0
    ds_read_b64_tr_b16 a[18:19], v7 offset:3584
    ds_read_b64_tr_b16 a[64:65], v7 offset:14336
    ds_read_b64_tr_b16 a[66:67], v7 offset:17920
    ds_read_b64_tr_b16 a[32:33], v7 offset:7168
    ds_read_b64_tr_b16 a[34:35], v7 offset:10752
    ds_read_b64_tr_b16 a[80:81], v7 offset:21504
    ds_read_b64_tr_b16 a[82:83], v7 offset:25088
    v_mfma_f32_16x16x32_bf16 v[60:63], a[20:23], a[12:15], v[60:63]
    v_mfma_f32_16x16x32_bf16 v[60:63], a[68:71], a[60:63], v[60:63]
    v_mfma_f32_16x16x32_bf16 v[56:59], a[20:23], a[8:11], v[56:59]
    v_mfma_f32_16x16x32_bf16 v[56:59], a[68:71], a[56:59], v[56:59]
    v_mfma_f32_16x16x32_bf16 v[52:55], a[20:23], a[4:7], v[52:55]
    v_mfma_f32_16x16x32_bf16 v[52:55], a[68:71], a[52:55], v[52:55]
    v_mfma_f32_16x16x32_bf16 v[48:51], a[20:23], a[0:3], v[48:51]
    v_mfma_f32_16x16x32_bf16 v[48:51], a[68:71], a[48:51], v[48:51]
    ds_read_b64_tr_b16 a[20:21], v7 offset:32
    v_mfma_f32_16x16x32_bf16 v[112:115], a[36:39], a[0:3], v[112:115]
    ds_read_b64_tr_b16 a[22:23], v7 offset:3616
    v_mfma_f32_16x16x32_bf16 v[112:115], a[84:87], a[48:51], v[112:115]
    ds_read_b64_tr_b16 a[68:69], v7 offset:14368
    v_mfma_f32_16x16x32_bf16 v[116:119], a[36:39], a[4:7], v[116:119]
    ds_read_b64_tr_b16 a[70:71], v7 offset:17952
    v_mfma_f32_16x16x32_bf16 v[116:119], a[84:87], a[52:55], v[116:119]
    v_mfma_f32_16x16x32_bf16 v[120:123], a[36:39], a[8:11], v[120:123]
    v_mfma_f32_16x16x32_bf16 v[120:123], a[84:87], a[56:59], v[120:123]
    v_mfma_f32_16x16x32_bf16 v[124:127], a[36:39], a[12:15], v[124:127]
    v_mfma_f32_16x16x32_bf16 v[124:127], a[84:87], a[60:63], v[124:127]
    ds_read_b64_tr_b16 a[36:37], v7 offset:7200
    v_mfma_f32_16x16x32_bf16 v[76:79], a[24:27], a[12:15], v[76:79]
    ds_read_b64_tr_b16 a[38:39], v7 offset:10784
    v_mfma_f32_16x16x32_bf16 v[76:79], a[72:75], a[60:63], v[76:79]
    ds_read_b64_tr_b16 a[84:85], v7 offset:21536
    v_mfma_f32_16x16x32_bf16 v[72:75], a[24:27], a[8:11], v[72:75]
    ds_read_b64_tr_b16 a[86:87], v7 offset:25120
    v_mfma_f32_16x16x32_bf16 v[72:75], a[72:75], a[56:59], v[72:75]
    v_mfma_f32_16x16x32_bf16 v[68:71], a[24:27], a[4:7], v[68:71]
    v_mfma_f32_16x16x32_bf16 v[68:71], a[72:75], a[52:55], v[68:71]
    v_mfma_f32_16x16x32_bf16 v[64:67], a[24:27], a[0:3], v[64:67]
    v_mfma_f32_16x16x32_bf16 v[64:67], a[72:75], a[48:51], v[64:67]
    ds_read_b64_tr_b16 a[24:25], v7 offset:64
    v_mfma_f32_16x16x32_bf16 v[128:131], a[40:43], a[0:3], v[128:131]
    ds_read_b64_tr_b16 a[26:27], v7 offset:3648
    v_mfma_f32_16x16x32_bf16 v[128:131], a[88:91], a[48:51], v[128:131]
    ds_read_b64_tr_b16 a[72:73], v7 offset:14400
    v_mfma_f32_16x16x32_bf16 v[132:135], a[40:43], a[4:7], v[132:135]
    ds_read_b64_tr_b16 a[74:75], v7 offset:17984
    v_mfma_f32_16x16x32_bf16 v[132:135], a[88:91], a[52:55], v[132:135]
    v_mfma_f32_16x16x32_bf16 v[136:139], a[40:43], a[8:11], v[136:139]
    v_mfma_f32_16x16x32_bf16 v[136:139], a[88:91], a[56:59], v[136:139]
    v_mfma_f32_16x16x32_bf16 v[140:143], a[40:43], a[12:15], v[140:143]
    v_mfma_f32_16x16x32_bf16 v[140:143], a[88:91], a[60:63], v[140:143]
    ds_read_b64_tr_b16 a[40:41], v7 offset:7232
    v_mfma_f32_16x16x32_bf16 v[80:83], a[28:31], a[0:3], v[80:83]
    ds_read_b64_tr_b16 a[42:43], v7 offset:10816
    v_mfma_f32_16x16x32_bf16 v[80:83], a[76:79], a[48:51], v[80:83]
    ds_read_b64_tr_b16 a[88:89], v7 offset:21568
    v_mfma_f32_16x16x32_bf16 v[144:147], a[44:47], a[0:3], v[144:147]
    ds_read_b64_tr_b16 a[90:91], v7 offset:25152
    v_mfma_f32_16x16x32_bf16 v[144:147], a[92:95], a[48:51], v[144:147]
    ds_read_b128 a[0:3], v6 offset:0
    ds_read_b128 a[48:51], v6 offset:16384
    v_mfma_f32_16x16x32_bf16 v[148:151], a[44:47], a[4:7], v[148:151]
    v_mfma_f32_16x16x32_bf16 v[148:151], a[92:95], a[52:55], v[148:151]
    v_mfma_f32_16x16x32_bf16 v[84:87], a[28:31], a[4:7], v[84:87]
    v_mfma_f32_16x16x32_bf16 v[84:87], a[76:79], a[52:55], v[84:87]
    ds_read_b128 a[4:7], v6 offset:1024
    ds_read_b128 a[52:55], v6 offset:17408
    v_mfma_f32_16x16x32_bf16 v[88:91], a[28:31], a[8:11], v[88:91]
    v_mfma_f32_16x16x32_bf16 v[88:91], a[76:79], a[56:59], v[88:91]
    v_mfma_f32_16x16x32_bf16 v[152:155], a[44:47], a[8:11], v[152:155]
    v_mfma_f32_16x16x32_bf16 v[152:155], a[92:95], a[56:59], v[152:155]
    ds_read_b128 a[8:11], v6 offset:2048
    ds_read_b128 a[56:59], v6 offset:18432
    v_mfma_f32_16x16x32_bf16 v[156:159], a[44:47], a[12:15], v[156:159]
    v_mfma_f32_16x16x32_bf16 v[156:159], a[92:95], a[60:63], v[156:159]
    v_mfma_f32_16x16x32_bf16 v[92:95], a[28:31], a[12:15], v[92:95]
    v_mfma_f32_16x16x32_bf16 v[92:95], a[76:79], a[60:63], v[92:95]
    ds_read_b128 a[12:15], v6 offset:3072
    ds_read_b128 a[60:63], v6 offset:19456
    s_waitcnt lgkmcnt(7)
    v_mfma_f32_16x16x32_bf16 v[32:35], a[16:19], a[0:3], v[32:35]
    ds_read_b64_tr_b16 a[28:29], v7 offset:96
    s_waitcnt lgkmcnt(7)
    v_mfma_f32_16x16x32_bf16 v[32:35], a[64:67], a[48:51], v[32:35]
    ds_read_b64_tr_b16 a[30:31], v7 offset:3680
    v_mfma_f32_16x16x32_bf16 v[96:99], a[32:35], a[0:3], v[96:99]
    ds_read_b64_tr_b16 a[76:77], v7 offset:14432
    v_mfma_f32_16x16x32_bf16 v[96:99], a[80:83], a[48:51], v[96:99]
    ds_read_b64_tr_b16 a[78:79], v7 offset:18016
    s_waitcnt lgkmcnt(9)
    v_mfma_f32_16x16x32_bf16 v[100:103], a[32:35], a[4:7], v[100:103]
    ds_read_b64_tr_b16 a[44:45], v7 offset:7264
    s_waitcnt lgkmcnt(9)
    v_mfma_f32_16x16x32_bf16 v[100:103], a[80:83], a[52:55], v[100:103]
    ds_read_b64_tr_b16 a[46:47], v7 offset:10848
    v_mfma_f32_16x16x32_bf16 v[36:39], a[16:19], a[4:7], v[36:39]
    ds_read_b64_tr_b16 a[92:93], v7 offset:21600
    v_mfma_f32_16x16x32_bf16 v[36:39], a[64:67], a[52:55], v[36:39]
    ds_read_b64_tr_b16 a[94:95], v7 offset:25184
    s_waitcnt lgkmcnt(11)
    v_mfma_f32_16x16x32_bf16 v[40:43], a[16:19], a[8:11], v[40:43]
    s_waitcnt lgkmcnt(10)
    v_mfma_f32_16x16x32_bf16 v[40:43], a[64:67], a[56:59], v[40:43]
    v_mfma_f32_16x16x32_bf16 v[104:107], a[32:35], a[8:11], v[104:107]
    v_mfma_f32_16x16x32_bf16 v[104:107], a[80:83], a[56:59], v[104:107]
    s_waitcnt lgkmcnt(9)
    v_mfma_f32_16x16x32_bf16 v[108:111], a[32:35], a[12:15], v[108:111]
    s_waitcnt lgkmcnt(8)
    v_mfma_f32_16x16x32_bf16 v[108:111], a[80:83], a[60:63], v[108:111]
    v_add_u32 v6, s37, v6
    v_add_u32 v7, s19, v7
    v_mfma_f32_16x16x32_bf16 v[44:47], a[16:19], a[12:15], v[44:47]
    v_mfma_f32_16x16x32_bf16 v[44:47], a[64:67], a[60:63], v[44:47]
    s_waitcnt lgkmcnt(0)
    s_barrier
    s_setprio 2
    s_bitcmp1_b32 s33, 1
    s_cbranch_scc1 Lxh_123
    s_bitcmp1_b32 s33, 0
    s_cbranch_scc1 Lx1_122
    v_mfma_f32_16x16x32_bf16 v[8:11], a[16:19], v[16:19], v[8:11]
    v_mfma_f32_16x16x32_bf16 v[8:11], a[64:67], v[16:19], v[8:11]
    v_mfma_f32_16x16x32_bf16 v[12:15], a[32:35], v[16:19], v[12:15]
    v_mfma_f32_16x16x32_bf16 v[12:15], a[80:83], v[16:19], v[12:15]
    s_branch Lxe_125
Lx1_122:
    v_mfma_f32_16x16x32_bf16 v[8:11], a[20:23], v[16:19], v[8:11]
    v_mfma_f32_16x16x32_bf16 v[8:11], a[68:71], v[16:19], v[8:11]
    v_mfma_f32_16x16x32_bf16 v[12:15], a[36:39], v[16:19], v[12:15]
    v_mfma_f32_16x16x32_bf16 v[12:15], a[84:87], v[16:19], v[12:15]
    s_branch Lxe_125
Lxh_123:
    s_bitcmp1_b32 s33, 0
    s_cbranch_scc1 Lx3_124
    v_mfma_f32_16x16x32_bf16 v[8:11], a[24:27], v[16:19], v[8:11]
    v_mfma_f32_16x16x32_bf16 v[8:11], a[72:75], v[16:19], v[8:11]
    v_mfma_f32_16x16x32_bf16 v[12:15], a[40:43], v[16:19], v[12:15]
    v_mfma_f32_16x16x32_bf16 v[12:15], a[88:91], v[16:19], v[12:15]
    s_branch Lxe_125
Lx3_124:
    v_mfma_f32_16x16x32_bf16 v[8:11], a[28:31], v[16:19], v[8:11]
    v_mfma_f32_16x16x32_bf16 v[8:11], a[76:79], v[16:19], v[8:11]
    v_mfma_f32_16x16x32_bf16 v[12:15], a[44:47], v[16:19], v[12:15]
    v_mfma_f32_16x16x32_bf16 v[12:15], a[92:95], v[16:19], v[12:15]
Lxe_125:
    s_setprio 0
    ds_read_b128 v[20:23], v30
    ds_read_b128 v[2:5], v31
    s_nop 7
    s_waitcnt lgkmcnt(1)
    v_add_f32 v8, v8, v20
    v_add_f32 v9, v9, v21
    v_add_f32 v10, v10, v22
    v_add_f32 v11, v11, v23
    s_waitcnt lgkmcnt(0)
    v_add_f32 v12, v12, v2
    v_add_f32 v13, v13, v3
    v_add_f32 v14, v14, v4
    v_add_f32 v15, v15, v5
    s_mov_b32 exec_lo, 0x10001
    s_mov_b32 exec_hi, 0x10001
    ds_write_b128 v30, v[8:11]
    ds_write_b128 v31, v[12:15]
    s_mov_b64 exec, -1
    v_mfma_f32_16x16x32_bf16 v[60:63], a[20:23], a[12:15], v[60:63]
    v_mfma_f32_16x16x32_bf16 v[60:63], a[68:71], a[60:63], v[60:63]
    v_mfma_f32_16x16x32_bf16 v[56:59], a[20:23], a[8:11], v[56:59]
    v_mfma_f32_16x16x32_bf16 v[56:59], a[68:71], a[56:59], v[56:59]
    v_mfma_f32_16x16x32_bf16 v[52:55], a[20:23], a[4:7], v[52:55]
    v_mfma_f32_16x16x32_bf16 v[52:55], a[68:71], a[52:55], v[52:55]
    v_mfma_f32_16x16x32_bf16 v[48:51], a[20:23], a[0:3], v[48:51]
    v_mfma_f32_16x16x32_bf16 v[48:51], a[68:71], a[48:51], v[48:51]
    v_mfma_f32_16x16x32_bf16 v[112:115], a[36:39], a[0:3], v[112:115]
    v_mfma_f32_16x16x32_bf16 v[112:115], a[84:87], a[48:51], v[112:115]
    v_mfma_f32_16x16x32_bf16 v[116:119], a[36:39], a[4:7], v[116:119]
    v_mfma_f32_16x16x32_bf16 v[116:119], a[84:87], a[52:55], v[116:119]
    v_mfma_f32_16x16x32_bf16 v[120:123], a[36:39], a[8:11], v[120:123]
    v_mfma_f32_16x16x32_bf16 v[120:123], a[84:87], a[56:59], v[120:123]
    v_mfma_f32_16x16x32_bf16 v[124:127], a[36:39], a[12:15], v[124:127]
    v_mfma_f32_16x16x32_bf16 v[124:127], a[84:87], a[60:63], v[124:127]
    v_mfma_f32_16x16x32_bf16 v[76:79], a[24:27], a[12:15], v[76:79]
    v_mfma_f32_16x16x32_bf16 v[76:79], a[72:75], a[60:63], v[76:79]
    v_mfma_f32_16x16x32_bf16 v[72:75], a[24:27], a[8:11], v[72:75]
    v_mfma_f32_16x16x32_bf16 v[72:75], a[72:75], a[56:59], v[72:75]
    v_mfma_f32_16x16x32_bf16 v[68:71], a[24:27], a[4:7], v[68:71]
    v_mfma_f32_16x16x32_bf16 v[68:71], a[72:75], a[52:55], v[68:71]
    v_mfma_f32_16x16x32_bf16 v[64:67], a[24:27], a[0:3], v[64:67]
    v_mfma_f32_16x16x32_bf16 v[64:67], a[72:75], a[48:51], v[64:67]
    v_mfma_f32_16x16x32_bf16 v[128:131], a[40:43], a[0:3], v[128:131]
    v_mfma_f32_16x16x32_bf16 v[128:131], a[88:91], a[48:51], v[128:131]
    v_mfma_f32_16x16x32_bf16 v[132:135], a[40:43], a[4:7], v[132:135]
    v_mfma_f32_16x16x32_bf16 v[132:135], a[88:91], a[52:55], v[132:135]
    v_mfma_f32_16x16x32_bf16 v[136:139], a[40:43], a[8:11], v[136:139]
    v_mfma_f32_16x16x32_bf16 v[136:139], a[88:91], a[56:59], v[136:139]
    v_mfma_f32_16x16x32_bf16 v[140:143], a[40:43], a[12:15], v[140:143]
    v_mfma_f32_16x16x32_bf16 v[140:143], a[88:91], a[60:63], v[140:143]
    v_mfma_f32_16x16x32_bf16 v[80:83], a[28:31], a[0:3], v[80:83]
    v_mfma_f32_16x16x32_bf16 v[80:83], a[76:79], a[48:51], v[80:83]
    v_mfma_f32_16x16x32_bf16 v[144:147], a[44:47], a[0:3], v[144:147]
    v_mfma_f32_16x16x32_bf16 v[144:147], a[92:95], a[48:51], v[144:147]
    v_mfma_f32_16x16x32_bf16 v[148:151], a[44:47], a[4:7], v[148:151]
    v_mfma_f32_16x16x32_bf16 v[148:151], a[92:95], a[52:55], v[148:151]
    v_mfma_f32_16x16x32_bf16 v[84:87], a[28:31], a[4:7], v[84:87]
    v_mfma_f32_16x16x32_bf16 v[84:87], a[76:79], a[52:55], v[84:87]
    v_mfma_f32_16x16x32_bf16 v[88:91], a[28:31], a[8:11], v[88:91]
    v_mfma_f32_16x16x32_bf16 v[88:91], a[76:79], a[56:59], v[88:91]
    v_mfma_f32_16x16x32_bf16 v[152:155], a[44:47], a[8:11], v[152:155]
    v_mfma_f32_16x16x32_bf16 v[152:155], a[92:95], a[56:59], v[152:155]
    v_mfma_f32_16x16x32_bf16 v[156:159], a[44:47], a[12:15], v[156:159]
    v_mfma_f32_16x16x32_bf16 v[156:159], a[92:95], a[60:63], v[156:159]
    v_mfma_f32_16x16x32_bf16 v[92:95], a[28:31], a[12:15], v[92:95]
    v_mfma_f32_16x16x32_bf16 v[92:95], a[76:79], a[60:63], v[92:95]
    s_waitcnt lgkmcnt(0)
    s_waitcnt vmcnt(0)
    s_barrier
    s_setprio 1
    s_add_u32 s12, s70, 16777216
    s_addc_u32 s13, s71, 0
    s_and_b32 s13, s13, 0xffff
    s_mov_b32 s14, 14680064
    s_mov_b32 s15, 0x20000
    s_mul_i32 s86, s81, 7
    s_add_u32 s86, s86, 1
    s_lshr_b32 s86, s86, 1
    s_lshl_b32 s86, s86, 17
    s_add_u32 s86, s86, s82
    s_add_u32 s87, s86, 131072
    s_add_u32 s88, s86, 262144
    s_cmp_eq_u32 s83, 0
    s_mov_b32 s89, 393216
    s_cselect_b32 s89, s89, 4294836736
    s_add_u32 s89, s89, s86
    s_mov_b32 s90, 3184710632
    s_mov_b32 s91, 3222493025
    v_lshrrev_b32 v18, 4, v0
    v_lshlrev_b32 v18, 4, v18
    v_add_u32 v18, 153600, v18
    v_and_b32 v20, 15, v0
    s_lshl_b32 s40, s33, 8
    s_add_u32 s40, s40, 153600
    v_lshl_add_u32 v20, v20, 2, s40
    ds_read_b32 v4, v20 offset:0
    ds_read_b32 v2, v20 offset:1024
    ds_read_b32 v8, v20 offset:64
    ds_read_b32 v6, v20 offset:1088
    ds_read_b32 v12, v20 offset:128
    ds_read_b32 v10, v20 offset:1152
    ds_read_b32 v16, v20 offset:192
    ds_read_b32 v14, v20 offset:1216
    s_waitcnt lgkmcnt(0)
    v_mul_f32 v3, v4, v4
    v_mul_f32 v5, v3, v4
    v_mul_f32 v5, s90, v5
    v_mul_f32 v4, s91, v4
    v_rcp_f32 v3, v3
    v_mul_f32 v7, v8, v8
    v_mul_f32 v9, v7, v8
    v_mul_f32 v9, s90, v9
    v_mul_f32 v8, s91, v8
    v_rcp_f32 v7, v7
    v_mul_f32 v11, v12, v12
    v_mul_f32 v13, v11, v12
    v_mul_f32 v13, s90, v13
    v_mul_f32 v12, s91, v12
    v_rcp_f32 v11, v11
    v_mul_f32 v15, v16, v16
    v_mul_f32 v17, v15, v16
    v_mul_f32 v17, s90, v17
    v_mul_f32 v16, s91, v16
    v_rcp_f32 v15, v15
    ds_read_b128 v[24:27], v18 offset:2048
    ds_read_b128 v[28:31], v18 offset:2496
    s_waitcnt lgkmcnt(0)
    v_pk_fma_f32 v[32:33], v[2:3], v[24:25], v[32:33] op_sel_hi:[0,1,1]
    v_pk_fma_f32 v[34:35], v[2:3], v[26:27], v[34:35] op_sel_hi:[0,1,1]
    v_pk_fma_f32 v[96:97], v[2:3], v[28:29], v[96:97] op_sel_hi:[0,1,1]
    v_pk_fma_f32 v[98:99], v[2:3], v[30:31], v[98:99] op_sel_hi:[0,1,1]
    v_pk_mul_f32 v[20:21], v[32:33], v[32:33]
    v_pk_mul_f32 v[22:23], v[34:35], v[34:35]
    v_pk_fma_f32 v[20:21], v[20:21], v[4:5], v[4:5] op_sel:[0,1,0] op_sel_hi:[1,1,0]
    v_pk_fma_f32 v[22:23], v[22:23], v[4:5], v[4:5] op_sel:[0,1,0] op_sel_hi:[1,1,0]
    v_pk_mul_f32 v[20:21], v[20:21], v[32:33]
    v_pk_mul_f32 v[22:23], v[22:23], v[34:35]
    v_exp_f32 v20, v20
    v_exp_f32 v21, v21
    v_exp_f32 v22, v22
    v_exp_f32 v23, v23
    v_pk_mul_f32 v[32:33], v[32:33], v[96:97]
    v_pk_mul_f32 v[34:35], v[34:35], v[98:99]
    v_pk_fma_f32 v[20:21], v[20:21], v[2:3], v[2:3] op_sel:[0,1,1] op_sel_hi:[1,1,1]
    v_pk_fma_f32 v[22:23], v[22:23], v[2:3], v[2:3] op_sel:[0,1,1] op_sel_hi:[1,1,1]
    v_rcp_f32 v20, v20
    v_rcp_f32 v21, v21
    v_rcp_f32 v22, v22
    v_rcp_f32 v23, v23
    s_nop 0
    v_pk_mul_f32 v[32:33], v[32:33], v[20:21]
    v_pk_mul_f32 v[34:35], v[34:35], v[22:23]
    v_cvt_pk_bf16_f32 v96, v32, v33
    v_cvt_pk_bf16_f32 v97, v34, v35
    v_pk_fma_f32 v[36:37], v[6:7], v[24:25], v[36:37] op_sel_hi:[0,1,1]
    v_pk_fma_f32 v[38:39], v[6:7], v[26:27], v[38:39] op_sel_hi:[0,1,1]
    v_pk_fma_f32 v[100:101], v[6:7], v[28:29], v[100:101] op_sel_hi:[0,1,1]
    v_pk_fma_f32 v[102:103], v[6:7], v[30:31], v[102:103] op_sel_hi:[0,1,1]
    v_pk_fma_f32 v[40:41], v[10:11], v[24:25], v[40:41] op_sel_hi:[0,1,1]
    v_pk_fma_f32 v[42:43], v[10:11], v[26:27], v[42:43] op_sel_hi:[0,1,1]
    v_pk_fma_f32 v[104:105], v[10:11], v[28:29], v[104:105] op_sel_hi:[0,1,1]
    v_pk_fma_f32 v[106:107], v[10:11], v[30:31], v[106:107] op_sel_hi:[0,1,1]
    v_pk_mul_f32 v[20:21], v[36:37], v[36:37]
    v_pk_mul_f32 v[22:23], v[38:39], v[38:39]
    v_pk_mul_f32 v[32:33], v[40:41], v[40:41]
    v_pk_mul_f32 v[34:35], v[42:43], v[42:43]
    v_pk_fma_f32 v[20:21], v[20:21], v[8:9], v[8:9] op_sel:[0,1,0] op_sel_hi:[1,1,0]
    v_pk_fma_f32 v[22:23], v[22:23], v[8:9], v[8:9] op_sel:[0,1,0] op_sel_hi:[1,1,0]
    v_pk_fma_f32 v[32:33], v[32:33], v[12:13], v[12:13] op_sel:[0,1,0] op_sel_hi:[1,1,0]
    v_pk_fma_f32 v[34:35], v[34:35], v[12:13], v[12:13] op_sel:[0,1,0] op_sel_hi:[1,1,0]
    v_pk_mul_f32 v[20:21], v[20:21], v[36:37]
    v_pk_mul_f32 v[22:23], v[22:23], v[38:39]
    v_pk_mul_f32 v[32:33], v[32:33], v[40:41]
    v_pk_mul_f32 v[34:35], v[34:35], v[42:43]
    v_exp_f32 v20, v20
    v_exp_f32 v21, v21
    v_exp_f32 v22, v22
    v_exp_f32 v23, v23
    v_pk_mul_f32 v[36:37], v[36:37], v[100:101]
    v_pk_mul_f32 v[38:39], v[38:39], v[102:103]
    v_exp_f32 v32, v32
    v_exp_f32 v33, v33
    v_exp_f32 v34, v34
    v_exp_f32 v35, v35
    v_pk_mul_f32 v[40:41], v[40:41], v[104:105]
    v_pk_mul_f32 v[42:43], v[42:43], v[106:107]
    v_pk_fma_f32 v[20:21], v[20:21], v[6:7], v[6:7] op_sel:[0,1,1] op_sel_hi:[1,1,1]
    v_pk_fma_f32 v[22:23], v[22:23], v[6:7], v[6:7] op_sel:[0,1,1] op_sel_hi:[1,1,1]
    v_pk_fma_f32 v[32:33], v[32:33], v[10:11], v[10:11] op_sel:[0,1,1] op_sel_hi:[1,1,1]
    v_pk_fma_f32 v[34:35], v[34:35], v[10:11], v[10:11] op_sel:[0,1,1] op_sel_hi:[1,1,1]
    v_rcp_f32 v20, v20
    v_rcp_f32 v21, v21
    v_rcp_f32 v22, v22
    v_rcp_f32 v23, v23
    v_rcp_f32 v32, v32
    v_rcp_f32 v33, v33
    v_rcp_f32 v34, v34
    v_rcp_f32 v35, v35
    v_pk_mul_f32 v[36:37], v[36:37], v[20:21]
    v_pk_mul_f32 v[38:39], v[38:39], v[22:23]
    v_pk_mul_f32 v[40:41], v[40:41], v[32:33]
    v_pk_mul_f32 v[42:43], v[42:43], v[34:35]
    v_cvt_pk_bf16_f32 v100, v36, v37
    v_cvt_pk_bf16_f32 v101, v38, v39
    v_cvt_pk_bf16_f32 v104, v40, v41
    v_cvt_pk_bf16_f32 v105, v42, v43
    v_pk_fma_f32 v[44:45], v[14:15], v[24:25], v[44:45] op_sel_hi:[0,1,1]
    v_pk_fma_f32 v[46:47], v[14:15], v[26:27], v[46:47] op_sel_hi:[0,1,1]
    v_pk_fma_f32 v[108:109], v[14:15], v[28:29], v[108:109] op_sel_hi:[0,1,1]
    v_pk_fma_f32 v[110:111], v[14:15], v[30:31], v[110:111] op_sel_hi:[0,1,1]
    v_pk_mul_f32 v[20:21], v[44:45], v[44:45]
    v_pk_mul_f32 v[22:23], v[46:47], v[46:47]
    v_pk_fma_f32 v[20:21], v[20:21], v[16:17], v[16:17] op_sel:[0,1,0] op_sel_hi:[1,1,0]
    v_pk_fma_f32 v[22:23], v[22:23], v[16:17], v[16:17] op_sel:[0,1,0] op_sel_hi:[1,1,0]
    v_pk_mul_f32 v[20:21], v[20:21], v[44:45]
    v_pk_mul_f32 v[22:23], v[22:23], v[46:47]
    v_exp_f32 v20, v20
    v_exp_f32 v21, v21
    v_exp_f32 v22, v22
    v_exp_f32 v23, v23
    v_pk_mul_f32 v[44:45], v[44:45], v[108:109]
    v_pk_mul_f32 v[46:47], v[46:47], v[110:111]
    v_pk_fma_f32 v[20:21], v[20:21], v[14:15], v[14:15] op_sel:[0,1,1] op_sel_hi:[1,1,1]
    v_pk_fma_f32 v[22:23], v[22:23], v[14:15], v[14:15] op_sel:[0,1,1] op_sel_hi:[1,1,1]
    v_rcp_f32 v20, v20
    v_rcp_f32 v21, v21
    v_rcp_f32 v22, v22
    v_rcp_f32 v23, v23
    s_nop 0
    v_pk_mul_f32 v[44:45], v[44:45], v[20:21]
    v_pk_mul_f32 v[46:47], v[46:47], v[22:23]
    v_cvt_pk_bf16_f32 v108, v44, v45
    v_cvt_pk_bf16_f32 v109, v46, v47
    ds_read_b128 v[24:27], v18 offset:2112
    ds_read_b128 v[28:31], v18 offset:2560
    s_waitcnt lgkmcnt(0)
    v_pk_fma_f32 v[48:49], v[2:3], v[24:25], v[48:49] op_sel_hi:[0,1,1]
    v_pk_fma_f32 v[50:51], v[2:3], v[26:27], v[50:51] op_sel_hi:[0,1,1]
    v_pk_fma_f32 v[112:113], v[2:3], v[28:29], v[112:113] op_sel_hi:[0,1,1]
    v_pk_fma_f32 v[114:115], v[2:3], v[30:31], v[114:115] op_sel_hi:[0,1,1]
    v_pk_fma_f32 v[52:53], v[6:7], v[24:25], v[52:53] op_sel_hi:[0,1,1]
    v_pk_fma_f32 v[54:55], v[6:7], v[26:27], v[54:55] op_sel_hi:[0,1,1]
    v_pk_fma_f32 v[116:117], v[6:7], v[28:29], v[116:117] op_sel_hi:[0,1,1]
    v_pk_fma_f32 v[118:119], v[6:7], v[30:31], v[118:119] op_sel_hi:[0,1,1]
    v_pk_mul_f32 v[20:21], v[48:49], v[48:49]
    v_pk_mul_f32 v[22:23], v[50:51], v[50:51]
    v_pk_mul_f32 v[32:33], v[52:53], v[52:53]
    v_pk_mul_f32 v[34:35], v[54:55], v[54:55]
    v_pk_fma_f32 v[20:21], v[20:21], v[4:5], v[4:5] op_sel:[0,1,0] op_sel_hi:[1,1,0]
    v_pk_fma_f32 v[22:23], v[22:23], v[4:5], v[4:5] op_sel:[0,1,0] op_sel_hi:[1,1,0]
    v_pk_fma_f32 v[32:33], v[32:33], v[8:9], v[8:9] op_sel:[0,1,0] op_sel_hi:[1,1,0]
    v_pk_fma_f32 v[34:35], v[34:35], v[8:9], v[8:9] op_sel:[0,1,0] op_sel_hi:[1,1,0]
    v_pk_mul_f32 v[20:21], v[20:21], v[48:49]
    v_pk_mul_f32 v[22:23], v[22:23], v[50:51]
    v_pk_mul_f32 v[32:33], v[32:33], v[52:53]
    v_pk_mul_f32 v[34:35], v[34:35], v[54:55]
    v_exp_f32 v20, v20
    v_exp_f32 v21, v21
    v_exp_f32 v22, v22
    v_exp_f32 v23, v23
    v_pk_mul_f32 v[48:49], v[48:49], v[112:113]
    v_pk_mul_f32 v[50:51], v[50:51], v[114:115]
    v_exp_f32 v32, v32
    v_exp_f32 v33, v33
    v_exp_f32 v34, v34
    v_exp_f32 v35, v35
    v_pk_mul_f32 v[52:53], v[52:53], v[116:117]
    v_pk_mul_f32 v[54:55], v[54:55], v[118:119]
    v_pk_fma_f32 v[20:21], v[20:21], v[2:3], v[2:3] op_sel:[0,1,1] op_sel_hi:[1,1,1]
    v_pk_fma_f32 v[22:23], v[22:23], v[2:3], v[2:3] op_sel:[0,1,1] op_sel_hi:[1,1,1]
    v_pk_fma_f32 v[32:33], v[32:33], v[6:7], v[6:7] op_sel:[0,1,1] op_sel_hi:[1,1,1]
    v_pk_fma_f32 v[34:35], v[34:35], v[6:7], v[6:7] op_sel:[0,1,1] op_sel_hi:[1,1,1]
    v_rcp_f32 v20, v20
    v_rcp_f32 v21, v21
    v_rcp_f32 v22, v22
    v_rcp_f32 v23, v23
    v_rcp_f32 v32, v32
    v_rcp_f32 v33, v33
    v_rcp_f32 v34, v34
    v_rcp_f32 v35, v35
    v_pk_mul_f32 v[48:49], v[48:49], v[20:21]
    v_pk_mul_f32 v[50:51], v[50:51], v[22:23]
    v_pk_mul_f32 v[52:53], v[52:53], v[32:33]
    v_pk_mul_f32 v[54:55], v[54:55], v[34:35]
    v_cvt_pk_bf16_f32 v98, v48, v49
    v_cvt_pk_bf16_f32 v99, v50, v51
    v_cvt_pk_bf16_f32 v102, v52, v53
    v_cvt_pk_bf16_f32 v103, v54, v55
    buffer_store_dwordx4 v[96:99], v1, s[12:15], s86 offen offset:0 sc1
    buffer_store_dwordx4 v[100:103], v1, s[12:15], s86 offen offset:1024 sc1
    v_pk_fma_f32 v[56:57], v[10:11], v[24:25], v[56:57] op_sel_hi:[0,1,1]
    v_pk_fma_f32 v[58:59], v[10:11], v[26:27], v[58:59] op_sel_hi:[0,1,1]
    v_pk_fma_f32 v[120:121], v[10:11], v[28:29], v[120:121] op_sel_hi:[0,1,1]
    v_pk_fma_f32 v[122:123], v[10:11], v[30:31], v[122:123] op_sel_hi:[0,1,1]
    v_pk_fma_f32 v[60:61], v[14:15], v[24:25], v[60:61] op_sel_hi:[0,1,1]
    v_pk_fma_f32 v[62:63], v[14:15], v[26:27], v[62:63] op_sel_hi:[0,1,1]
    v_pk_fma_f32 v[124:125], v[14:15], v[28:29], v[124:125] op_sel_hi:[0,1,1]
    v_pk_fma_f32 v[126:127], v[14:15], v[30:31], v[126:127] op_sel_hi:[0,1,1]
    v_pk_mul_f32 v[20:21], v[56:57], v[56:57]
    v_pk_mul_f32 v[22:23], v[58:59], v[58:59]
    v_pk_mul_f32 v[32:33], v[60:61], v[60:61]
    v_pk_mul_f32 v[34:35], v[62:63], v[62:63]
    v_pk_fma_f32 v[20:21], v[20:21], v[12:13], v[12:13] op_sel:[0,1,0] op_sel_hi:[1,1,0]
    v_pk_fma_f32 v[22:23], v[22:23], v[12:13], v[12:13] op_sel:[0,1,0] op_sel_hi:[1,1,0]
    v_pk_fma_f32 v[32:33], v[32:33], v[16:17], v[16:17] op_sel:[0,1,0] op_sel_hi:[1,1,0]
    v_pk_fma_f32 v[34:35], v[34:35], v[16:17], v[16:17] op_sel:[0,1,0] op_sel_hi:[1,1,0]
    v_pk_mul_f32 v[20:21], v[20:21], v[56:57]
    v_pk_mul_f32 v[22:23], v[22:23], v[58:59]
    v_pk_mul_f32 v[32:33], v[32:33], v[60:61]
    v_pk_mul_f32 v[34:35], v[34:35], v[62:63]
    v_exp_f32 v20, v20
    v_exp_f32 v21, v21
    v_exp_f32 v22, v22
    v_exp_f32 v23, v23
    v_pk_mul_f32 v[56:57], v[56:57], v[120:121]
    v_pk_mul_f32 v[58:59], v[58:59], v[122:123]
    v_exp_f32 v32, v32
    v_exp_f32 v33, v33
    v_exp_f32 v34, v34
    v_exp_f32 v35, v35
    v_pk_mul_f32 v[60:61], v[60:61], v[124:125]
    v_pk_mul_f32 v[62:63], v[62:63], v[126:127]
    v_pk_fma_f32 v[20:21], v[20:21], v[10:11], v[10:11] op_sel:[0,1,1] op_sel_hi:[1,1,1]
    v_pk_fma_f32 v[22:23], v[22:23], v[10:11], v[10:11] op_sel:[0,1,1] op_sel_hi:[1,1,1]
    v_pk_fma_f32 v[32:33], v[32:33], v[14:15], v[14:15] op_sel:[0,1,1] op_sel_hi:[1,1,1]
    v_pk_fma_f32 v[34:35], v[34:35], v[14:15], v[14:15] op_sel:[0,1,1] op_sel_hi:[1,1,1]
    v_rcp_f32 v20, v20
    v_rcp_f32 v21, v21
    v_rcp_f32 v22, v22
    v_rcp_f32 v23, v23
    v_rcp_f32 v32, v32
    v_rcp_f32 v33, v33
    v_rcp_f32 v34, v34
    v_rcp_f32 v35, v35
    v_pk_mul_f32 v[56:57], v[56:57], v[20:21]
    v_pk_mul_f32 v[58:59], v[58:59], v[22:23]
    v_pk_mul_f32 v[60:61], v[60:61], v[32:33]
    v_pk_mul_f32 v[62:63], v[62:63], v[34:35]
    v_cvt_pk_bf16_f32 v106, v56, v57
    v_cvt_pk_bf16_f32 v107, v58, v59
    v_cvt_pk_bf16_f32 v110, v60, v61
    v_cvt_pk_bf16_f32 v111, v62, v63
    buffer_store_dwordx4 v[104:107], v1, s[12:15], s86 offen offset:2048 sc1
    buffer_store_dwordx4 v[108:111], v1, s[12:15], s86 offen offset:3072 sc1
    ds_read_b128 v[24:27], v18 offset:2176
    ds_read_b128 v[28:31], v18 offset:2624
    s_waitcnt lgkmcnt(0)
    v_pk_fma_f32 v[64:65], v[2:3], v[24:25], v[64:65] op_sel_hi:[0,1,1]
    v_pk_fma_f32 v[66:67], v[2:3], v[26:27], v[66:67] op_sel_hi:[0,1,1]
    v_pk_fma_f32 v[128:129], v[2:3], v[28:29], v[128:129] op_sel_hi:[0,1,1]
    v_pk_fma_f32 v[130:131], v[2:3], v[30:31], v[130:131] op_sel_hi:[0,1,1]
    v_pk_fma_f32 v[68:69], v[6:7], v[24:25], v[68:69] op_sel_hi:[0,1,1]
    v_pk_fma_f32 v[70:71], v[6:7], v[26:27], v[70:71] op_sel_hi:[0,1,1]
    v_pk_fma_f32 v[132:133], v[6:7], v[28:29], v[132:133] op_sel_hi:[0,1,1]
    v_pk_fma_f32 v[134:135], v[6:7], v[30:31], v[134:135] op_sel_hi:[0,1,1]
    v_pk_mul_f32 v[20:21], v[64:65], v[64:65]
    v_pk_mul_f32 v[22:23], v[66:67], v[66:67]
    v_pk_mul_f32 v[32:33], v[68:69], v[68:69]
    v_pk_mul_f32 v[34:35], v[70:71], v[70:71]
    v_pk_fma_f32 v[20:21], v[20:21], v[4:5], v[4:5] op_sel:[0,1,0] op_sel_hi:[1,1,0]
    v_pk_fma_f32 v[22:23], v[22:23], v[4:5], v[4:5] op_sel:[0,1,0] op_sel_hi:[1,1,0]
    v_pk_fma_f32 v[32:33], v[32:33], v[8:9], v[8:9] op_sel:[0,1,0] op_sel_hi:[1,1,0]
    v_pk_fma_f32 v[34:35], v[34:35], v[8:9], v[8:9] op_sel:[0,1,0] op_sel_hi:[1,1,0]
    v_pk_mul_f32 v[20:21], v[20:21], v[64:65]
    v_pk_mul_f32 v[22:23], v[22:23], v[66:67]
    v_pk_mul_f32 v[32:33], v[32:33], v[68:69]
    v_pk_mul_f32 v[34:35], v[34:35], v[70:71]
    v_exp_f32 v20, v20
    v_exp_f32 v21, v21
    v_exp_f32 v22, v22
    v_exp_f32 v23, v23
    v_pk_mul_f32 v[64:65], v[64:65], v[128:129]
    v_pk_mul_f32 v[66:67], v[66:67], v[130:131]
    v_exp_f32 v32, v32
    v_exp_f32 v33, v33
    v_exp_f32 v34, v34
    v_exp_f32 v35, v35
    v_pk_mul_f32 v[68:69], v[68:69], v[132:133]
    v_pk_mul_f32 v[70:71], v[70:71], v[134:135]
    v_pk_fma_f32 v[20:21], v[20:21], v[2:3], v[2:3] op_sel:[0,1,1] op_sel_hi:[1,1,1]
    v_pk_fma_f32 v[22:23], v[22:23], v[2:3], v[2:3] op_sel:[0,1,1] op_sel_hi:[1,1,1]
    v_pk_fma_f32 v[32:33], v[32:33], v[6:7], v[6:7] op_sel:[0,1,1] op_sel_hi:[1,1,1]
    v_pk_fma_f32 v[34:35], v[34:35], v[6:7], v[6:7] op_sel:[0,1,1] op_sel_hi:[1,1,1]
    v_rcp_f32 v20, v20
    v_rcp_f32 v21, v21
    v_rcp_f32 v22, v22
    v_rcp_f32 v23, v23
    v_rcp_f32 v32, v32
    v_rcp_f32 v33, v33
    v_rcp_f32 v34, v34
    v_rcp_f32 v35, v35
    v_pk_mul_f32 v[64:65], v[64:65], v[20:21]
    v_pk_mul_f32 v[66:67], v[66:67], v[22:23]
    v_pk_mul_f32 v[68:69], v[68:69], v[32:33]
    v_pk_mul_f32 v[70:71], v[70:71], v[34:35]
    v_cvt_pk_bf16_f32 v128, v64, v65
    v_cvt_pk_bf16_f32 v129, v66, v67
    v_cvt_pk_bf16_f32 v132, v68, v69
    v_cvt_pk_bf16_f32 v133, v70, v71
    v_pk_fma_f32 v[72:73], v[10:11], v[24:25], v[72:73] op_sel_hi:[0,1,1]
    v_pk_fma_f32 v[74:75], v[10:11], v[26:27], v[74:75] op_sel_hi:[0,1,1]
    v_pk_fma_f32 v[136:137], v[10:11], v[28:29], v[136:137] op_sel_hi:[0,1,1]
    v_pk_fma_f32 v[138:139], v[10:11], v[30:31], v[138:139] op_sel_hi:[0,1,1]
    v_pk_fma_f32 v[76:77], v[14:15], v[24:25], v[76:77] op_sel_hi:[0,1,1]
    v_pk_fma_f32 v[78:79], v[14:15], v[26:27], v[78:79] op_sel_hi:[0,1,1]
    v_pk_fma_f32 v[140:141], v[14:15], v[28:29], v[140:141] op_sel_hi:[0,1,1]
    v_pk_fma_f32 v[142:143], v[14:15], v[30:31], v[142:143] op_sel_hi:[0,1,1]
    v_pk_mul_f32 v[20:21], v[72:73], v[72:73]
    v_pk_mul_f32 v[22:23], v[74:75], v[74:75]
    v_pk_mul_f32 v[32:33], v[76:77], v[76:77]
    v_pk_mul_f32 v[34:35], v[78:79], v[78:79]
    v_pk_fma_f32 v[20:21], v[20:21], v[12:13], v[12:13] op_sel:[0,1,0] op_sel_hi:[1,1,0]
    v_pk_fma_f32 v[22:23], v[22:23], v[12:13], v[12:13] op_sel:[0,1,0] op_sel_hi:[1,1,0]
    v_pk_fma_f32 v[32:33], v[32:33], v[16:17], v[16:17] op_sel:[0,1,0] op_sel_hi:[1,1,0]
    v_pk_fma_f32 v[34:35], v[34:35], v[16:17], v[16:17] op_sel:[0,1,0] op_sel_hi:[1,1,0]
    v_pk_mul_f32 v[20:21], v[20:21], v[72:73]
    v_pk_mul_f32 v[22:23], v[22:23], v[74:75]
    v_pk_mul_f32 v[32:33], v[32:33], v[76:77]
    v_pk_mul_f32 v[34:35], v[34:35], v[78:79]
    v_exp_f32 v20, v20
    v_exp_f32 v21, v21
    v_exp_f32 v22, v22
    v_exp_f32 v23, v23
    v_pk_mul_f32 v[72:73], v[72:73], v[136:137]
    v_pk_mul_f32 v[74:75], v[74:75], v[138:139]
    v_exp_f32 v32, v32
    v_exp_f32 v33, v33
    v_exp_f32 v34, v34
    v_exp_f32 v35, v35
    v_pk_mul_f32 v[76:77], v[76:77], v[140:141]
    v_pk_mul_f32 v[78:79], v[78:79], v[142:143]
    v_pk_fma_f32 v[20:21], v[20:21], v[10:11], v[10:11] op_sel:[0,1,1] op_sel_hi:[1,1,1]
    v_pk_fma_f32 v[22:23], v[22:23], v[10:11], v[10:11] op_sel:[0,1,1] op_sel_hi:[1,1,1]
    v_pk_fma_f32 v[32:33], v[32:33], v[14:15], v[14:15] op_sel:[0,1,1] op_sel_hi:[1,1,1]
    v_pk_fma_f32 v[34:35], v[34:35], v[14:15], v[14:15] op_sel:[0,1,1] op_sel_hi:[1,1,1]
    v_rcp_f32 v20, v20
    v_rcp_f32 v21, v21
    v_rcp_f32 v22, v22
    v_rcp_f32 v23, v23
    v_rcp_f32 v32, v32
    v_rcp_f32 v33, v33
    v_rcp_f32 v34, v34
    v_rcp_f32 v35, v35
    v_pk_mul_f32 v[72:73], v[72:73], v[20:21]
    v_pk_mul_f32 v[74:75], v[74:75], v[22:23]
    v_pk_mul_f32 v[76:77], v[76:77], v[32:33]
    v_pk_mul_f32 v[78:79], v[78:79], v[34:35]
    v_cvt_pk_bf16_f32 v136, v72, v73
    v_cvt_pk_bf16_f32 v137, v74, v75
    v_cvt_pk_bf16_f32 v140, v76, v77
    v_cvt_pk_bf16_f32 v141, v78, v79
    ds_read_b128 v[24:27], v18 offset:2240
    ds_read_b128 v[28:31], v18 offset:2688
    s_waitcnt lgkmcnt(0)
    v_pk_fma_f32 v[80:81], v[2:3], v[24:25], v[80:81] op_sel_hi:[0,1,1]
    v_pk_fma_f32 v[82:83], v[2:3], v[26:27], v[82:83] op_sel_hi:[0,1,1]
    v_pk_fma_f32 v[144:145], v[2:3], v[28:29], v[144:145] op_sel_hi:[0,1,1]
    v_pk_fma_f32 v[146:147], v[2:3], v[30:31], v[146:147] op_sel_hi:[0,1,1]
    v_pk_fma_f32 v[84:85], v[6:7], v[24:25], v[84:85] op_sel_hi:[0,1,1]
    v_pk_fma_f32 v[86:87], v[6:7], v[26:27], v[86:87] op_sel_hi:[0,1,1]
    v_pk_fma_f32 v[148:149], v[6:7], v[28:29], v[148:149] op_sel_hi:[0,1,1]
    v_pk_fma_f32 v[150:151], v[6:7], v[30:31], v[150:151] op_sel_hi:[0,1,1]
    v_pk_mul_f32 v[20:21], v[80:81], v[80:81]
    v_pk_mul_f32 v[22:23], v[82:83], v[82:83]
    v_pk_mul_f32 v[32:33], v[84:85], v[84:85]
    v_pk_mul_f32 v[34:35], v[86:87], v[86:87]
    v_pk_fma_f32 v[20:21], v[20:21], v[4:5], v[4:5] op_sel:[0,1,0] op_sel_hi:[1,1,0]
    v_pk_fma_f32 v[22:23], v[22:23], v[4:5], v[4:5] op_sel:[0,1,0] op_sel_hi:[1,1,0]
    v_pk_fma_f32 v[32:33], v[32:33], v[8:9], v[8:9] op_sel:[0,1,0] op_sel_hi:[1,1,0]
    v_pk_fma_f32 v[34:35], v[34:35], v[8:9], v[8:9] op_sel:[0,1,0] op_sel_hi:[1,1,0]
    v_pk_mul_f32 v[20:21], v[20:21], v[80:81]
    v_pk_mul_f32 v[22:23], v[22:23], v[82:83]
    v_pk_mul_f32 v[32:33], v[32:33], v[84:85]
    v_pk_mul_f32 v[34:35], v[34:35], v[86:87]
    v_exp_f32 v20, v20
    v_exp_f32 v21, v21
    v_exp_f32 v22, v22
    v_exp_f32 v23, v23
    v_pk_mul_f32 v[80:81], v[80:81], v[144:145]
    v_pk_mul_f32 v[82:83], v[82:83], v[146:147]
    v_exp_f32 v32, v32
    v_exp_f32 v33, v33
    v_exp_f32 v34, v34
    v_exp_f32 v35, v35
    v_pk_mul_f32 v[84:85], v[84:85], v[148:149]
    v_pk_mul_f32 v[86:87], v[86:87], v[150:151]
    v_pk_fma_f32 v[20:21], v[20:21], v[2:3], v[2:3] op_sel:[0,1,1] op_sel_hi:[1,1,1]
    v_pk_fma_f32 v[22:23], v[22:23], v[2:3], v[2:3] op_sel:[0,1,1] op_sel_hi:[1,1,1]
    v_pk_fma_f32 v[32:33], v[32:33], v[6:7], v[6:7] op_sel:[0,1,1] op_sel_hi:[1,1,1]
    v_pk_fma_f32 v[34:35], v[34:35], v[6:7], v[6:7] op_sel:[0,1,1] op_sel_hi:[1,1,1]
    v_rcp_f32 v20, v20
    v_rcp_f32 v21, v21
    v_rcp_f32 v22, v22
    v_rcp_f32 v23, v23
    v_rcp_f32 v32, v32
    v_rcp_f32 v33, v33
    v_rcp_f32 v34, v34
    v_rcp_f32 v35, v35
    v_pk_mul_f32 v[80:81], v[80:81], v[20:21]
    v_pk_mul_f32 v[82:83], v[82:83], v[22:23]
    v_pk_mul_f32 v[84:85], v[84:85], v[32:33]
    v_pk_mul_f32 v[86:87], v[86:87], v[34:35]
    v_cvt_pk_bf16_f32 v130, v80, v81
    v_cvt_pk_bf16_f32 v131, v82, v83
    v_cvt_pk_bf16_f32 v134, v84, v85
    v_cvt_pk_bf16_f32 v135, v86, v87
    buffer_store_dwordx4 v[128:131], v1, s[12:15], s87 offen offset:0 sc1
    buffer_store_dwordx4 v[132:135], v1, s[12:15], s87 offen offset:1024 sc1
    v_pk_fma_f32 v[88:89], v[10:11], v[24:25], v[88:89] op_sel_hi:[0,1,1]
    v_pk_fma_f32 v[90:91], v[10:11], v[26:27], v[90:91] op_sel_hi:[0,1,1]
    v_pk_fma_f32 v[152:153], v[10:11], v[28:29], v[152:153] op_sel_hi:[0,1,1]
    v_pk_fma_f32 v[154:155], v[10:11], v[30:31], v[154:155] op_sel_hi:[0,1,1]
    v_pk_fma_f32 v[92:93], v[14:15], v[24:25], v[92:93] op_sel_hi:[0,1,1]
    v_pk_fma_f32 v[94:95], v[14:15], v[26:27], v[94:95] op_sel_hi:[0,1,1]
    v_pk_fma_f32 v[156:157], v[14:15], v[28:29], v[156:157] op_sel_hi:[0,1,1]
    v_pk_fma_f32 v[158:159], v[14:15], v[30:31], v[158:159] op_sel_hi:[0,1,1]
    v_pk_mul_f32 v[20:21], v[88:89], v[88:89]
    v_pk_mul_f32 v[22:23], v[90:91], v[90:91]
    v_pk_mul_f32 v[32:33], v[92:93], v[92:93]
    v_pk_mul_f32 v[34:35], v[94:95], v[94:95]
    v_pk_fma_f32 v[20:21], v[20:21], v[12:13], v[12:13] op_sel:[0,1,0] op_sel_hi:[1,1,0]
    v_pk_fma_f32 v[22:23], v[22:23], v[12:13], v[12:13] op_sel:[0,1,0] op_sel_hi:[1,1,0]
    v_pk_fma_f32 v[32:33], v[32:33], v[16:17], v[16:17] op_sel:[0,1,0] op_sel_hi:[1,1,0]
    v_pk_fma_f32 v[34:35], v[34:35], v[16:17], v[16:17] op_sel:[0,1,0] op_sel_hi:[1,1,0]
    v_pk_mul_f32 v[20:21], v[20:21], v[88:89]
    v_pk_mul_f32 v[22:23], v[22:23], v[90:91]
    v_pk_mul_f32 v[32:33], v[32:33], v[92:93]
    v_pk_mul_f32 v[34:35], v[34:35], v[94:95]
    v_exp_f32 v20, v20
    v_exp_f32 v21, v21
    v_exp_f32 v22, v22
    v_exp_f32 v23, v23
    v_pk_mul_f32 v[88:89], v[88:89], v[152:153]
    v_pk_mul_f32 v[90:91], v[90:91], v[154:155]
    v_exp_f32 v32, v32
    v_exp_f32 v33, v33
    v_exp_f32 v34, v34
    v_exp_f32 v35, v35
    v_pk_mul_f32 v[92:93], v[92:93], v[156:157]
    v_pk_mul_f32 v[94:95], v[94:95], v[158:159]
    v_pk_fma_f32 v[20:21], v[20:21], v[10:11], v[10:11] op_sel:[0,1,1] op_sel_hi:[1,1,1]
    v_pk_fma_f32 v[22:23], v[22:23], v[10:11], v[10:11] op_sel:[0,1,1] op_sel_hi:[1,1,1]
    v_pk_fma_f32 v[32:33], v[32:33], v[14:15], v[14:15] op_sel:[0,1,1] op_sel_hi:[1,1,1]
    v_pk_fma_f32 v[34:35], v[34:35], v[14:15], v[14:15] op_sel:[0,1,1] op_sel_hi:[1,1,1]
    v_rcp_f32 v20, v20
    v_rcp_f32 v21, v21
    v_rcp_f32 v22, v22
    v_rcp_f32 v23, v23
    v_rcp_f32 v32, v32
    v_rcp_f32 v33, v33
    v_rcp_f32 v34, v34
    v_rcp_f32 v35, v35
    v_pk_mul_f32 v[88:89], v[88:89], v[20:21]
    v_pk_mul_f32 v[90:91], v[90:91], v[22:23]
    v_pk_mul_f32 v[92:93], v[92:93], v[32:33]
    v_pk_mul_f32 v[94:95], v[94:95], v[34:35]
    v_cvt_pk_bf16_f32 v138, v88, v89
    v_cvt_pk_bf16_f32 v139, v90, v91
    v_cvt_pk_bf16_f32 v142, v92, v93
    v_cvt_pk_bf16_f32 v143, v94, v95
    buffer_store_dwordx4 v[136:139], v1, s[12:15], s87 offen offset:2048 sc1
    buffer_store_dwordx4 v[140:143], v1, s[12:15], s87 offen offset:3072 sc1
    v_mov_b32 v2, 163784
    v_mov_b32 v3, 1
    s_waitcnt vmcnt(4)
    s_mov_b64 exec, 1
    ds_add_u32 v2, v3
    s_mov_b64 exec, -1
    s_cmp_lg_u32 s33, 0
    s_cbranch_scc1 Lof_126
    v_mov_b32 v2, 163784
Llw_127:
    ds_read_b32 v3, v2
    s_waitcnt lgkmcnt(0)
    v_cmp_gt_u32 vcc, 4, v3
    s_cbranch_vccnz Llw_127
    v_mov_b32 v2, 1
    v_mul_u32_u24 v3, 256, v0
    s_mov_b32 exec_lo, 0xffff
    s_mov_b32 exec_hi, 0
    buffer_atomic_add v2, v3, s[20:23], s43 offen sc1
    s_mov_b64 exec, -1
Lof_126:
    s_setprio 0
    s_and_b32 s72, s28, 1
    s_lshl_b32 s72, s72, 2
    s_and_b32 s73, s29, 3
    s_add_u32 s72, s72, s73
    s_lshl_b32 s72, s72, 1
    s_bfe_u32 s73, s29, 0x10002
    s_add_u32 s72, s72, s73
    s_bfe_u32 s73, s28, 0x10001
    s_lshl_b32 s73, s73, 2
    s_lshr_b32 s74, s29, 3
    s_add_u32 s73, s73, s74
    s_bfe_u32 s74, s28, 0x10002
    s_lshl_b32 s75, s72, 3
    s_add_u32 s75, s75, s73
    s_lshl_b32 s75, s75, 1
    s_add_u32 s75, s75, s74
    s_lshl_b32 s40, s35, 12
    s_add_u32 s40, s40, 98304
    v_add_u32 v6, s40, v1
    v_lshrrev_b32 v13, 5, v0
    v_lshlrev_b32 v13, 11, v13
    s_lshl_b32 s40, s34, 10
    s_add_u32 s40, s40, 0
    v_add_u32 v13, s40, v13
    v_bfe_u32 v14, v0, 2, 3
    v_lshl_add_u32 v13, v14, 7, v13
    v_and_b32 v14, 3, v0
    v_lshl_add_u32 v13, v14, 3, v13
    v_bfe_u32 v14, v0, 3, 2
    v_lshl_add_u32 v7, v14, 5, v13
    v_xor_b32 v15, 1, v14
    v_lshl_add_u32 v10, v15, 5, v13
    v_xor_b32 v15, 2, v14
    v_lshl_add_u32 v11, v15, 5, v13
    v_xor_b32 v15, 3, v14
    v_lshl_add_u32 v12, v15, 5, v13
    s_add_u32 s24, s70, 8388608
    s_addc_u32 s25, s71, 0
    s_and_b32 s25, s25, 0xffff
    s_mov_b32 s26, 4194304
    s_mov_b32 s27, 0x20000
    s_lshl_b32 s48, s73, 2
    s_lshl_b32 s40, s34, 1
    s_add_u32 s48, s48, s40
    s_lshl_b32 s48, s48, 17
    s_lshl_b32 s40, s72, 13
    s_add_u32 s48, s48, s40
    s_lshl_b32 s40, s35, 12
    s_add_u32 s48, s48, s40
    s_lshl_b32 s40, s74, 11
    s_add_u32 s48, s48, s40
    s_add_u32 s49, s48, 131072
    s_add_u32 s12, s70, 33554432
    s_addc_u32 s13, s71, 0
    s_and_b32 s13, s13, 0xffff
    s_mov_b32 s14, 8388608
    s_mov_b32 s15, 0x20000
    s_lshl_b32 s50, s75, 15
    s_lshl_b32 s40, s33, 13
    s_add_u32 s50, s50, s40
    s_add_u32 s51, s50, 4096
    s_xor_b32 s44, s50, 32768
    s_add_u32 s45, s44, 4096
    s_lshl_b32 s42, s75, 7
    s_add_u32 s42, s42, 1376256
    s_cmp_lg_u32 s33, 1
    s_cbranch_scc1 Low_128
    v_mov_b32 v2, 0
    s_mov_b64 exec, 1
    s_mov_b32 s101, 0
Lpoll_130:
    s_add_u32 s101, s101, 1
    s_cmp_ge_u32 s101, 200000
    s_cbranch_scc1 Lpoll_130x
    buffer_atomic_umax v2, off, s[20:23], s42 sc0 sc1
    s_waitcnt vmcnt(0)
    v_cmp_gt_u32 vcc, 16, v2
    s_cbranch_vccnz Lpoll_130
Lpoll_130x:
    s_mov_b64 exec, -1
Low_128:
    s_cmp_lg_u32 s33, 0
    s_cbranch_scc1 Low_131
    s_waitcnt vmcnt(1)
    s_branch Lox_132
Low_131:
    s_waitcnt vmcnt(0)
Lox_132:
    s_barrier
    s_cmp_lg_u32 s33, 0
    s_cbranch_scc1 Lof_133
    s_add_u32 s43, s43, 4294934540
    v_mov_b32 v2, 1
    v_mul_u32_u24 v3, 256, v0
    s_mov_b32 exec_lo, 0xffff
    s_mov_b32 exec_hi, 0
    buffer_atomic_add v2, v3, s[20:23], s43 offen sc1
    s_mov_b64 exec, -1
Lof_133:
    s_mov_b32 s36, 0
    s_mov_b32 s46, 16384
    s_mov_b32 s47, 4294918144
    s_mov_b32 s40, 0
    s_mov_b32 s43, 4294885376
    s_barrier
    ds_read_b128 a[0:3], v6 offset:0
    ds_read_b128 a[16:19], v6 offset:8192
    ds_read_b64_tr_b16 a[32:33], v7 offset:0
    ds_read_b64_tr_b16 a[34:35], v7 offset:4096
    ds_read_b64_tr_b16 a[48:49], v7 offset:8192
    ds_read_b64_tr_b16 a[50:51], v7 offset:12288
    ds_read_b64_tr_b16 a[36:37], v10 offset:0
    ds_read_b64_tr_b16 a[38:39], v10 offset:4096
    ds_read_b64_tr_b16 a[52:53], v10 offset:8192
    ds_read_b64_tr_b16 a[54:55], v10 offset:12288
    ds_read_b64_tr_b16 a[40:41], v11 offset:0
    ds_read_b64_tr_b16 a[42:43], v11 offset:4096
    ds_read_b64_tr_b16 a[56:57], v11 offset:8192
    ds_read_b64_tr_b16 a[58:59], v11 offset:12288
    ds_read_b64_tr_b16 a[44:45], v12 offset:0
    ds_read_b64_tr_b16 a[46:47], v12 offset:4096
    ds_read_b64_tr_b16 a[60:61], v12 offset:8192
    ds_read_b64_tr_b16 a[62:63], v12 offset:12288
    ds_read_b128 a[4:7], v6 offset:1024
    ds_read_b128 a[20:23], v6 offset:9216
    ds_read_b128 a[8:11], v6 offset:2048
    ds_read_b128 a[24:27], v6 offset:10240
    ds_read_b128 a[12:15], v6 offset:3072
    ds_read_b128 a[28:31], v6 offset:11264
    s_add_u32 s40, s40, 16384
    s_cmp_ge_u32 s40, 98304
    s_cselect_b32 s41, s43, s46
    s_cselect_b32 s40, 0, s40
    s_add_u32 s36, s36, 16384
    s_cmp_ge_u32 s36, 65536
    s_cselect_b32 s37, s47, s46
    s_cselect_b32 s36, 0, s36
    v_add_u32 v7, s41, v7
    v_add_u32 v10, s41, v10
    v_add_u32 v11, s41, v11
    v_add_u32 v12, s41, v12
    v_add_u32 v6, s37, v6
    s_waitcnt lgkmcnt(14)
    v_mfma_f32_16x16x32_bf16 v[48:51], a[32:35], a[0:3], 0
    s_add_u32 s40, s40, 16384
    s_cmp_ge_u32 s40, 98304
    s_cselect_b32 s41, s43, s46
    s_cselect_b32 s40, 0, s40
    v_mfma_f32_16x16x32_bf16 v[48:51], a[48:51], a[16:19], v[48:51]
    s_add_u32 s36, s36, 16384
    s_cmp_ge_u32 s36, 65536
    s_cselect_b32 s37, s47, s46
    s_cselect_b32 s36, 0, s36
    v_mfma_f32_16x16x32_bf16 v[52:55], a[36:39], a[0:3], 0
    v_mfma_f32_16x16x32_bf16 v[52:55], a[52:55], a[16:19], v[52:55]
    s_waitcnt lgkmcnt(12)
    v_mfma_f32_16x16x32_bf16 v[56:59], a[40:43], a[0:3], 0
    s_waitcnt lgkmcnt(10)
    v_mfma_f32_16x16x32_bf16 v[56:59], a[56:59], a[16:19], v[56:59]
    s_waitcnt lgkmcnt(8)
    v_mfma_f32_16x16x32_bf16 v[60:63], a[44:47], a[0:3], 0
    s_waitcnt lgkmcnt(6)
    v_mfma_f32_16x16x32_bf16 v[60:63], a[60:63], a[16:19], v[60:63]
    s_waitcnt lgkmcnt(5)
    v_mfma_f32_16x16x32_bf16 v[76:79], a[44:47], a[4:7], 0
    s_waitcnt lgkmcnt(4)
    v_mfma_f32_16x16x32_bf16 v[76:79], a[60:63], a[20:23], v[76:79]
    v_mfma_f32_16x16x32_bf16 v[72:75], a[40:43], a[4:7], 0
    v_mfma_f32_16x16x32_bf16 v[72:75], a[56:59], a[20:23], v[72:75]
    s_waitcnt lgkmcnt(0)
    s_barrier
    v_mfma_f32_16x16x32_bf16 v[68:71], a[36:39], a[4:7], 0
    ds_read_b128 a[64:67], v6 offset:0
    ds_read_b128 a[80:83], v6 offset:8192
    v_mfma_f32_16x16x32_bf16 v[68:71], a[52:55], a[20:23], v[68:71]
    ds_read_b64_tr_b16 v[112:113], v7 offset:0
    v_mfma_f32_16x16x32_bf16 v[64:67], a[32:35], a[4:7], 0
    ds_read_b64_tr_b16 v[114:115], v7 offset:4096
    v_mfma_f32_16x16x32_bf16 v[64:67], a[48:51], a[20:23], v[64:67]
    ds_read_b64_tr_b16 v[128:129], v7 offset:8192
    ds_read_b64_tr_b16 v[130:131], v7 offset:12288
    v_mfma_f32_16x16x32_bf16 v[80:83], a[32:35], a[8:11], 0
    ds_read_b64_tr_b16 v[116:117], v10 offset:0
    v_mfma_f32_16x16x32_bf16 v[80:83], a[48:51], a[24:27], v[80:83]
    ds_read_b64_tr_b16 v[118:119], v10 offset:4096
    v_mfma_f32_16x16x32_bf16 v[84:87], a[36:39], a[8:11], 0
    ds_read_b64_tr_b16 v[132:133], v10 offset:8192
    ds_read_b64_tr_b16 v[134:135], v10 offset:12288
    v_mfma_f32_16x16x32_bf16 v[84:87], a[52:55], a[24:27], v[84:87]
    ds_read_b64_tr_b16 v[120:121], v11 offset:0
    v_mfma_f32_16x16x32_bf16 v[88:91], a[40:43], a[8:11], 0
    ds_read_b64_tr_b16 v[122:123], v11 offset:4096
    v_mfma_f32_16x16x32_bf16 v[88:91], a[56:59], a[24:27], v[88:91]
    ds_read_b64_tr_b16 v[136:137], v11 offset:8192
    ds_read_b64_tr_b16 v[138:139], v11 offset:12288
    v_mfma_f32_16x16x32_bf16 v[92:95], a[44:47], a[8:11], 0
    ds_read_b64_tr_b16 v[124:125], v12 offset:0
    v_mfma_f32_16x16x32_bf16 v[92:95], a[60:63], a[24:27], v[92:95]
    ds_read_b64_tr_b16 v[126:127], v12 offset:4096
    v_mfma_f32_16x16x32_bf16 v[108:111], a[44:47], a[12:15], 0
    ds_read_b64_tr_b16 v[140:141], v12 offset:8192
    ds_read_b64_tr_b16 v[142:143], v12 offset:12288
    v_mfma_f32_16x16x32_bf16 v[108:111], a[60:63], a[28:31], v[108:111]
    ds_read_b128 a[68:71], v6 offset:1024
    v_mfma_f32_16x16x32_bf16 v[104:107], a[40:43], a[12:15], 0
    ds_read_b128 a[84:87], v6 offset:9216
    v_mfma_f32_16x16x32_bf16 v[104:107], a[56:59], a[28:31], v[104:107]
    ds_read_b128 a[72:75], v6 offset:2048
    ds_read_b128 a[88:91], v6 offset:10240
    v_mfma_f32_16x16x32_bf16 v[100:103], a[36:39], a[12:15], 0
    ds_read_b128 a[76:79], v6 offset:3072
    v_mfma_f32_16x16x32_bf16 v[100:103], a[52:55], a[28:31], v[100:103]
    ds_read_b128 a[92:95], v6 offset:11264
    v_mfma_f32_16x16x32_bf16 v[96:99], a[32:35], a[12:15], 0
    v_add_u32 v7, s41, v7
    v_add_u32 v10, s41, v10
    v_add_u32 v11, s41, v11
    v_mfma_f32_16x16x32_bf16 v[96:99], a[48:51], a[28:31], v[96:99]
    v_add_u32 v12, s41, v12
    v_add_u32 v6, s37, v6
    s_mov_b32 s38, 11
Lcloop_134:
    s_waitcnt lgkmcnt(0)
    v_mfma_f32_16x16x32_bf16 v[48:51], v[112:115], a[64:67], v[48:51]
    v_mfma_f32_16x16x32_bf16 v[48:51], v[128:131], a[80:83], v[48:51]
    s_barrier
    v_mfma_f32_16x16x32_bf16 v[52:55], v[116:119], a[64:67], v[52:55]
    ds_read_b128 a[0:3], v6 offset:0
    ds_read_b128 a[16:19], v6 offset:8192
    v_mfma_f32_16x16x32_bf16 v[52:55], v[132:135], a[80:83], v[52:55]
    ds_read_b64_tr_b16 a[32:33], v7 offset:0
    v_mfma_f32_16x16x32_bf16 v[56:59], v[120:123], a[64:67], v[56:59]
    ds_read_b64_tr_b16 a[34:35], v7 offset:4096
    v_mfma_f32_16x16x32_bf16 v[56:59], v[136:139], a[80:83], v[56:59]
    ds_read_b64_tr_b16 a[48:49], v7 offset:8192
    v_mfma_f32_16x16x32_bf16 v[60:63], v[124:127], a[64:67], v[60:63]
    s_add_u32 s40, s40, 16384
    ds_read_b64_tr_b16 a[50:51], v7 offset:12288
    v_mfma_f32_16x16x32_bf16 v[60:63], v[140:143], a[80:83], v[60:63]
    ds_read_b64_tr_b16 a[36:37], v10 offset:0
    v_mfma_f32_16x16x32_bf16 v[76:79], v[124:127], a[68:71], v[76:79]
    s_cmp_ge_u32 s40, 98304
    ds_read_b64_tr_b16 a[38:39], v10 offset:4096
    v_mfma_f32_16x16x32_bf16 v[76:79], v[140:143], a[84:87], v[76:79]
    ds_read_b64_tr_b16 a[52:53], v10 offset:8192
    v_mfma_f32_16x16x32_bf16 v[72:75], v[120:123], a[68:71], v[72:75]
    s_cselect_b32 s41, s43, s46
    ds_read_b64_tr_b16 a[54:55], v10 offset:12288
    v_mfma_f32_16x16x32_bf16 v[72:75], v[136:139], a[84:87], v[72:75]
    ds_read_b64_tr_b16 a[40:41], v11 offset:0
    v_mfma_f32_16x16x32_bf16 v[68:71], v[116:119], a[68:71], v[68:71]
    s_cselect_b32 s40, 0, s40
    ds_read_b64_tr_b16 a[42:43], v11 offset:4096
    v_mfma_f32_16x16x32_bf16 v[68:71], v[132:135], a[84:87], v[68:71]
    ds_read_b64_tr_b16 a[56:57], v11 offset:8192
    ds_read_b64_tr_b16 a[58:59], v11 offset:12288
    v_mfma_f32_16x16x32_bf16 v[64:67], v[112:115], a[68:71], v[64:67]
    s_add_u32 s36, s36, 16384
    ds_read_b64_tr_b16 a[44:45], v12 offset:0
    v_mfma_f32_16x16x32_bf16 v[64:67], v[128:131], a[84:87], v[64:67]
    ds_read_b64_tr_b16 a[46:47], v12 offset:4096
    v_mfma_f32_16x16x32_bf16 v[80:83], v[112:115], a[72:75], v[80:83]
    s_cmp_ge_u32 s36, 65536
    ds_read_b64_tr_b16 a[60:61], v12 offset:8192
    v_mfma_f32_16x16x32_bf16 v[80:83], v[128:131], a[88:91], v[80:83]
    ds_read_b64_tr_b16 a[62:63], v12 offset:12288
    v_mfma_f32_16x16x32_bf16 v[84:87], v[116:119], a[72:75], v[84:87]
    s_cselect_b32 s37, s47, s46
    ds_read_b128 a[4:7], v6 offset:1024
    v_mfma_f32_16x16x32_bf16 v[84:87], v[132:135], a[88:91], v[84:87]
    ds_read_b128 a[20:23], v6 offset:9216
    v_mfma_f32_16x16x32_bf16 v[88:91], v[120:123], a[72:75], v[88:91]
    s_cselect_b32 s36, 0, s36
    ds_read_b128 a[8:11], v6 offset:2048
    v_mfma_f32_16x16x32_bf16 v[88:91], v[136:139], a[88:91], v[88:91]
    ds_read_b128 a[24:27], v6 offset:10240
    v_mfma_f32_16x16x32_bf16 v[92:95], v[124:127], a[72:75], v[92:95]
    ds_read_b128 a[12:15], v6 offset:3072
    v_mfma_f32_16x16x32_bf16 v[92:95], v[140:143], a[88:91], v[92:95]
    ds_read_b128 a[28:31], v6 offset:11264
    v_mfma_f32_16x16x32_bf16 v[108:111], v[124:127], a[76:79], v[108:111]
    v_add_u32 v7, s41, v7
    v_mfma_f32_16x16x32_bf16 v[108:111], v[140:143], a[92:95], v[108:111]
    v_add_u32 v10, s41, v10
    v_mfma_f32_16x16x32_bf16 v[104:107], v[120:123], a[76:79], v[104:107]
    v_mfma_f32_16x16x32_bf16 v[104:107], v[136:139], a[92:95], v[104:107]
    v_add_u32 v11, s41, v11
    v_mfma_f32_16x16x32_bf16 v[100:103], v[116:119], a[76:79], v[100:103]
    v_add_u32 v12, s41, v12
    v_mfma_f32_16x16x32_bf16 v[100:103], v[132:135], a[92:95], v[100:103]
    v_mfma_f32_16x16x32_bf16 v[96:99], v[112:115], a[76:79], v[96:99]
    v_add_u32 v6, s37, v6
    v_mfma_f32_16x16x32_bf16 v[96:99], v[128:131], a[92:95], v[96:99]
    s_waitcnt lgkmcnt(0)
    v_mfma_f32_16x16x32_bf16 v[48:51], a[32:35], a[0:3], v[48:51]
    v_mfma_f32_16x16x32_bf16 v[48:51], a[48:51], a[16:19], v[48:51]
    s_barrier
    v_mfma_f32_16x16x32_bf16 v[52:55], a[36:39], a[0:3], v[52:55]
    ds_read_b128 a[64:67], v6 offset:0
    ds_read_b128 a[80:83], v6 offset:8192
    v_mfma_f32_16x16x32_bf16 v[52:55], a[52:55], a[16:19], v[52:55]
    ds_read_b64_tr_b16 v[112:113], v7 offset:0
    v_mfma_f32_16x16x32_bf16 v[56:59], a[40:43], a[0:3], v[56:59]
    ds_read_b64_tr_b16 v[114:115], v7 offset:4096
    v_mfma_f32_16x16x32_bf16 v[56:59], a[56:59], a[16:19], v[56:59]
    ds_read_b64_tr_b16 v[128:129], v7 offset:8192
    v_mfma_f32_16x16x32_bf16 v[60:63], a[44:47], a[0:3], v[60:63]
    s_add_u32 s40, s40, 16384
    ds_read_b64_tr_b16 v[130:131], v7 offset:12288
    v_mfma_f32_16x16x32_bf16 v[60:63], a[60:63], a[16:19], v[60:63]
    ds_read_b64_tr_b16 v[116:117], v10 offset:0
    v_mfma_f32_16x16x32_bf16 v[76:79], a[44:47], a[4:7], v[76:79]
    s_cmp_ge_u32 s40, 98304
    ds_read_b64_tr_b16 v[118:119], v10 offset:4096
    v_mfma_f32_16x16x32_bf16 v[76:79], a[60:63], a[20:23], v[76:79]
    ds_read_b64_tr_b16 v[132:133], v10 offset:8192
    v_mfma_f32_16x16x32_bf16 v[72:75], a[40:43], a[4:7], v[72:75]
    s_cselect_b32 s41, s43, s46
    ds_read_b64_tr_b16 v[134:135], v10 offset:12288
    v_mfma_f32_16x16x32_bf16 v[72:75], a[56:59], a[20:23], v[72:75]
    ds_read_b64_tr_b16 v[120:121], v11 offset:0
    v_mfma_f32_16x16x32_bf16 v[68:71], a[36:39], a[4:7], v[68:71]
    s_cselect_b32 s40, 0, s40
    ds_read_b64_tr_b16 v[122:123], v11 offset:4096
    v_mfma_f32_16x16x32_bf16 v[68:71], a[52:55], a[20:23], v[68:71]
    ds_read_b64_tr_b16 v[136:137], v11 offset:8192
    ds_read_b64_tr_b16 v[138:139], v11 offset:12288
    v_mfma_f32_16x16x32_bf16 v[64:67], a[32:35], a[4:7], v[64:67]
    s_add_u32 s36, s36, 16384
    ds_read_b64_tr_b16 v[124:125], v12 offset:0
    v_mfma_f32_16x16x32_bf16 v[64:67], a[48:51], a[20:23], v[64:67]
    ds_read_b64_tr_b16 v[126:127], v12 offset:4096
    v_mfma_f32_16x16x32_bf16 v[80:83], a[32:35], a[8:11], v[80:83]
    s_cmp_ge_u32 s36, 65536
    ds_read_b64_tr_b16 v[140:141], v12 offset:8192
    v_mfma_f32_16x16x32_bf16 v[80:83], a[48:51], a[24:27], v[80:83]
    ds_read_b64_tr_b16 v[142:143], v12 offset:12288
    v_mfma_f32_16x16x32_bf16 v[84:87], a[36:39], a[8:11], v[84:87]
    s_cselect_b32 s37, s47, s46
    ds_read_b128 a[68:71], v6 offset:1024
    v_mfma_f32_16x16x32_bf16 v[84:87], a[52:55], a[24:27], v[84:87]
    ds_read_b128 a[84:87], v6 offset:9216
    v_mfma_f32_16x16x32_bf16 v[88:91], a[40:43], a[8:11], v[88:91]
    s_cselect_b32 s36, 0, s36
    ds_read_b128 a[72:75], v6 offset:2048
    v_mfma_f32_16x16x32_bf16 v[88:91], a[56:59], a[24:27], v[88:91]
    ds_read_b128 a[88:91], v6 offset:10240
    v_mfma_f32_16x16x32_bf16 v[92:95], a[44:47], a[8:11], v[92:95]
    ds_read_b128 a[76:79], v6 offset:3072
    v_mfma_f32_16x16x32_bf16 v[92:95], a[60:63], a[24:27], v[92:95]
    ds_read_b128 a[92:95], v6 offset:11264
    v_mfma_f32_16x16x32_bf16 v[108:111], a[44:47], a[12:15], v[108:111]
    v_add_u32 v7, s41, v7
    v_mfma_f32_16x16x32_bf16 v[108:111], a[60:63], a[28:31], v[108:111]
    v_add_u32 v10, s41, v10
    v_mfma_f32_16x16x32_bf16 v[104:107], a[40:43], a[12:15], v[104:107]
    v_add_u32 v11, s41, v11
    v_mfma_f32_16x16x32_bf16 v[104:107], a[56:59], a[28:31], v[104:107]
    v_add_u32 v12, s41, v12
    v_mfma_f32_16x16x32_bf16 v[100:103], a[36:39], a[12:15], v[100:103]
    v_add_u32 v6, s37, v6
    v_mfma_f32_16x16x32_bf16 v[100:103], a[52:55], a[28:31], v[100:103]
    s_sub_u32 s38, s38, 1
    v_mfma_f32_16x16x32_bf16 v[96:99], a[32:35], a[12:15], v[96:99]
    s_cmp_lg_u32 s38, 0
    v_mfma_f32_16x16x32_bf16 v[96:99], a[48:51], a[28:31], v[96:99]
    s_cbranch_scc1 Lcloop_134
    v_lshlrev_b32 v13, 3, v0
    v_sub_u32 v6, v6, v13
    s_waitcnt lgkmcnt(0)
    v_mfma_f32_16x16x32_bf16 v[48:51], v[112:115], a[64:67], v[48:51]
    v_mfma_f32_16x16x32_bf16 v[48:51], v[128:131], a[80:83], v[48:51]
    s_barrier
    v_mfma_f32_16x16x32_bf16 v[52:55], v[116:119], a[64:67], v[52:55]
    ds_read_b64 a[0:1], v6 offset:2048
    ds_read_b64 a[2:3], v6 offset:2560
    v_mfma_f32_16x16x32_bf16 v[52:55], v[132:135], a[80:83], v[52:55]
    ds_read_b64 a[8:9], v6 offset:10240
    v_mfma_f32_16x16x32_bf16 v[56:59], v[120:123], a[64:67], v[56:59]
    ds_read_b64 a[10:11], v6 offset:10752
    v_mfma_f32_16x16x32_bf16 v[56:59], v[136:139], a[80:83], v[56:59]
    ds_read_b64_tr_b16 v[144:145], v7 offset:0
    v_mfma_f32_16x16x32_bf16 v[60:63], v[124:127], a[64:67], v[60:63]
    ds_read_b64_tr_b16 v[146:147], v7 offset:4096
    v_mfma_f32_16x16x32_bf16 v[60:63], v[140:143], a[80:83], v[60:63]
    ds_read_b64_tr_b16 v[16:17], v7 offset:8192
    v_mfma_f32_16x16x32_bf16 v[76:79], v[124:127], a[68:71], v[76:79]
    ds_read_b64_tr_b16 v[18:19], v7 offset:12288
    v_mfma_f32_16x16x32_bf16 v[76:79], v[140:143], a[84:87], v[76:79]
    ds_read_b64_tr_b16 v[148:149], v10 offset:0
    v_mfma_f32_16x16x32_bf16 v[72:75], v[120:123], a[68:71], v[72:75]
    ds_read_b64_tr_b16 v[150:151], v10 offset:4096
    v_mfma_f32_16x16x32_bf16 v[72:75], v[136:139], a[84:87], v[72:75]
    ds_read_b64_tr_b16 v[20:21], v10 offset:8192
    v_mfma_f32_16x16x32_bf16 v[68:71], v[116:119], a[68:71], v[68:71]
    ds_read_b64_tr_b16 v[22:23], v10 offset:12288
    v_mfma_f32_16x16x32_bf16 v[68:71], v[132:135], a[84:87], v[68:71]
    ds_read_b64_tr_b16 v[152:153], v11 offset:0
    ds_read_b64_tr_b16 v[154:155], v11 offset:4096
    v_mfma_f32_16x16x32_bf16 v[64:67], v[112:115], a[68:71], v[64:67]
    ds_read_b64_tr_b16 v[24:25], v11 offset:8192
    v_mfma_f32_16x16x32_bf16 v[64:67], v[128:131], a[84:87], v[64:67]
    ds_read_b64_tr_b16 v[26:27], v11 offset:12288
    v_mfma_f32_16x16x32_bf16 v[80:83], v[112:115], a[72:75], v[80:83]
    ds_read_b64_tr_b16 v[156:157], v12 offset:0
    v_mfma_f32_16x16x32_bf16 v[80:83], v[128:131], a[88:91], v[80:83]
    ds_read_b64_tr_b16 v[158:159], v12 offset:4096
    v_mfma_f32_16x16x32_bf16 v[84:87], v[116:119], a[72:75], v[84:87]
    ds_read_b64_tr_b16 v[28:29], v12 offset:8192
    v_mfma_f32_16x16x32_bf16 v[84:87], v[132:135], a[88:91], v[84:87]
    ds_read_b64_tr_b16 v[30:31], v12 offset:12288
    v_mfma_f32_16x16x32_bf16 v[88:91], v[120:123], a[72:75], v[88:91]
    ds_read_b64 a[4:5], v6 offset:3072
    v_mfma_f32_16x16x32_bf16 v[88:91], v[136:139], a[88:91], v[88:91]
    ds_read_b64 a[6:7], v6 offset:3584
    v_mfma_f32_16x16x32_bf16 v[92:95], v[124:127], a[72:75], v[92:95]
    ds_read_b64 a[12:13], v6 offset:11264
    v_mfma_f32_16x16x32_bf16 v[92:95], v[140:143], a[88:91], v[92:95]
    ds_read_b64 a[14:15], v6 offset:11776
    v_mfma_f32_16x16x32_bf16 v[108:111], v[124:127], a[76:79], v[108:111]
    v_mfma_f32_16x16x32_bf16 v[108:111], v[140:143], a[92:95], v[108:111]
    v_mfma_f32_16x16x32_bf16 v[104:107], v[120:123], a[76:79], v[104:107]
    v_mfma_f32_16x16x32_bf16 v[104:107], v[136:139], a[92:95], v[104:107]
    v_mfma_f32_16x16x32_bf16 v[100:103], v[116:119], a[76:79], v[100:103]
    v_mfma_f32_16x16x32_bf16 v[100:103], v[132:135], a[92:95], v[100:103]
    v_mfma_f32_16x16x32_bf16 v[96:99], v[112:115], a[76:79], v[96:99]
    v_mfma_f32_16x16x32_bf16 v[96:99], v[128:131], a[92:95], v[96:99]
    s_barrier
    s_waitcnt lgkmcnt(14)
    v_mfma_f32_16x16x32_bf16 v[80:83], v[144:147], a[0:3], v[80:83]
    ds_read_b64 a[16:17], v6 offset:18432
    ds_read_b64 a[18:19], v6 offset:18944
    v_mfma_f32_16x16x32_bf16 v[80:83], v[16:19], a[8:11], v[80:83]
    ds_read_b64 a[24:25], v6 offset:26624
    ds_read_b64 a[26:27], v6 offset:27136
    v_mfma_f32_16x16x32_bf16 v[84:87], v[148:151], a[0:3], v[84:87]
    ds_read_b64_tr_b16 v[112:113], v7 offset:16384
    ds_read_b64_tr_b16 v[114:115], v7 offset:20480
    s_waitcnt lgkmcnt(14)
    v_mfma_f32_16x16x32_bf16 v[84:87], v[20:23], a[8:11], v[84:87]
    ds_read_b64_tr_b16 v[128:129], v7 offset:24576
    v_mfma_f32_16x16x32_bf16 v[88:91], v[152:155], a[0:3], v[88:91]
    ds_read_b64_tr_b16 v[130:131], v7 offset:28672
    ds_read_b64_tr_b16 v[116:117], v10 offset:16384
    v_mfma_f32_16x16x32_bf16 v[88:91], v[24:27], a[8:11], v[88:91]
    ds_read_b64_tr_b16 v[118:119], v10 offset:20480
    ds_read_b64_tr_b16 v[132:133], v10 offset:24576
    s_waitcnt lgkmcnt(14)
    v_mfma_f32_16x16x32_bf16 v[92:95], v[156:159], a[0:3], v[92:95]
    ds_read_b64_tr_b16 v[134:135], v10 offset:28672
    v_mfma_f32_16x16x32_bf16 v[92:95], v[28:31], a[8:11], v[92:95]
    ds_read_b64_tr_b16 v[120:121], v11 offset:16384
    ds_read_b64_tr_b16 v[122:123], v11 offset:20480
    s_waitcnt lgkmcnt(14)
    v_mfma_f32_16x16x32_bf16 v[108:111], v[156:159], a[4:7], v[108:111]
    ds_read_b64_tr_b16 v[136:137], v11 offset:24576
    ds_read_b64_tr_b16 v[138:139], v11 offset:28672
    v_mfma_f32_16x16x32_bf16 v[108:111], v[28:31], a[12:15], v[108:111]
    ds_read_b64_tr_b16 v[124:125], v12 offset:16384
    ds_read_b64_tr_b16 v[126:127], v12 offset:20480
    v_mfma_f32_16x16x32_bf16 v[104:107], v[152:155], a[4:7], v[104:107]
    ds_read_b64_tr_b16 v[140:141], v12 offset:24576
    v_mfma_f32_16x16x32_bf16 v[104:107], v[24:27], a[12:15], v[104:107]
    ds_read_b64_tr_b16 v[142:143], v12 offset:28672
    ds_read_b64 a[20:21], v6 offset:19456
    v_mfma_f32_16x16x32_bf16 v[100:103], v[148:151], a[4:7], v[100:103]
    ds_read_b64 a[22:23], v6 offset:19968
    ds_read_b64 a[28:29], v6 offset:27648
    v_mfma_f32_16x16x32_bf16 v[100:103], v[20:23], a[12:15], v[100:103]
    ds_read_b64 a[30:31], v6 offset:28160
    v_mfma_f32_16x16x32_bf16 v[96:99], v[144:147], a[4:7], v[96:99]
    v_mfma_f32_16x16x32_bf16 v[96:99], v[16:19], a[12:15], v[96:99]
    s_barrier
    s_waitcnt lgkmcnt(14)
    v_mfma_f32_16x16x32_bf16 v[80:83], v[112:115], a[16:19], v[80:83]
    ds_read_b64 a[0:1], v6 offset:34816
    ds_read_b64 a[2:3], v6 offset:35328
    v_mfma_f32_16x16x32_bf16 v[80:83], v[128:131], a[24:27], v[80:83]
    ds_read_b64 a[8:9], v6 offset:43008
    ds_read_b64 a[10:11], v6 offset:43520
    v_mfma_f32_16x16x32_bf16 v[84:87], v[116:119], a[16:19], v[84:87]
    ds_read_b64_tr_b16 a[32:33], v7 offset:32768
    ds_read_b64_tr_b16 a[34:35], v7 offset:36864
    s_waitcnt lgkmcnt(14)
    v_mfma_f32_16x16x32_bf16 v[84:87], v[132:135], a[24:27], v[84:87]
    ds_read_b64_tr_b16 a[48:49], v7 offset:40960
    v_mfma_f32_16x16x32_bf16 v[88:91], v[120:123], a[16:19], v[88:91]
    ds_read_b64_tr_b16 a[50:51], v7 offset:45056
    ds_read_b64_tr_b16 a[36:37], v10 offset:32768
    v_mfma_f32_16x16x32_bf16 v[88:91], v[136:139], a[24:27], v[88:91]
    ds_read_b64_tr_b16 a[38:39], v10 offset:36864
    ds_read_b64_tr_b16 a[52:53], v10 offset:40960
    s_waitcnt lgkmcnt(14)
    v_mfma_f32_16x16x32_bf16 v[92:95], v[124:127], a[16:19], v[92:95]
    ds_read_b64_tr_b16 a[54:55], v10 offset:45056
    v_mfma_f32_16x16x32_bf16 v[92:95], v[140:143], a[24:27], v[92:95]
    ds_read_b64_tr_b16 a[40:41], v11 offset:32768
    ds_read_b64_tr_b16 a[42:43], v11 offset:36864
    s_waitcnt lgkmcnt(14)
    v_mfma_f32_16x16x32_bf16 v[108:111], v[124:127], a[20:23], v[108:111]
    ds_read_b64_tr_b16 a[56:57], v11 offset:40960
    ds_read_b64_tr_b16 a[58:59], v11 offset:45056
    buffer_load_dwordx4 v[32:35], v1, s[24:27], s48 offen offset:0 sc1
    v_mfma_f32_16x16x32_bf16 v[108:111], v[140:143], a[28:31], v[108:111]
    ds_read_b64_tr_b16 a[44:45], v12 offset:32768
    ds_read_b64_tr_b16 a[46:47], v12 offset:36864
    v_mfma_f32_16x16x32_bf16 v[104:107], v[120:123], a[20:23], v[104:107]
    ds_read_b64_tr_b16 a[60:61], v12 offset:40960
    buffer_load_dwordx4 v[36:39], v1, s[24:27], s49 offen offset:0 sc1
    v_mfma_f32_16x16x32_bf16 v[104:107], v[136:139], a[28:31], v[104:107]
    ds_read_b64_tr_b16 a[62:63], v12 offset:45056
    ds_read_b64 a[4:5], v6 offset:35840
    v_mfma_f32_16x16x32_bf16 v[100:103], v[116:119], a[20:23], v[100:103]
    ds_read_b64 a[6:7], v6 offset:36352
    ds_read_b64 a[12:13], v6 offset:44032
    buffer_load_dwordx4 v[40:43], v1, s[24:27], s48 offen offset:1024 sc1
    v_mfma_f32_16x16x32_bf16 v[100:103], v[132:135], a[28:31], v[100:103]
    ds_read_b64 a[14:15], v6 offset:44544
    v_mfma_f32_16x16x32_bf16 v[96:99], v[112:115], a[20:23], v[96:99]
    buffer_load_dwordx4 v[44:47], v1, s[24:27], s49 offen offset:1024 sc1
    v_mfma_f32_16x16x32_bf16 v[96:99], v[128:131], a[28:31], v[96:99]
    s_barrier
    s_waitcnt lgkmcnt(14)
    v_mfma_f32_16x16x32_bf16 v[80:83], a[32:35], a[0:3], v[80:83]
    ds_read_b64 a[16:17], v6 offset:51200
    ds_read_b64 a[18:19], v6 offset:51712
    v_mfma_f32_16x16x32_bf16 v[80:83], a[48:51], a[8:11], v[80:83]
    ds_read_b64 a[24:25], v6 offset:59392
    ds_read_b64 a[26:27], v6 offset:59904
    v_mfma_f32_16x16x32_bf16 v[84:87], a[36:39], a[0:3], v[84:87]
    ds_read_b64_tr_b16 a[64:65], v7 offset:49152
    ds_read_b64_tr_b16 a[66:67], v7 offset:53248
    s_waitcnt lgkmcnt(14)
    v_mfma_f32_16x16x32_bf16 v[84:87], a[52:55], a[8:11], v[84:87]
    ds_read_b64_tr_b16 a[80:81], v7 offset:57344
    v_mfma_f32_16x16x32_bf16 v[88:91], a[40:43], a[0:3], v[88:91]
    ds_read_b64_tr_b16 a[82:83], v7 offset:61440
    ds_read_b64_tr_b16 a[68:69], v10 offset:49152
    v_mfma_f32_16x16x32_bf16 v[88:91], a[56:59], a[8:11], v[88:91]
    ds_read_b64_tr_b16 a[70:71], v10 offset:53248
    ds_read_b64_tr_b16 a[84:85], v10 offset:57344
    s_waitcnt lgkmcnt(14)
    v_mfma_f32_16x16x32_bf16 v[92:95], a[44:47], a[0:3], v[92:95]
    ds_read_b64_tr_b16 a[86:87], v10 offset:61440
    v_mfma_f32_16x16x32_bf16 v[92:95], a[60:63], a[8:11], v[92:95]
    ds_read_b64_tr_b16 a[72:73], v11 offset:49152
    ds_read_b64_tr_b16 a[74:75], v11 offset:53248
    s_waitcnt lgkmcnt(14)
    v_mfma_f32_16x16x32_bf16 v[108:111], a[44:47], a[4:7], v[108:111]
    ds_read_b64_tr_b16 a[88:89], v11 offset:57344
    ds_read_b64_tr_b16 a[90:91], v11 offset:61440
    v_mfma_f32_16x16x32_bf16 v[108:111], a[60:63], a[12:15], v[108:111]
    ds_read_b64_tr_b16 a[76:77], v12 offset:49152
    ds_read_b64_tr_b16 a[78:79], v12 offset:53248
    v_mfma_f32_16x16x32_bf16 v[104:107], a[40:43], a[4:7], v[104:107]
    ds_read_b64_tr_b16 a[92:93], v12 offset:57344
    v_mfma_f32_16x16x32_bf16 v[104:107], a[56:59], a[12:15], v[104:107]
    ds_read_b64_tr_b16 a[94:95], v12 offset:61440
    ds_read_b64 a[20:21], v6 offset:52224
    v_mfma_f32_16x16x32_bf16 v[100:103], a[36:39], a[4:7], v[100:103]
    ds_read_b64 a[22:23], v6 offset:52736
    ds_read_b64 a[28:29], v6 offset:60416
    v_mfma_f32_16x16x32_bf16 v[100:103], a[52:55], a[12:15], v[100:103]
    ds_read_b64 a[30:31], v6 offset:60928
    v_mfma_f32_16x16x32_bf16 v[96:99], a[32:35], a[4:7], v[96:99]
    v_mfma_f32_16x16x32_bf16 v[96:99], a[48:51], a[12:15], v[96:99]
    s_waitcnt lgkmcnt(14)
    v_mfma_f32_16x16x32_bf16 v[80:83], a[64:67], a[16:19], v[80:83]
    ds_read_b64 a[0:1], v6 offset:0
    v_mfma_f32_16x16x32_bf16 v[80:83], a[80:83], a[24:27], v[80:83]
    ds_read_b64 a[2:3], v6 offset:512
    v_mfma_f32_16x16x32_bf16 v[84:87], a[68:71], a[16:19], v[84:87]
    ds_read_b64 a[8:9], v6 offset:8192
    s_waitcnt lgkmcnt(14)
    v_mfma_f32_16x16x32_bf16 v[84:87], a[84:87], a[24:27], v[84:87]
    ds_read_b64 a[10:11], v6 offset:8704
    s_waitcnt lgkmcnt(14)
    v_mfma_f32_16x16x32_bf16 v[88:91], a[72:75], a[16:19], v[88:91]
    ds_read_b64 a[4:5], v6 offset:1024
    s_waitcnt lgkmcnt(13)
    v_mfma_f32_16x16x32_bf16 v[88:91], a[88:91], a[24:27], v[88:91]
    ds_read_b64 a[6:7], v6 offset:1536
    s_waitcnt lgkmcnt(12)
    v_mfma_f32_16x16x32_bf16 v[92:95], a[76:79], a[16:19], v[92:95]
    ds_read_b64 a[12:13], v6 offset:9216
    s_waitcnt lgkmcnt(11)
    v_mfma_f32_16x16x32_bf16 v[92:95], a[92:95], a[24:27], v[92:95]
    ds_read_b64 a[14:15], v6 offset:9728
    s_waitcnt lgkmcnt(10)
    v_mfma_f32_16x16x32_bf16 v[108:111], a[76:79], a[20:23], v[108:111]
    s_waitcnt lgkmcnt(8)
    v_mfma_f32_16x16x32_bf16 v[108:111], a[92:95], a[28:31], v[108:111]
    buffer_store_dwordx4 v[80:83], v1, s[12:15], s44 offen offset:0 sc1
    v_mfma_f32_16x16x32_bf16 v[104:107], a[72:75], a[20:23], v[104:107]
    v_mfma_f32_16x16x32_bf16 v[104:107], a[88:91], a[28:31], v[104:107]
    buffer_store_dwordx4 v[84:87], v1, s[12:15], s44 offen offset:1024 sc1
    v_mfma_f32_16x16x32_bf16 v[100:103], a[68:71], a[20:23], v[100:103]
    v_mfma_f32_16x16x32_bf16 v[100:103], a[84:87], a[28:31], v[100:103]
    buffer_store_dwordx4 v[88:91], v1, s[12:15], s44 offen offset:2048 sc1
    v_mfma_f32_16x16x32_bf16 v[96:99], a[64:67], a[20:23], v[96:99]
    v_mfma_f32_16x16x32_bf16 v[96:99], a[80:83], a[28:31], v[96:99]
    buffer_store_dwordx4 v[92:95], v1, s[12:15], s44 offen offset:3072 sc1
    s_waitcnt lgkmcnt(6)
    v_mfma_f32_16x16x32_bf16 v[48:51], v[144:147], a[0:3], v[48:51]
    ds_read_b64 a[16:17], v6 offset:16384
    s_waitcnt lgkmcnt(5)
    v_mfma_f32_16x16x32_bf16 v[48:51], v[16:19], a[8:11], v[48:51]
    ds_read_b64 a[18:19], v6 offset:16896
    buffer_store_dwordx4 v[108:111], v1, s[12:15], s45 offen offset:3072 sc1
    v_mfma_f32_16x16x32_bf16 v[52:55], v[148:151], a[0:3], v[52:55]
    ds_read_b64 a[24:25], v6 offset:24576
    v_mfma_f32_16x16x32_bf16 v[52:55], v[20:23], a[8:11], v[52:55]
    ds_read_b64 a[26:27], v6 offset:25088
    buffer_store_dwordx4 v[104:107], v1, s[12:15], s45 offen offset:2048 sc1
    v_mfma_f32_16x16x32_bf16 v[56:59], v[152:155], a[0:3], v[56:59]
    ds_read_b64 a[20:21], v6 offset:17408
    v_mfma_f32_16x16x32_bf16 v[56:59], v[24:27], a[8:11], v[56:59]
    ds_read_b64 a[22:23], v6 offset:17920
    buffer_store_dwordx4 v[100:103], v1, s[12:15], s45 offen offset:1024 sc1
    v_mfma_f32_16x16x32_bf16 v[60:63], v[156:159], a[0:3], v[60:63]
    ds_read_b64 a[28:29], v6 offset:25600
    v_mfma_f32_16x16x32_bf16 v[60:63], v[28:31], a[8:11], v[60:63]
    ds_read_b64 a[30:31], v6 offset:26112
    buffer_store_dwordx4 v[96:99], v1, s[12:15], s45 offen offset:0 sc1
    s_waitcnt lgkmcnt(10)
    v_mfma_f32_16x16x32_bf16 v[76:79], v[156:159], a[4:7], v[76:79]
    s_waitcnt lgkmcnt(8)
    v_mfma_f32_16x16x32_bf16 v[76:79], v[28:31], a[12:15], v[76:79]
    v_mfma_f32_16x16x32_bf16 v[72:75], v[152:155], a[4:7], v[72:75]
    v_mfma_f32_16x16x32_bf16 v[72:75], v[24:27], a[12:15], v[72:75]
    v_mfma_f32_16x16x32_bf16 v[68:71], v[148:151], a[4:7], v[68:71]
    v_mfma_f32_16x16x32_bf16 v[68:71], v[20:23], a[12:15], v[68:71]
    v_mfma_f32_16x16x32_bf16 v[64:67], v[144:147], a[4:7], v[64:67]
    v_mfma_f32_16x16x32_bf16 v[64:67], v[16:19], a[12:15], v[64:67]
    s_waitcnt lgkmcnt(6)
    v_mfma_f32_16x16x32_bf16 v[48:51], v[112:115], a[16:19], v[48:51]
    ds_read_b64 a[0:1], v6 offset:32768
    s_waitcnt lgkmcnt(5)
    v_mfma_f32_16x16x32_bf16 v[48:51], v[128:131], a[24:27], v[48:51]
    ds_read_b64 a[2:3], v6 offset:33280
    v_mfma_f32_16x16x32_bf16 v[52:55], v[116:119], a[16:19], v[52:55]
    ds_read_b64 a[8:9], v6 offset:40960
    v_mfma_f32_16x16x32_bf16 v[52:55], v[132:135], a[24:27], v[52:55]
    ds_read_b64 a[10:11], v6 offset:41472
    v_mfma_f32_16x16x32_bf16 v[56:59], v[120:123], a[16:19], v[56:59]
    ds_read_b64 a[4:5], v6 offset:33792
    v_mfma_f32_16x16x32_bf16 v[56:59], v[136:139], a[24:27], v[56:59]
    ds_read_b64 a[6:7], v6 offset:34304
    v_mfma_f32_16x16x32_bf16 v[60:63], v[124:127], a[16:19], v[60:63]
    ds_read_b64 a[12:13], v6 offset:41984
    v_mfma_f32_16x16x32_bf16 v[60:63], v[140:143], a[24:27], v[60:63]
    ds_read_b64 a[14:15], v6 offset:42496
    s_waitcnt lgkmcnt(10)
    v_mfma_f32_16x16x32_bf16 v[76:79], v[124:127], a[20:23], v[76:79]
    s_waitcnt lgkmcnt(8)
    v_mfma_f32_16x16x32_bf16 v[76:79], v[140:143], a[28:31], v[76:79]
    v_mfma_f32_16x16x32_bf16 v[72:75], v[120:123], a[20:23], v[72:75]
    v_mfma_f32_16x16x32_bf16 v[72:75], v[136:139], a[28:31], v[72:75]
    v_mfma_f32_16x16x32_bf16 v[68:71], v[116:119], a[20:23], v[68:71]
    v_mfma_f32_16x16x32_bf16 v[68:71], v[132:135], a[28:31], v[68:71]
    v_mfma_f32_16x16x32_bf16 v[64:67], v[112:115], a[20:23], v[64:67]
    v_mfma_f32_16x16x32_bf16 v[64:67], v[128:131], a[28:31], v[64:67]
    s_waitcnt lgkmcnt(6)
    v_mfma_f32_16x16x32_bf16 v[48:51], a[32:35], a[0:3], v[48:51]
    ds_read_b64 a[16:17], v6 offset:49152
    s_waitcnt lgkmcnt(5)
    v_mfma_f32_16x16x32_bf16 v[48:51], a[48:51], a[8:11], v[48:51]
    ds_read_b64 a[18:19], v6 offset:49664
    v_mfma_f32_16x16x32_bf16 v[52:55], a[36:39], a[0:3], v[52:55]
    ds_read_b64 a[24:25], v6 offset:57344
    v_mfma_f32_16x16x32_bf16 v[52:55], a[52:55], a[8:11], v[52:55]
    ds_read_b64 a[26:27], v6 offset:57856
    v_mfma_f32_16x16x32_bf16 v[56:59], a[40:43], a[0:3], v[56:59]
    ds_read_b64 a[20:21], v6 offset:50176
    v_mfma_f32_16x16x32_bf16 v[56:59], a[56:59], a[8:11], v[56:59]
    ds_read_b64 a[22:23], v6 offset:50688
    v_mfma_f32_16x16x32_bf16 v[60:63], a[44:47], a[0:3], v[60:63]
    ds_read_b64 a[28:29], v6 offset:58368
    v_mfma_f32_16x16x32_bf16 v[60:63], a[60:63], a[8:11], v[60:63]
    ds_read_b64 a[30:31], v6 offset:58880
    s_waitcnt lgkmcnt(10)
    v_mfma_f32_16x16x32_bf16 v[76:79], a[44:47], a[4:7], v[76:79]
    s_waitcnt lgkmcnt(8)
    v_mfma_f32_16x16x32_bf16 v[76:79], a[60:63], a[12:15], v[76:79]
    v_mfma_f32_16x16x32_bf16 v[72:75], a[40:43], a[4:7], v[72:75]
    v_mfma_f32_16x16x32_bf16 v[72:75], a[56:59], a[12:15], v[72:75]
    v_mfma_f32_16x16x32_bf16 v[68:71], a[36:39], a[4:7], v[68:71]
    v_mfma_f32_16x16x32_bf16 v[68:71], a[52:55], a[12:15], v[68:71]
    v_mfma_f32_16x16x32_bf16 v[64:67], a[32:35], a[4:7], v[64:67]
    v_mfma_f32_16x16x32_bf16 v[64:67], a[48:51], a[12:15], v[64:67]
    s_waitcnt lgkmcnt(6)
    v_mfma_f32_16x16x32_bf16 v[48:51], a[64:67], a[16:19], v[48:51]
    s_waitcnt lgkmcnt(4)
    v_mfma_f32_16x16x32_bf16 v[48:51], a[80:83], a[24:27], v[48:51]
    v_mfma_f32_16x16x32_bf16 v[52:55], a[68:71], a[16:19], v[52:55]
    v_mfma_f32_16x16x32_bf16 v[52:55], a[84:87], a[24:27], v[52:55]
    v_mfma_f32_16x16x32_bf16 v[56:59], a[72:75], a[16:19], v[56:59]
    v_mfma_f32_16x16x32_bf16 v[56:59], a[88:91], a[24:27], v[56:59]
    v_mfma_f32_16x16x32_bf16 v[60:63], a[76:79], a[16:19], v[60:63]
    v_mfma_f32_16x16x32_bf16 v[60:63], a[92:95], a[24:27], v[60:63]
    s_waitcnt lgkmcnt(2)
    v_mfma_f32_16x16x32_bf16 v[76:79], a[76:79], a[20:23], v[76:79]
    s_waitcnt lgkmcnt(0)
    v_mfma_f32_16x16x32_bf16 v[76:79], a[92:95], a[28:31], v[76:79]
    v_mfma_f32_16x16x32_bf16 v[72:75], a[72:75], a[20:23], v[72:75]
    v_mfma_f32_16x16x32_bf16 v[72:75], a[88:91], a[28:31], v[72:75]
    v_mfma_f32_16x16x32_bf16 v[68:71], a[68:71], a[20:23], v[68:71]
    v_mfma_f32_16x16x32_bf16 v[68:71], a[84:87], a[28:31], v[68:71]
    v_mfma_f32_16x16x32_bf16 v[64:67], a[64:67], a[20:23], v[64:67]
    v_mfma_f32_16x16x32_bf16 v[64:67], a[80:83], a[28:31], v[64:67]
    s_nop 7
    s_mov_b32 s24, s66
    s_and_b32 s25, s67, 0xffff
    s_mov_b32 s26, 4194304
    s_mov_b32 s27, 0x20000
    v_and_b32 v10, 15, v0
    v_lshlrev_b32 v10, 12, v10
    v_lshrrev_b32 v11, 4, v0
    v_lshl_add_u32 v4, v11, 3, v10
    s_lshl_b32 s42, s72, 18
    s_lshl_b32 s40, s35, 17
    s_add_u32 s42, s42, s40
    s_lshl_b32 s40, s73, 8
    s_lshl_b32 s41, s34, 7
    s_add_u32 s40, s40, s41
    s_lshl_b32 s41, s74, 16
    s_add_u32 s40, s40, s41
    s_add_u32 s42, s42, s40
    s_add_u32 s43, s42, 65536
    v_bfe_u32 v11, v0, 4, 1
    v_lshl_add_u32 v4, v11, 5, v10
    v_lshrrev_b32 v11, 5, v0
    v_lshl_add_u32 v4, v11, 4, v4
    v_and_b32 v4, 0xffff7fff, v4
    v_bfe_u32 v11, v0, 3, 1
    v_lshl_add_u32 v4, v11, 6, v4
    s_add_u32 s43, s42, 32768
    s_waitcnt vmcnt(8)
    v_and_b32 v5, 7, v0
    v_lshlrev_b32 v5, 4, v5
    v_lshl_add_u32 v5, v11, 11, v5
    v_bfe_u32 v11, v0, 4, 1
    v_lshl_add_u32 v5, v11, 10, v5
    v_lshrrev_b32 v11, 5, v0
    v_lshl_add_u32 v5, v11, 9, v5
    v_lshlrev_b32 v14, 16, v32
    v_and_b32 v15, 0xffff0000, v32
    v_add_f32 v48, v48, v14
    v_add_f32 v49, v49, v15
    v_lshlrev_b32 v16, 16, v33
    v_and_b32 v17, 0xffff0000, v33
    v_add_f32 v50, v50, v16
    v_add_f32 v51, v51, v17
    v_lshlrev_b32 v14, 16, v34
    v_and_b32 v15, 0xffff0000, v34
    v_add_f32 v52, v52, v14
    v_add_f32 v53, v53, v15
    v_lshlrev_b32 v16, 16, v35
    v_and_b32 v17, 0xffff0000, v35
    v_add_f32 v54, v54, v16
    v_add_f32 v55, v55, v17
    v_lshlrev_b32 v14, 16, v36
    v_and_b32 v15, 0xffff0000, v36
    v_add_f32 v56, v56, v14
    v_add_f32 v57, v57, v15
    v_lshlrev_b32 v16, 16, v37
    v_and_b32 v17, 0xffff0000, v37
    v_add_f32 v58, v58, v16
    v_add_f32 v59, v59, v17
    v_lshlrev_b32 v14, 16, v38
    v_and_b32 v15, 0xffff0000, v38
    v_add_f32 v60, v60, v14
    v_add_f32 v61, v61, v15
    v_lshlrev_b32 v16, 16, v39
    v_and_b32 v17, 0xffff0000, v39
    v_add_f32 v62, v62, v16
    v_add_f32 v63, v63, v17
    v_lshlrev_b32 v14, 16, v40
    v_and_b32 v15, 0xffff0000, v40
    v_add_f32 v64, v64, v14
    v_add_f32 v65, v65, v15
    v_lshlrev_b32 v16, 16, v41
    v_and_b32 v17, 0xffff0000, v41
    v_add_f32 v66, v66, v16
    v_add_f32 v67, v67, v17
    v_lshlrev_b32 v14, 16, v42
    v_and_b32 v15, 0xffff0000, v42
    v_add_f32 v68, v68, v14
    v_add_f32 v69, v69, v15
    v_lshlrev_b32 v16, 16, v43
    v_and_b32 v17, 0xffff0000, v43
    v_add_f32 v70, v70, v16
    s_waitcnt vmcnt(0)
    s_barrier
    v_add_f32 v71, v71, v17
    v_lshlrev_b32 v14, 16, v44
    v_and_b32 v15, 0xffff0000, v44
    v_add_f32 v72, v72, v14
    v_add_f32 v73, v73, v15
    v_lshlrev_b32 v16, 16, v45
    v_and_b32 v17, 0xffff0000, v45
    v_add_f32 v74, v74, v16
    v_add_f32 v75, v75, v17
    v_lshlrev_b32 v14, 16, v46
    v_and_b32 v15, 0xffff0000, v46
    v_add_f32 v76, v76, v14
    v_add_f32 v77, v77, v15
    v_lshlrev_b32 v16, 16, v47
    v_and_b32 v17, 0xffff0000, v47
    v_add_f32 v78, v78, v16
    v_add_f32 v79, v79, v17
    v_permlane16_swap_b32 v48, v52
    v_permlane16_swap_b32 v49, v53
    v_permlane16_swap_b32 v50, v54
    v_permlane16_swap_b32 v51, v55
    v_permlane16_swap_b32 v56, v60
    v_permlane16_swap_b32 v57, v61
    v_permlane16_swap_b32 v58, v62
    v_permlane16_swap_b32 v59, v63
    v_mov_b32 v16, v48
    v_mov_b32 v17, v49
    v_mov_b32 v18, v50
    v_mov_b32 v19, v51
    v_mov_b32 v20, v52
    v_mov_b32 v21, v53
    v_mov_b32 v22, v54
    v_mov_b32 v23, v55
    v_mov_b32_dpp v48, v56 row_ror:8 row_mask:0xf bank_mask:0xc
    v_mov_b32_dpp v49, v57 row_ror:8 row_mask:0xf bank_mask:0xc
    v_mov_b32_dpp v50, v58 row_ror:8 row_mask:0xf bank_mask:0xc
    v_mov_b32_dpp v51, v59 row_ror:8 row_mask:0xf bank_mask:0xc
    v_mov_b32_dpp v52, v60 row_ror:8 row_mask:0xf bank_mask:0xc
    v_mov_b32_dpp v53, v61 row_ror:8 row_mask:0xf bank_mask:0xc
    v_mov_b32_dpp v54, v62 row_ror:8 row_mask:0xf bank_mask:0xc
    v_mov_b32_dpp v55, v63 row_ror:8 row_mask:0xf bank_mask:0xc
    v_mov_b32_dpp v56, v16 row_ror:8 row_mask:0xf bank_mask:0x3
    v_mov_b32_dpp v57, v17 row_ror:8 row_mask:0xf bank_mask:0x3
    v_mov_b32_dpp v58, v18 row_ror:8 row_mask:0xf bank_mask:0x3
    v_mov_b32_dpp v59, v19 row_ror:8 row_mask:0xf bank_mask:0x3
    v_mov_b32_dpp v60, v20 row_ror:8 row_mask:0xf bank_mask:0x3
    v_mov_b32_dpp v61, v21 row_ror:8 row_mask:0xf bank_mask:0x3
    v_mov_b32_dpp v62, v22 row_ror:8 row_mask:0xf bank_mask:0x3
    v_mov_b32_dpp v63, v23 row_ror:8 row_mask:0xf bank_mask:0x3
    v_permlane16_swap_b32 v64, v68
    v_permlane16_swap_b32 v65, v69
    v_permlane16_swap_b32 v66, v70
    v_permlane16_swap_b32 v67, v71
    v_permlane16_swap_b32 v72, v76
    v_permlane16_swap_b32 v73, v77
    v_permlane16_swap_b32 v74, v78
    v_permlane16_swap_b32 v75, v79
    v_mov_b32 v16, v64
    v_mov_b32 v17, v65
    v_mov_b32 v18, v66
    v_mov_b32 v19, v67
    v_mov_b32 v20, v68
    v_mov_b32 v21, v69
    v_mov_b32 v22, v70
    v_mov_b32 v23, v71
    v_mov_b32_dpp v64, v72 row_ror:8 row_mask:0xf bank_mask:0xc
    v_mov_b32_dpp v65, v73 row_ror:8 row_mask:0xf bank_mask:0xc
    v_mov_b32_dpp v66, v74 row_ror:8 row_mask:0xf bank_mask:0xc
    v_mov_b32_dpp v67, v75 row_ror:8 row_mask:0xf bank_mask:0xc
    v_mov_b32_dpp v68, v76 row_ror:8 row_mask:0xf bank_mask:0xc
    v_mov_b32_dpp v69, v77 row_ror:8 row_mask:0xf bank_mask:0xc
    v_mov_b32_dpp v70, v78 row_ror:8 row_mask:0xf bank_mask:0xc
    v_mov_b32_dpp v71, v79 row_ror:8 row_mask:0xf bank_mask:0xc
    v_mov_b32_dpp v72, v16 row_ror:8 row_mask:0xf bank_mask:0x3
    v_mov_b32_dpp v73, v17 row_ror:8 row_mask:0xf bank_mask:0x3
    v_mov_b32_dpp v74, v18 row_ror:8 row_mask:0xf bank_mask:0x3
    v_mov_b32_dpp v75, v19 row_ror:8 row_mask:0xf bank_mask:0x3
    v_mov_b32_dpp v76, v20 row_ror:8 row_mask:0xf bank_mask:0x3
    v_mov_b32_dpp v77, v21 row_ror:8 row_mask:0xf bank_mask:0x3
    v_mov_b32_dpp v78, v22 row_ror:8 row_mask:0xf bank_mask:0x3
    v_mov_b32_dpp v79, v23 row_ror:8 row_mask:0xf bank_mask:0x3
    s_barrier
    buffer_load_dwordx4 v[112:115], v5, s[12:15], s50 offen offset:0 sc1
    buffer_load_dwordx4 v[116:119], v5, s[12:15], s50 offen offset:256 sc1
    buffer_load_dwordx4 v[120:123], v5, s[12:15], s50 offen offset:128 sc1
    buffer_load_dwordx4 v[124:127], v5, s[12:15], s50 offen offset:384 sc1
    buffer_load_dwordx4 v[128:131], v5, s[12:15], s51 offen offset:0 sc1
    buffer_load_dwordx4 v[132:135], v5, s[12:15], s51 offen offset:256 sc1
    buffer_load_dwordx4 v[136:139], v5, s[12:15], s51 offen offset:128 sc1
    buffer_load_dwordx4 v[140:143], v5, s[12:15], s51 offen offset:384 sc1
    s_waitcnt vmcnt(6)
    v_add_f32 v48, v48, v112
    v_add_f32 v49, v49, v113
    v_add_f32 v50, v50, v114
    v_add_f32 v51, v51, v115
    v_add_f32 v52, v52, v116
    v_add_f32 v53, v53, v117
    v_add_f32 v54, v54, v118
    v_add_f32 v55, v55, v119
    v_cvt_pk_bf16_f32 v48, v48, v49
    v_cvt_pk_bf16_f32 v49, v50, v51
    v_cvt_pk_bf16_f32 v50, v52, v53
    v_cvt_pk_bf16_f32 v51, v54, v55
    buffer_store_dwordx4 v[48:51], v4, s[24:27], s42 offen offset:0 sc1
    s_waitcnt vmcnt(5)
    v_add_f32 v56, v56, v120
    v_add_f32 v57, v57, v121
    v_add_f32 v58, v58, v122
    v_add_f32 v59, v59, v123
    v_add_f32 v60, v60, v124
    v_add_f32 v61, v61, v125
    v_add_f32 v62, v62, v126
    v_add_f32 v63, v63, v127
    v_cvt_pk_bf16_f32 v56, v56, v57
    v_cvt_pk_bf16_f32 v57, v58, v59
    v_cvt_pk_bf16_f32 v58, v60, v61
    v_cvt_pk_bf16_f32 v59, v62, v63
    buffer_store_dwordx4 v[56:59], v4, s[24:27], s43 offen offset:0 sc1
    s_waitcnt vmcnt(4)
    v_add_f32 v64, v64, v128
    v_add_f32 v65, v65, v129
    v_add_f32 v66, v66, v130
    v_add_f32 v67, v67, v131
    v_add_f32 v68, v68, v132
    v_add_f32 v69, v69, v133
    v_add_f32 v70, v70, v134
    v_add_f32 v71, v71, v135
    v_cvt_pk_bf16_f32 v64, v64, v65
    v_cvt_pk_bf16_f32 v65, v66, v67
    v_cvt_pk_bf16_f32 v66, v68, v69
    v_cvt_pk_bf16_f32 v67, v70, v71
    buffer_store_dwordx4 v[64:67], v4, s[24:27], s42 offen offset:2048 sc1
    s_waitcnt vmcnt(3)
    v_add_f32 v72, v72, v136
    v_add_f32 v73, v73, v137
    v_add_f32 v74, v74, v138
    v_add_f32 v75, v75, v139
    v_add_f32 v76, v76, v140
    v_add_f32 v77, v77, v141
    v_add_f32 v78, v78, v142
    v_add_f32 v79, v79, v143
    v_cvt_pk_bf16_f32 v72, v72, v73
    v_cvt_pk_bf16_f32 v73, v74, v75
    v_cvt_pk_bf16_f32 v74, v76, v77
    v_cvt_pk_bf16_f32 v75, v78, v79
    buffer_store_dwordx4 v[72:75], v4, s[24:27], s43 offen offset:2048 sc1
Lend_sequential_preLN__sliding_local_dilated__geglu_ffn__prompt_kernel:
    s_endpgm
Lp2alt_54:
    s_or_b32 s40, s44, s45
    s_cbranch_scc1 Lp2a2_55
    s_cmp_lg_u32 s36, 1
    s_cbranch_scc1 Lp2a2_55
    s_waitcnt lgkmcnt(14)
    v_mfma_f32_16x16x32_bf16 v[32:35], a[0:3], v[64:67], v[32:35]
    v_mfma_f32_16x16x32_bf16 v[48:51], a[0:3], v[68:71], v[48:51]
    ds_read_b64_tr_b16 a[0:1], v10 offset:0
    ds_read_b64_tr_b16 a[2:3], v10 offset:2048
    s_waitcnt lgkmcnt(14)
    v_mfma_f32_16x16x32_bf16 v[36:39], a[4:7], v[64:67], v[36:39]
    v_mfma_f32_16x16x32_bf16 v[52:55], a[4:7], v[68:71], v[52:55]
    ds_read_b64_tr_b16 a[4:5], v11 offset:0
    ds_read_b64_tr_b16 a[6:7], v11 offset:2048
    s_waitcnt lgkmcnt(14)
    v_mfma_f32_16x16x32_bf16 v[40:43], a[8:11], v[64:67], v[40:43]
    v_mfma_f32_16x16x32_bf16 v[56:59], a[8:11], v[68:71], v[56:59]
    ds_read_b64_tr_b16 a[8:9], v12 offset:0
    ds_read_b64_tr_b16 a[10:11], v12 offset:2048
    s_waitcnt lgkmcnt(14)
    v_mfma_f32_16x16x32_bf16 v[44:47], a[12:15], v[64:67], v[44:47]
    v_mfma_f32_16x16x32_bf16 v[60:63], a[12:15], v[68:71], v[60:63]
    ds_read_b64_tr_b16 a[12:13], v13 offset:0
    ds_read_b64_tr_b16 a[14:15], v13 offset:2048
    s_waitcnt lgkmcnt(14)
    v_mfma_f32_16x16x32_bf16 v[32:35], a[16:19], v[72:75], v[32:35]
    v_mfma_f32_16x16x32_bf16 v[48:51], a[16:19], v[76:79], v[48:51]
    ds_read_b64_tr_b16 a[16:17], v10 offset:4096
    ds_read_b64_tr_b16 a[18:19], v10 offset:6144
    s_waitcnt lgkmcnt(14)
    v_mfma_f32_16x16x32_bf16 v[36:39], a[20:23], v[72:75], v[36:39]
    v_mfma_f32_16x16x32_bf16 v[52:55], a[20:23], v[76:79], v[52:55]
    ds_read_b64_tr_b16 a[20:21], v11 offset:4096
    ds_read_b64_tr_b16 a[22:23], v11 offset:6144
    s_waitcnt vmcnt(0)
    s_mov_b32 s36, 0
    s_waitcnt lgkmcnt(14)
    v_mfma_f32_16x16x32_bf16 v[40:43], a[24:27], v[72:75], v[40:43]
    v_max3_u32 v18, v80, v81, v82
    v_max3_u32 v19, v83, v84, v85
    v_mfma_f32_16x16x32_bf16 v[56:59], a[24:27], v[76:79], v[56:59]
    v_max3_u32 v20, v86, v87, v88
    v_max3_u32 v18, v18, v89, v90
    ds_read_b64_tr_b16 a[24:25], v12 offset:4096
    ds_read_b64_tr_b16 a[26:27], v12 offset:6144
    s_waitcnt lgkmcnt(14)
    v_mfma_f32_16x16x32_bf16 v[44:47], a[28:31], v[72:75], v[44:47]
    v_max3_u32 v19, v19, v91, v92
    v_max3_u32 v20, v20, v93, v94
    v_mfma_f32_16x16x32_bf16 v[60:63], a[28:31], v[76:79], v[60:63]
    v_max3_u32 v18, v18, v19, v95
    v_max_u32 v18, v18, v20
    v_cmp_lt_u32 vcc, s49, v18
    ds_read_b64_tr_b16 a[28:29], v13 offset:4096
    ds_read_b64_tr_b16 a[30:31], v13 offset:6144
    s_cbranch_vccnz Lp2f1_32
    s_branch Lp2d0_35
Lp2a2_55:
    v_readfirstlane_b32 s40, v4
    v_readfirstlane_b32 s41, v5
    s_or_b64 s[46:47], s[46:47], s[40:41]
    s_waitcnt lgkmcnt(14)
    v_mfma_f32_16x16x32_bf16 v[32:35], a[0:3], v[64:67], v[32:35]
    v_mfma_f32_16x16x32_bf16 v[48:51], a[0:3], v[68:71], v[48:51]
    ds_read_b64_tr_b16 a[0:1], v10 offset:0
    ds_read_b64_tr_b16 a[2:3], v10 offset:2048
    s_branch Lp2g_48
Lp2gb_49:
    s_waitcnt lgkmcnt(14)
    v_mfma_f32_16x16x32_bf16 v[36:39], a[4:7], v[64:67], v[36:39]
    v_mfma_f32_16x16x32_bf16 v[52:55], a[4:7], v[68:71], v[52:55]
    ds_read_b64_tr_b16 a[4:5], v11 offset:0
    ds_read_b64_tr_b16 a[6:7], v11 offset:2048
    s_waitcnt lgkmcnt(14)
    v_mfma_f32_16x16x32_bf16 v[40:43], a[8:11], v[64:67], v[40:43]
    v_mfma_f32_16x16x32_bf16 v[56:59], a[8:11], v[68:71], v[56:59]
    ds_read_b64_tr_b16 a[8:9], v12 offset:0
    ds_read_b64_tr_b16 a[10:11], v12 offset:2048
    s_andn2_b64 s[40:41], s[44:45], s[46:47]
    s_cbranch_scc1 Lp2p_51
Lp2pb_50:
    s_waitcnt lgkmcnt(14)
    v_mfma_f32_16x16x32_bf16 v[44:47], a[12:15], v[64:67], v[44:47]
    v_mfma_f32_16x16x32_bf16 v[60:63], a[12:15], v[68:71], v[60:63]
    ds_read_b64_tr_b16 a[12:13], v13 offset:0
    ds_read_b64_tr_b16 a[14:15], v13 offset:2048
    s_waitcnt lgkmcnt(14)
    v_mfma_f32_16x16x32_bf16 v[32:35], a[16:19], v[72:75], v[32:35]
    v_mfma_f32_16x16x32_bf16 v[48:51], a[16:19], v[76:79], v[48:51]
    ds_read_b64_tr_b16 a[16:17], v10 offset:4096
    ds_read_b64_tr_b16 a[18:19], v10 offset:6144
    s_waitcnt lgkmcnt(14)
    v_mfma_f32_16x16x32_bf16 v[36:39], a[20:23], v[72:75], v[36:39]
    v_mfma_f32_16x16x32_bf16 v[52:55], a[20:23], v[76:79], v[52:55]
    ds_read_b64_tr_b16 a[20:21], v11 offset:4096
    ds_read_b64_tr_b16 a[22:23], v11 offset:6144
    s_branch Lp2w_52
Lp2wb_53:
    s_waitcnt lgkmcnt(14)
    v_mfma_f32_16x16x32_bf16 v[40:43], a[24:27], v[72:75], v[40:43]
    v_max3_u32 v18, v80, v81, v82
    v_max3_u32 v19, v83, v84, v85
    v_mfma_f32_16x16x32_bf16 v[56:59], a[24:27], v[76:79], v[56:59]
    v_max3_u32 v20, v86, v87, v88
    v_max3_u32 v18, v18, v89, v90
    ds_read_b64_tr_b16 a[24:25], v12 offset:4096
    ds_read_b64_tr_b16 a[26:27], v12 offset:6144
    s_waitcnt lgkmcnt(14)
    v_mfma_f32_16x16x32_bf16 v[44:47], a[28:31], v[72:75], v[44:47]
    v_max3_u32 v19, v19, v91, v92
    v_max3_u32 v20, v20, v93, v94
    v_mfma_f32_16x16x32_bf16 v[60:63], a[28:31], v[76:79], v[60:63]
    v_max3_u32 v18, v18, v19, v95
    v_max_u32 v18, v18, v20
    v_cmp_lt_u32 vcc, s49, v18
    ds_read_b64_tr_b16 a[28:29], v13 offset:4096
    ds_read_b64_tr_b16 a[30:31], v13 offset:6144
    s_sub_u32 s36, s36, 1
    s_cbranch_scc1 Lp2e1_29
    s_cbranch_vccnz Lp2f1_32
    s_branch Lp2s1_26
Lp2g_48:
    s_cmp_lg_u32 s36, 1
    s_cbranch_scc1 Lp2c_56
    s_and_b64 s[40:41], s[44:45], s[46:47]
    s_cbranch_scc0 Lp2gb_49
    s_ff1_i32_b64 s42, s[40:41]
    s_bitset0_b64 s[44:45], s42
    s_lshr_b32 s42, s42, 2
    s_lshl_b32 s82, s42, 13
    s_lshl_b32 s40, s82, 5
    s_add_u32 s40, s40, s16
    s_add_u32 s41, s40, 131072
    buffer_load_dwordx4 v[96:99], v24, s[4:7], s40 offen sc1
    buffer_load_dwordx4 v[100:103], v25, s[4:7], s40 offen sc1
    buffer_load_dwordx4 v[104:107], v24, s[4:7], s41 offen sc1
    buffer_load_dwordx4 v[108:111], v25, s[4:7], s41 offen sc1
    s_add_u32 s36, s36, 1
Lp2c_56:
    s_branch Lp2gb_49
Lp2p_51:
    s_mov_b64 exec, 1
    buffer_atomic_umax_x2 v[4:5], off, s[20:23], s43 sc0 sc1
    s_mov_b64 exec, -1
    s_branch Lp2pb_50
Lp2w_52:
    s_cmp_lt_u32 s36, 2
    s_cbranch_scc1 Lwn_57
    s_waitcnt vmcnt(4)
    s_branch Lp2wb_53
Lwn_57:
    s_waitcnt vmcnt(0)
    s_branch Lp2wb_53
Lp2e0_28:
    s_mov_b32 s36, 0
    s_or_b32 s40, s44, s45
    s_cbranch_scc0 Lp2done_34
Lp2l_58:
    ds_read_b64 v[6:7], v8
    v_readfirstlane_b32 s40, v4
    v_readfirstlane_b32 s41, v5
    s_or_b64 s[46:47], s[46:47], s[40:41]
    s_and_b64 s[40:41], s[44:45], s[46:47]
    s_cbranch_scc1 Lp2go_59
    s_mov_b64 exec, 1
    buffer_atomic_umax_x2 v[4:5], off, s[20:23], s43 sc0 sc1
    s_mov_b64 exec, -1
    s_waitcnt lgkmcnt(0)
    v_readfirstlane_b32 s40, v6
    v_readfirstlane_b32 s41, v7
    s_or_b64 s[46:47], s[46:47], s[40:41]
    s_and_b64 s[40:41], s[44:45], s[46:47]
    s_cbranch_scc1 Lp2go_59
    s_waitcnt vmcnt(0)
    s_mov_b64 exec, 1
    ds_or_b64 v8, v[4:5]
    s_mov_b64 exec, -1
    s_add_u32 s101, s101, 1
    s_cmp_ge_u32 s101, 200000
    s_cselect_b32 s49, -1, s49
    s_cselect_b64 s[46:47], -1, s[46:47]
    s_branch Lp2l_58
Lp2go_59:
    s_and_b64 s[40:41], s[44:45], s[46:47]
    s_cbranch_scc0 Lp2l_58
    s_ff1_i32_b64 s42, s[40:41]
    s_bitset0_b64 s[44:45], s42
    s_lshr_b32 s42, s42, 2
    s_lshl_b32 s80, s42, 13
    s_lshl_b32 s40, s80, 5
    s_add_u32 s40, s40, s16
    s_add_u32 s41, s40, 131072
    buffer_load_dwordx4 v[64:67], v24, s[4:7], s40 offen sc1
    buffer_load_dwordx4 v[68:71], v25, s[4:7], s40 offen sc1
    buffer_load_dwordx4 v[72:75], v24, s[4:7], s41 offen sc1
    buffer_load_dwordx4 v[76:79], v25, s[4:7], s41 offen sc1
    v_add_u32 v10, s80, v26
    v_add_u32 v11, s80, v27
    v_add_u32 v12, s80, v28
    v_add_u32 v13, s80, v29
    ds_read_b64_tr_b16 a[0:1], v10 offset:0
    ds_read_b64_tr_b16 a[2:3], v10 offset:2048
    ds_read_b64_tr_b16 a[4:5], v11 offset:0
    ds_read_b64_tr_b16 a[6:7], v11 offset:2048
    ds_read_b64_tr_b16 a[8:9], v12 offset:0
    ds_read_b64_tr_b16 a[10:11], v12 offset:2048
    ds_read_b64_tr_b16 a[12:13], v13 offset:0
    ds_read_b64_tr_b16 a[14:15], v13 offset:2048
    ds_read_b64_tr_b16 a[16:17], v10 offset:4096
    ds_read_b64_tr_b16 a[18:19], v10 offset:6144
    ds_read_b64_tr_b16 a[20:21], v11 offset:4096
    ds_read_b64_tr_b16 a[22:23], v11 offset:6144
    ds_read_b64_tr_b16 a[24:25], v12 offset:4096
    ds_read_b64_tr_b16 a[26:27], v12 offset:6144
    ds_read_b64_tr_b16 a[28:29], v13 offset:4096
    ds_read_b64_tr_b16 a[30:31], v13 offset:6144
    s_and_b64 s[40:41], s[44:45], s[46:47]
    s_cbranch_scc0 Lp2ce_60
    s_ff1_i32_b64 s42, s[40:41]
    s_bitset0_b64 s[44:45], s42
    s_lshr_b32 s42, s42, 2
    s_lshl_b32 s81, s42, 13
    s_lshl_b32 s40, s81, 5
    s_add_u32 s40, s40, s16
    s_add_u32 s41, s40, 131072
    buffer_load_dwordx4 v[80:83], v24, s[4:7], s40 offen sc1
    buffer_load_dwordx4 v[84:87], v25, s[4:7], s40 offen sc1
    buffer_load_dwordx4 v[88:91], v24, s[4:7], s41 offen sc1
    buffer_load_dwordx4 v[92:95], v25, s[4:7], s41 offen sc1
    s_add_u32 s36, s36, 1
Lp2ce_60:
    s_cmp_lt_u32 s36, 1
    s_cbranch_scc1 Lwn_63
    s_waitcnt vmcnt(4)
    s_branch Lp2w2_36
Lwn_63:
    s_waitcnt vmcnt(0)
    s_branch Lp2w2_36
Lp2w2_36:
    v_max3_u32 v18, v64, v65, v66
    v_max3_u32 v19, v67, v68, v69
    v_max3_u32 v20, v70, v71, v72
    v_max3_u32 v18, v18, v73, v74
    v_max3_u32 v19, v19, v75, v76
    v_max3_u32 v20, v20, v77, v78
    v_max3_u32 v18, v18, v19, v79
    v_max_u32 v18, v18, v20
    v_cmp_lt_u32 vcc, s49, v18
    s_cbranch_vccz Lp2s0_25
Lp2f0_31:
    s_add_u32 s101, s101, 1
    s_cmp_ge_u32 s101, 200000
    s_cselect_b32 s49, -1, s49
    s_cselect_b64 s[46:47], -1, s[46:47]
    s_lshl_b32 s40, s80, 5
    s_add_u32 s40, s40, s16
    s_add_u32 s41, s40, 131072
    buffer_load_dwordx4 v[64:67], v24, s[4:7], s40 offen sc1
    buffer_load_dwordx4 v[68:71], v25, s[4:7], s40 offen sc1
    buffer_load_dwordx4 v[72:75], v24, s[4:7], s41 offen sc1
    buffer_load_dwordx4 v[76:79], v25, s[4:7], s41 offen sc1
    s_waitcnt vmcnt(0)
    s_branch Lp2w2_36
Lp2a2_71:
Lp2d0_35:
    s_waitcnt lgkmcnt(14)
    v_mfma_f32_16x16x32_bf16 v[32:35], a[0:3], v[80:83], v[32:35]
    v_mfma_f32_16x16x32_bf16 v[48:51], a[0:3], v[84:87], v[48:51]
    s_waitcnt lgkmcnt(12)
    v_mfma_f32_16x16x32_bf16 v[36:39], a[4:7], v[80:83], v[36:39]
    v_mfma_f32_16x16x32_bf16 v[52:55], a[4:7], v[84:87], v[52:55]
    s_waitcnt lgkmcnt(10)
    v_mfma_f32_16x16x32_bf16 v[40:43], a[8:11], v[80:83], v[40:43]
    v_mfma_f32_16x16x32_bf16 v[56:59], a[8:11], v[84:87], v[56:59]
    s_waitcnt lgkmcnt(8)
    v_mfma_f32_16x16x32_bf16 v[44:47], a[12:15], v[80:83], v[44:47]
    v_mfma_f32_16x16x32_bf16 v[60:63], a[12:15], v[84:87], v[60:63]
    s_waitcnt lgkmcnt(6)
    v_mfma_f32_16x16x32_bf16 v[32:35], a[16:19], v[88:91], v[32:35]
    v_mfma_f32_16x16x32_bf16 v[48:51], a[16:19], v[92:95], v[48:51]
    s_waitcnt lgkmcnt(4)
    v_mfma_f32_16x16x32_bf16 v[36:39], a[20:23], v[88:91], v[36:39]
    v_mfma_f32_16x16x32_bf16 v[52:55], a[20:23], v[92:95], v[52:55]
    s_waitcnt lgkmcnt(2)
    v_mfma_f32_16x16x32_bf16 v[40:43], a[24:27], v[88:91], v[40:43]
    v_mfma_f32_16x16x32_bf16 v[56:59], a[24:27], v[92:95], v[56:59]
    s_waitcnt lgkmcnt(0)
    v_mfma_f32_16x16x32_bf16 v[44:47], a[28:31], v[88:91], v[44:47]
    v_mfma_f32_16x16x32_bf16 v[60:63], a[28:31], v[92:95], v[60:63]
    s_branch Lp2done_34
Lp2alt_70:
    s_or_b32 s40, s44, s45
    s_or_b32 s40, s40, s36
    s_cbranch_scc0 Lp2a2_71
    v_readfirstlane_b32 s40, v4
    v_readfirstlane_b32 s41, v5
    s_or_b64 s[46:47], s[46:47], s[40:41]
    s_waitcnt lgkmcnt(14)
    v_mfma_f32_16x16x32_bf16 v[32:35], a[0:3], v[80:83], v[32:35]
    v_mfma_f32_16x16x32_bf16 v[48:51], a[0:3], v[84:87], v[48:51]
    ds_read_b64_tr_b16 a[0:1], v10 offset:0
    ds_read_b64_tr_b16 a[2:3], v10 offset:2048
    s_branch Lp2g_64
Lp2gb_65:
    s_waitcnt lgkmcnt(14)
    v_mfma_f32_16x16x32_bf16 v[36:39], a[4:7], v[80:83], v[36:39]
    v_mfma_f32_16x16x32_bf16 v[52:55], a[4:7], v[84:87], v[52:55]
    ds_read_b64_tr_b16 a[4:5], v11 offset:0
    ds_read_b64_tr_b16 a[6:7], v11 offset:2048
    s_waitcnt lgkmcnt(14)
    v_mfma_f32_16x16x32_bf16 v[40:43], a[8:11], v[80:83], v[40:43]
    v_mfma_f32_16x16x32_bf16 v[56:59], a[8:11], v[84:87], v[56:59]
    ds_read_b64_tr_b16 a[8:9], v12 offset:0
    ds_read_b64_tr_b16 a[10:11], v12 offset:2048
    s_andn2_b64 s[40:41], s[44:45], s[46:47]
    s_cbranch_scc1 Lp2p_67
Lp2pb_66:
    s_waitcnt lgkmcnt(14)
    v_mfma_f32_16x16x32_bf16 v[44:47], a[12:15], v[80:83], v[44:47]
    v_mfma_f32_16x16x32_bf16 v[60:63], a[12:15], v[84:87], v[60:63]
    ds_read_b64_tr_b16 a[12:13], v13 offset:0
    ds_read_b64_tr_b16 a[14:15], v13 offset:2048
    s_waitcnt lgkmcnt(14)
    v_mfma_f32_16x16x32_bf16 v[32:35], a[16:19], v[88:91], v[32:35]
    v_mfma_f32_16x16x32_bf16 v[48:51], a[16:19], v[92:95], v[48:51]
    ds_read_b64_tr_b16 a[16:17], v10 offset:4096
    ds_read_b64_tr_b16 a[18:19], v10 offset:6144
    s_waitcnt lgkmcnt(14)
    v_mfma_f32_16x16x32_bf16 v[36:39], a[20:23], v[88:91], v[36:39]
    v_mfma_f32_16x16x32_bf16 v[52:55], a[20:23], v[92:95], v[52:55]
    ds_read_b64_tr_b16 a[20:21], v11 offset:4096
    ds_read_b64_tr_b16 a[22:23], v11 offset:6144
    s_branch Lp2w_68
Lp2wb_69:
    s_waitcnt lgkmcnt(14)
    v_mfma_f32_16x16x32_bf16 v[40:43], a[24:27], v[88:91], v[40:43]
    v_max3_u32 v18, v96, v97, v98
    v_max3_u32 v19, v99, v100, v101
    v_mfma_f32_16x16x32_bf16 v[56:59], a[24:27], v[92:95], v[56:59]
    v_max3_u32 v20, v102, v103, v104
    v_max3_u32 v18, v18, v105, v106
    ds_read_b64_tr_b16 a[24:25], v12 offset:4096
    ds_read_b64_tr_b16 a[26:27], v12 offset:6144
    s_waitcnt lgkmcnt(14)
    v_mfma_f32_16x16x32_bf16 v[44:47], a[28:31], v[88:91], v[44:47]
    v_max3_u32 v19, v19, v107, v108
    v_max3_u32 v20, v20, v109, v110
    v_mfma_f32_16x16x32_bf16 v[60:63], a[28:31], v[92:95], v[60:63]
    v_max3_u32 v18, v18, v19, v111
    v_max_u32 v18, v18, v20
    v_cmp_lt_u32 vcc, s49, v18
    ds_read_b64_tr_b16 a[28:29], v13 offset:4096
    ds_read_b64_tr_b16 a[30:31], v13 offset:6144
    s_sub_u32 s36, s36, 1
    s_cbranch_scc1 Lp2e2_30
    s_cbranch_vccnz Lp2f2_33
    s_branch Lp2s2_27
Lp2g_64:
    s_cmp_lg_u32 s36, 1
    s_cbranch_scc1 Lp2c_72
    s_and_b64 s[40:41], s[44:45], s[46:47]
    s_cbranch_scc0 Lp2gb_65
    s_ff1_i32_b64 s42, s[40:41]
    s_bitset0_b64 s[44:45], s42
    s_lshr_b32 s42, s42, 2
    s_lshl_b32 s80, s42, 13
    s_lshl_b32 s40, s80, 5
    s_add_u32 s40, s40, s16
    s_add_u32 s41, s40, 131072
    buffer_load_dwordx4 v[64:67], v24, s[4:7], s40 offen sc1
    buffer_load_dwordx4 v[68:71], v25, s[4:7], s40 offen sc1
    buffer_load_dwordx4 v[72:75], v24, s[4:7], s41 offen sc1
    buffer_load_dwordx4 v[76:79], v25, s[4:7], s41 offen sc1
    s_add_u32 s36, s36, 1
Lp2c_72:
    s_branch Lp2gb_65
Lp2p_67:
    s_mov_b64 exec, 1
    buffer_atomic_umax_x2 v[4:5], off, s[20:23], s43 sc0 sc1
    s_mov_b64 exec, -1
    s_branch Lp2pb_66
Lp2w_68:
    s_cmp_lt_u32 s36, 2
    s_cbranch_scc1 Lwn_73
    s_waitcnt vmcnt(4)
    s_branch Lp2wb_69
Lwn_73:
    s_waitcnt vmcnt(0)
    s_branch Lp2wb_69
Lp2e1_29:
    s_mov_b32 s36, 0
    s_or_b32 s40, s44, s45
    s_cbranch_scc0 Lp2done_34
Lp2l_74:
    ds_read_b64 v[6:7], v8
    v_readfirstlane_b32 s40, v4
    v_readfirstlane_b32 s41, v5
    s_or_b64 s[46:47], s[46:47], s[40:41]
    s_and_b64 s[40:41], s[44:45], s[46:47]
    s_cbranch_scc1 Lp2go_75
    s_mov_b64 exec, 1
    buffer_atomic_umax_x2 v[4:5], off, s[20:23], s43 sc0 sc1
    s_mov_b64 exec, -1
    s_waitcnt lgkmcnt(0)
    v_readfirstlane_b32 s40, v6
    v_readfirstlane_b32 s41, v7
    s_or_b64 s[46:47], s[46:47], s[40:41]
    s_and_b64 s[40:41], s[44:45], s[46:47]
    s_cbranch_scc1 Lp2go_75
    s_waitcnt vmcnt(0)
    s_mov_b64 exec, 1
    ds_or_b64 v8, v[4:5]
    s_mov_b64 exec, -1
    s_add_u32 s101, s101, 1
    s_cmp_ge_u32 s101, 200000
    s_cselect_b32 s49, -1, s49
    s_cselect_b64 s[46:47], -1, s[46:47]
    s_branch Lp2l_74
Lp2go_75:
    s_and_b64 s[40:41], s[44:45], s[46:47]
    s_cbranch_scc0 Lp2l_74
    s_ff1_i32_b64 s42, s[40:41]
    s_bitset0_b64 s[44:45], s42
    s_lshr_b32 s42, s42, 2
    s_lshl_b32 s81, s42, 13
    s_lshl_b32 s40, s81, 5
    s_add_u32 s40, s40, s16
    s_add_u32 s41, s40, 131072
    buffer_load_dwordx4 v[80:83], v24, s[4:7], s40 offen sc1
    buffer_load_dwordx4 v[84:87], v25, s[4:7], s40 offen sc1
    buffer_load_dwordx4 v[88:91], v24, s[4:7], s41 offen sc1
    buffer_load_dwordx4 v[92:95], v25, s[4:7], s41 offen sc1
    v_add_u32 v10, s81, v26
    v_add_u32 v11, s81, v27
    v_add_u32 v12, s81, v28
    v_add_u32 v13, s81, v29
    ds_read_b64_tr_b16 a[0:1], v10 offset:0
    ds_read_b64_tr_b16 a[2:3], v10 offset:2048
    ds_read_b64_tr_b16 a[4:5], v11 offset:0
    ds_read_b64_tr_b16 a[6:7], v11 offset:2048
    ds_read_b64_tr_b16 a[8:9], v12 offset:0
    ds_read_b64_tr_b16 a[10:11], v12 offset:2048
    ds_read_b64_tr_b16 a[12:13], v13 offset:0
    ds_read_b64_tr_b16 a[14:15], v13 offset:2048
    ds_read_b64_tr_b16 a[16:17], v10 offset:4096
    ds_read_b64_tr_b16 a[18:19], v10 offset:6144
    ds_read_b64_tr_b16 a[20:21], v11 offset:4096
    ds_read_b64_tr_b16 a[22:23], v11 offset:6144
    ds_read_b64_tr_b16 a[24:25], v12 offset:4096
    ds_read_b64_tr_b16 a[26:27], v12 offset:6144
    ds_read_b64_tr_b16 a[28:29], v13 offset:4096
    ds_read_b64_tr_b16 a[30:31], v13 offset:6144
    s_and_b64 s[40:41], s[44:45], s[46:47]
    s_cbranch_scc0 Lp2ce_76
    s_ff1_i32_b64 s42, s[40:41]
    s_bitset0_b64 s[44:45], s42
    s_lshr_b32 s42, s42, 2
    s_lshl_b32 s82, s42, 13
    s_lshl_b32 s40, s82, 5
    s_add_u32 s40, s40, s16
    s_add_u32 s41, s40, 131072
    buffer_load_dwordx4 v[96:99], v24, s[4:7], s40 offen sc1
    buffer_load_dwordx4 v[100:103], v25, s[4:7], s40 offen sc1
    buffer_load_dwordx4 v[104:107], v24, s[4:7], s41 offen sc1
    buffer_load_dwordx4 v[108:111], v25, s[4:7], s41 offen sc1
    s_add_u32 s36, s36, 1
Lp2ce_76:
    s_cmp_lt_u32 s36, 1
    s_cbranch_scc1 Lwn_79
    s_waitcnt vmcnt(4)
    s_branch Lp2w2_37
Lwn_79:
    s_waitcnt vmcnt(0)
    s_branch Lp2w2_37
Lp2w2_37:
    v_max3_u32 v18, v80, v81, v82
    v_max3_u32 v19, v83, v84, v85
    v_max3_u32 v20, v86, v87, v88
    v_max3_u32 v18, v18, v89, v90
    v_max3_u32 v19, v19, v91, v92
    v_max3_u32 v20, v20, v93, v94
    v_max3_u32 v18, v18, v19, v95
    v_max_u32 v18, v18, v20
    v_cmp_lt_u32 vcc, s49, v18
    s_cbranch_vccz Lp2s1_26
Lp2f1_32:
    s_add_u32 s101, s101, 1
    s_cmp_ge_u32 s101, 200000
    s_cselect_b32 s49, -1, s49
    s_cselect_b64 s[46:47], -1, s[46:47]
    s_lshl_b32 s40, s81, 5
    s_add_u32 s40, s40, s16
    s_add_u32 s41, s40, 131072
    buffer_load_dwordx4 v[80:83], v24, s[4:7], s40 offen sc1
    buffer_load_dwordx4 v[84:87], v25, s[4:7], s40 offen sc1
    buffer_load_dwordx4 v[88:91], v24, s[4:7], s41 offen sc1
    buffer_load_dwordx4 v[92:95], v25, s[4:7], s41 offen sc1
    s_waitcnt vmcnt(0)
    s_branch Lp2w2_37
Lp2alt_86:
    v_readfirstlane_b32 s40, v4
    v_readfirstlane_b32 s41, v5
    s_or_b64 s[46:47], s[46:47], s[40:41]
    s_waitcnt lgkmcnt(14)
    v_mfma_f32_16x16x32_bf16 v[32:35], a[0:3], v[96:99], v[32:35]
    v_mfma_f32_16x16x32_bf16 v[48:51], a[0:3], v[100:103], v[48:51]
    ds_read_b64_tr_b16 a[0:1], v10 offset:0
    ds_read_b64_tr_b16 a[2:3], v10 offset:2048
    s_branch Lp2g_80
Lp2gb_81:
    s_waitcnt lgkmcnt(14)
    v_mfma_f32_16x16x32_bf16 v[36:39], a[4:7], v[96:99], v[36:39]
    v_mfma_f32_16x16x32_bf16 v[52:55], a[4:7], v[100:103], v[52:55]
    ds_read_b64_tr_b16 a[4:5], v11 offset:0
    ds_read_b64_tr_b16 a[6:7], v11 offset:2048
    s_waitcnt lgkmcnt(14)
    v_mfma_f32_16x16x32_bf16 v[40:43], a[8:11], v[96:99], v[40:43]
    v_mfma_f32_16x16x32_bf16 v[56:59], a[8:11], v[100:103], v[56:59]
    ds_read_b64_tr_b16 a[8:9], v12 offset:0
    ds_read_b64_tr_b16 a[10:11], v12 offset:2048
    s_andn2_b64 s[40:41], s[44:45], s[46:47]
    s_cbranch_scc1 Lp2p_83
Lp2pb_82:
    s_waitcnt lgkmcnt(14)
    v_mfma_f32_16x16x32_bf16 v[44:47], a[12:15], v[96:99], v[44:47]
    v_mfma_f32_16x16x32_bf16 v[60:63], a[12:15], v[100:103], v[60:63]
    ds_read_b64_tr_b16 a[12:13], v13 offset:0
    ds_read_b64_tr_b16 a[14:15], v13 offset:2048
    s_waitcnt lgkmcnt(14)
    v_mfma_f32_16x16x32_bf16 v[32:35], a[16:19], v[104:107], v[32:35]
    v_mfma_f32_16x16x32_bf16 v[48:51], a[16:19], v[108:111], v[48:51]
    ds_read_b64_tr_b16 a[16:17], v10 offset:4096
    ds_read_b64_tr_b16 a[18:19], v10 offset:6144
    s_waitcnt lgkmcnt(14)
    v_mfma_f32_16x16x32_bf16 v[36:39], a[20:23], v[104:107], v[36:39]
    v_mfma_f32_16x16x32_bf16 v[52:55], a[20:23], v[108:111], v[52:55]
    ds_read_b64_tr_b16 a[20:21], v11 offset:4096
    ds_read_b64_tr_b16 a[22:23], v11 offset:6144
    s_branch Lp2w_84
Lp2wb_85:
    s_waitcnt lgkmcnt(14)
    v_mfma_f32_16x16x32_bf16 v[40:43], a[24:27], v[104:107], v[40:43]
    v_max3_u32 v18, v64, v65, v66
    v_max3_u32 v19, v67, v68, v69
    v_mfma_f32_16x16x32_bf16 v[56:59], a[24:27], v[108:111], v[56:59]
    v_max3_u32 v20, v70, v71, v72
    v_max3_u32 v18, v18, v73, v74
    ds_read_b64_tr_b16 a[24:25], v12 offset:4096
    ds_read_b64_tr_b16 a[26:27], v12 offset:6144
    s_waitcnt lgkmcnt(14)
    v_mfma_f32_16x16x32_bf16 v[44:47], a[28:31], v[104:107], v[44:47]
    v_max3_u32 v19, v19, v75, v76
    v_max3_u32 v20, v20, v77, v78
    v_mfma_f32_16x16x32_bf16 v[60:63], a[28:31], v[108:111], v[60:63]
    v_max3_u32 v18, v18, v19, v79
    v_max_u32 v18, v18, v20
    v_cmp_lt_u32 vcc, s49, v18
    ds_read_b64_tr_b16 a[28:29], v13 offset:4096
    ds_read_b64_tr_b16 a[30:31], v13 offset:6144
    s_sub_u32 s36, s36, 1
    s_cbranch_scc1 Lp2e0_28
    s_cbranch_vccnz Lp2f0_31
    s_branch Lp2s0_25
Lp2g_80:
    s_cmp_lg_u32 s36, 1
    s_cbranch_scc1 Lp2c_87
    s_and_b64 s[40:41], s[44:45], s[46:47]
    s_cbranch_scc0 Lp2gb_81
    s_ff1_i32_b64 s42, s[40:41]
    s_bitset0_b64 s[44:45], s42
    s_lshr_b32 s42, s42, 2
    s_lshl_b32 s81, s42, 13
    s_lshl_b32 s40, s81, 5
    s_add_u32 s40, s40, s16
    s_add_u32 s41, s40, 131072
    buffer_load_dwordx4 v[80:83], v24, s[4:7], s40 offen sc1
    buffer_load_dwordx4 v[84:87], v25, s[4:7], s40 offen sc1
    buffer_load_dwordx4 v[88:91], v24, s[4:7], s41 offen sc1
    buffer_load_dwordx4 v[92:95], v25, s[4:7], s41 offen sc1
    s_add_u32 s36, s36, 1
Lp2c_87:
    s_branch Lp2gb_81
Lp2p_83:
    s_mov_b64 exec, 1
    buffer_atomic_umax_x2 v[4:5], off, s[20:23], s43 sc0 sc1
    s_mov_b64 exec, -1
    s_branch Lp2pb_82
Lp2w_84:
    s_cmp_lt_u32 s36, 2
    s_cbranch_scc1 Lwn_88
    s_waitcnt vmcnt(4)
    s_branch Lp2wb_85
Lwn_88:
    s_waitcnt vmcnt(0)
    s_branch Lp2wb_85
Lp2e2_30:
    s_mov_b32 s36, 0
    s_or_b32 s40, s44, s45
    s_cbranch_scc0 Lp2done_34
Lp2l_89:
    ds_read_b64 v[6:7], v8
    v_readfirstlane_b32 s40, v4
    v_readfirstlane_b32 s41, v5
    s_or_b64 s[46:47], s[46:47], s[40:41]
    s_and_b64 s[40:41], s[44:45], s[46:47]
    s_cbranch_scc1 Lp2go_90
    s_mov_b64 exec, 1
    buffer_atomic_umax_x2 v[4:5], off, s[20:23], s43 sc0 sc1
    s_mov_b64 exec, -1
    s_waitcnt lgkmcnt(0)
    v_readfirstlane_b32 s40, v6
    v_readfirstlane_b32 s41, v7
    s_or_b64 s[46:47], s[46:47], s[40:41]
    s_and_b64 s[40:41], s[44:45], s[46:47]
    s_cbranch_scc1 Lp2go_90
    s_waitcnt vmcnt(0)
    s_mov_b64 exec, 1
    ds_or_b64 v8, v[4:5]
    s_mov_b64 exec, -1
    s_add_u32 s101, s101, 1
    s_cmp_ge_u32 s101, 200000
    s_cselect_b32 s49, -1, s49
    s_cselect_b64 s[46:47], -1, s[46:47]
    s_branch Lp2l_89
Lp2go_90:
    s_and_b64 s[40:41], s[44:45], s[46:47]
    s_cbranch_scc0 Lp2l_89
    s_ff1_i32_b64 s42, s[40:41]
    s_bitset0_b64 s[44:45], s42
    s_lshr_b32 s42, s42, 2
    s_lshl_b32 s82, s42, 13
    s_lshl_b32 s40, s82, 5
    s_add_u32 s40, s40, s16
    s_add_u32 s41, s40, 131072
    buffer_load_dwordx4 v[96:99], v24, s[4:7], s40 offen sc1
    buffer_load_dwordx4 v[100:103], v25, s[4:7], s40 offen sc1
    buffer_load_dwordx4 v[104:107], v24, s[4:7], s41 offen sc1
    buffer_load_dwordx4 v[108:111], v25, s[4:7], s41 offen sc1
    v_add_u32 v10, s82, v26
    v_add_u32 v11, s82, v27
    v_add_u32 v12, s82, v28
    v_add_u32 v13, s82, v29
    ds_read_b64_tr_b16 a[0:1], v10 offset:0
    ds_read_b64_tr_b16 a[2:3], v10 offset:2048
    ds_read_b64_tr_b16 a[4:5], v11 offset:0
    ds_read_b64_tr_b16 a[6:7], v11 offset:2048
    ds_read_b64_tr_b16 a[8:9], v12 offset:0
    ds_read_b64_tr_b16 a[10:11], v12 offset:2048
    ds_read_b64_tr_b16 a[12:13], v13 offset:0
    ds_read_b64_tr_b16 a[14:15], v13 offset:2048
    ds_read_b64_tr_b16 a[16:17], v10 offset:4096
    ds_read_b64_tr_b16 a[18:19], v10 offset:6144
    ds_read_b64_tr_b16 a[20:21], v11 offset:4096
    ds_read_b64_tr_b16 a[22:23], v11 offset:6144
    ds_read_b64_tr_b16 a[24:25], v12 offset:4096
    ds_read_b64_tr_b16 a[26:27], v12 offset:6144
    ds_read_b64_tr_b16 a[28:29], v13 offset:4096
    ds_read_b64_tr_b16 a[30:31], v13 offset:6144
    s_and_b64 s[40:41], s[44:45], s[46:47]
    s_cbranch_scc0 Lp2ce_91
    s_ff1_i32_b64 s42, s[40:41]
    s_bitset0_b64 s[44:45], s42
    s_lshr_b32 s42, s42, 2
    s_lshl_b32 s80, s42, 13
    s_lshl_b32 s40, s80, 5
    s_add_u32 s40, s40, s16
    s_add_u32 s41, s40, 131072
    buffer_load_dwordx4 v[64:67], v24, s[4:7], s40 offen sc1
    buffer_load_dwordx4 v[68:71], v25, s[4:7], s40 offen sc1
    buffer_load_dwordx4 v[72:75], v24, s[4:7], s41 offen sc1
    buffer_load_dwordx4 v[76:79], v25, s[4:7], s41 offen sc1
    s_add_u32 s36, s36, 1
Lp2ce_91:
    s_cmp_lt_u32 s36, 1
    s_cbranch_scc1 Lwn_94
    s_waitcnt vmcnt(4)
    s_branch Lp2w2_38
Lwn_94:
    s_waitcnt vmcnt(0)
    s_branch Lp2w2_38
Lp2w2_38:
    v_max3_u32 v18, v96, v97, v98
    v_max3_u32 v19, v99, v100, v101
    v_max3_u32 v20, v102, v103, v104
    v_max3_u32 v18, v18, v105, v106
    v_max3_u32 v19, v19, v107, v108
    v_max3_u32 v20, v20, v109, v110
    v_max3_u32 v18, v18, v19, v111
    v_max_u32 v18, v18, v20
    v_cmp_lt_u32 vcc, s49, v18
    s_cbranch_vccz Lp2s2_27
Lp2f2_33:
    s_add_u32 s101, s101, 1
    s_cmp_ge_u32 s101, 200000
    s_cselect_b32 s49, -1, s49
    s_cselect_b64 s[46:47], -1, s[46:47]
    s_lshl_b32 s40, s82, 5
    s_add_u32 s40, s40, s16
    s_add_u32 s41, s40, 131072
    buffer_load_dwordx4 v[96:99], v24, s[4:7], s40 offen sc1
    buffer_load_dwordx4 v[100:103], v25, s[4:7], s40 offen sc1
    buffer_load_dwordx4 v[104:107], v24, s[4:7], s41 offen sc1
    buffer_load_dwordx4 v[108:111], v25, s[4:7], s41 offen sc1
    s_waitcnt vmcnt(0)
    s_branch Lp2w2_38
Lhk_107:
    s_cmp_lg_u32 s38, 4
    s_cbranch_scc1 Lhn_109
    s_nop 7
    v_min_u32 v8, -2, v8
    v_min_u32 v9, -2, v9
    v_min_u32 v10, -2, v10
    v_min_u32 v11, -2, v11
    v_min_u32 v12, -2, v12
    v_min_u32 v13, -2, v13
    v_min_u32 v14, -2, v14
    v_min_u32 v15, -2, v15
    s_mov_b32 exec_lo, 0x10001
    s_mov_b32 exec_hi, 0x10001
    buffer_store_dwordx4 v[8:11], v30, s[20:23], s44 offen sc1
    buffer_store_dwordx4 v[12:15], v31, s[20:23], s44 offen sc1
    s_mov_b64 exec, -1
    s_nop 0
    v_mov_b32 v8, 0
    v_mov_b32 v9, 0
    v_mov_b32 v10, 0
    v_mov_b32 v11, 0
    v_mov_b32 v12, 0
    v_mov_b32 v13, 0
    v_mov_b32 v14, 0
    v_mov_b32 v15, 0
    s_branch Lhkb_108
Lhn_109:
    s_endpgm
Lhok_142:
    ds_read_b32 v3, v10
    ds_read_b128 v[148:151], v14
    ds_read_b128 v[152:155], v14 offset:1024
    s_branch Lhw_141
Lhk_155:
    s_cmp_lg_u32 s38, 11
    s_cbranch_scc1 Lhn_157
    v_and_b32 v140, 15, v0
    v_lshlrev_b32 v140, 14, v140
    s_lshl_b32 s40, s81, 6
    s_add_u32 s84, s84, s40
    s_lshl_b32 s40, s33, 4
    s_add_u32 s84, s84, s40
    buffer_load_dwordx4 v[128:131], v140, s[20:23], s84 offen sc1
    s_waitcnt vmcnt(9) lgkmcnt(0)
    s_branch Lhkb_156
Lhn_157:
    s_cmp_lg_u32 s38, 9
    s_cbranch_scc1 Lhn_158
    s_waitcnt vmcnt(16)
    s_mov_b32 s101, 0
Lsp_153:
    v_max3_u32 v132, v128, v129, v130
    v_max_u32 v132, v132, v131
    v_cmp_eq_u32 vcc, -1, v132
    s_cbranch_vccz Lsp_153x
    s_add_u32 s101, s101, 1
    s_cmp_ge_u32 s101, 200000
    s_cbranch_scc1 Lsp_153x
    buffer_load_dwordx4 v[128:131], v140, s[20:23], s84 offen sc1
    s_waitcnt vmcnt(0)
    s_branch Lsp_153
Lsp_153x:
    v_add_f32_dpp v132, v128, v128 row_ror:8 row_mask:0xf bank_mask:0xf
    v_add_f32_dpp v133, v130, v130 row_ror:8 row_mask:0xf bank_mask:0xf
    s_nop 0
    v_add_f32_dpp v132, v132, v132 row_ror:4 row_mask:0xf bank_mask:0xf
    v_add_f32_dpp v133, v133, v133 row_ror:4 row_mask:0xf bank_mask:0xf
    s_nop 0
    v_add_f32_dpp v132, v132, v132 row_ror:2 row_mask:0xf bank_mask:0xf
    v_add_f32_dpp v133, v133, v133 row_ror:2 row_mask:0xf bank_mask:0xf
    s_nop 0
    v_add_f32_dpp v132, v132, v132 row_ror:1 row_mask:0xf bank_mask:0xf
    v_add_f32_dpp v133, v133, v133 row_ror:1 row_mask:0xf bank_mask:0xf
    s_nop 0
    v_fmac_f32 v128, 3179282432, v132
    v_fmac_f32 v130, 3179282432, v133
    v_mul_f32 v128, v128, v128
    v_mul_f32 v130, v130, v130
    v_fmac_f32 v129, 1015021568, v128
    v_fmac_f32 v131, 1015021568, v130
    s_lshl_b32 s84, s80, 2
    s_lshr_b32 s40, s81, 3
    v_add_f32_dpp v129, v129, v129 row_ror:8 row_mask:0xf bank_mask:0xf
    v_add_f32_dpp v131, v131, v131 row_ror:8 row_mask:0xf bank_mask:0xf
    s_nop 0
    v_add_f32_dpp v129, v129, v129 row_ror:4 row_mask:0xf bank_mask:0xf
    v_add_f32_dpp v131, v131, v131 row_ror:4 row_mask:0xf bank_mask:0xf
    s_nop 0
    v_add_f32_dpp v129, v129, v129 row_ror:2 row_mask:0xf bank_mask:0xf
    v_add_f32_dpp v131, v131, v131 row_ror:2 row_mask:0xf bank_mask:0xf
    s_nop 0
    v_add_f32_dpp v129, v129, v129 row_ror:1 row_mask:0xf bank_mask:0xf
    v_add_f32_dpp v131, v131, v131 row_ror:1 row_mask:0xf bank_mask:0xf
    s_nop 0
    v_mov_b32 v136, 925353388
    v_mov_b32 v138, 925353388
    v_fmac_f32 v136, 981467136, v129
    v_fmac_f32 v138, 981467136, v131
    v_rsq_f32 v136, v136
    v_rsq_f32 v138, v138
    v_mul_f32 v137, 3128950784, v132
    v_mul_f32 v139, 3128950784, v133
    s_add_u32 s84, s84, s40
    s_lshl_b32 s84, s84, 11
    s_and_b32 s40, s81, 7
    s_lshl_b32 s40, s40, 6
    s_add_u32 s84, s84, s40
    s_lshl_b32 s40, s33, 4
    s_add_u32 s84, s84, s40
    s_add_u32 s84, s84, 262144
    v_min_u32 v136, -2, v136
    v_min_u32 v137, -2, v137
    v_min_u32 v138, -2, v138
    v_min_u32 v139, -2, v139
    s_mov_b64 exec, 1
    buffer_store_dwordx4 v[136:139], off, s[20:23], s84 offset:1536 sc1
    s_mov_b64 exec, -1
    s_waitcnt vmcnt(9) lgkmcnt(0)
    s_branch Lhkb_156
Lhn_158:
    s_cmp_lg_u32 s38, 3
    s_cbranch_scc1 Lhn_159
    buffer_load_dwordx4 a[88:91], v1, s[72:75], s79 offen
    v_lshrrev_b32 v20, 1, v20
    v_min_u32 v20, 892, v20
    s_lshl_b32 s84, s81, 13
    s_add_u32 s84, s84, 262144
    s_add_u32 s85, s84, 4096
    v_lshlrev_b32 v140, 3, v0
    s_lshl_b32 s49, s80, 2
    s_add_u32 s49, s49, s33
    s_lshl_b32 s49, s49, 11
    s_add_u32 s49, s49, 262144
    s_waitcnt vmcnt(9) lgkmcnt(0)
    s_branch Lhkb_156
Lhn_159:
    s_cmp_lg_u32 s38, 4
    s_cbranch_scc1 Lhn_160
    s_nop 7
    v_min_u32 v144, -2, v144
    v_min_u32 v145, -2, v145
    v_min_u32 v146, -2, v146
    v_min_u32 v147, -2, v147
    v_min_u32 v148, -2, v148
    v_min_u32 v149, -2, v149
    v_min_u32 v150, -2, v150
    v_min_u32 v151, -2, v151
    s_mov_b32 exec_lo, 0x10001
    s_mov_b32 exec_hi, 0x10001
    buffer_store_dwordx4 v[144:147], v30, s[20:23], s44 offen sc1
    buffer_store_dwordx4 v[148:151], v31, s[20:23], s44 offen sc1
    s_mov_b64 exec, -1
    s_nop 0
    v_mov_b32 v144, 0
    v_mov_b32 v145, 0
    v_mov_b32 v146, 0
    v_mov_b32 v147, 0
    v_mov_b32 v148, 0
    v_mov_b32 v149, 0
    v_mov_b32 v150, 0
    v_mov_b32 v151, 0
    s_waitcnt vmcnt(10) lgkmcnt(0)
    s_branch Lhkb_156
Lhn_160:
    s_endpgm
.section .rodata,"a"
.p2align 6
.amdhsa_kernel sequential_preLN__sliding_local_dilated__geglu_ffn__prompt_kernel
  .amdhsa_next_free_vgpr 256
  .amdhsa_next_free_sgpr 102
  .amdhsa_accum_offset 160
  .amdhsa_group_segment_fixed_size 0
  .amdhsa_kernarg_size 80
  .amdhsa_user_sgpr_count 2
  .amdhsa_user_sgpr_kernarg_segment_ptr 1
  .amdhsa_system_sgpr_workgroup_id_x 1
.end_amdhsa_kernel
```
